```python
import torch

def _softmax(x, axis=-1):
    return torch.softmax(x, dim=axis)
def _gelu(x):
    return torch.nn.functional.gelu(x, approximate="tanh")
def _silu(x):
    return torch.nn.functional.silu(x)
def _sigmoid(x):
    return torch.sigmoid(x)
def _layernorm(x, axis=-1, eps=1e-5):
    m = x.mean(dim=axis, keepdim=True)
    v = x.var(dim=axis, keepdim=True, unbiased=False)
    return (x - m) / torch.sqrt(v + eps)
def _scatter_add(tgt, idx, src, axis=0):
    return tgt.clone().index_add_(axis, idx, src)
def _segment_sum(src, seg, n):
    out = torch.zeros((n,) + src.shape[1:], dtype=src.dtype)
    return out.index_add_(0, seg, src)
def _pad(x, pw):
    flat = tuple(v for pair in reversed(pw) for v in pair)
    return torch.nn.functional.pad(x, flat)

kernel_name = 'interleave_layers__sliding_local_dilated__mixer_channel_mlp__prompt'

def setup_inputs():

    _w = (lambda a: (lambda t: t.to(torch.bfloat16) if t.is_floating_point() else t)(torch.as_tensor(a)))
    def _A_setup():
        B, S, D = 1, 2048, 576
        return {
            "x": _w((lambda *s: torch.randn(*s, dtype=torch.bfloat16) * 0.05)(B, S, D)),
            "wqkv": _w((lambda *s: torch.randn(*s, dtype=torch.bfloat16) * 0.05)(D, 3 * D)),
            "wo": _w((lambda *s: torch.randn(*s, dtype=torch.bfloat16) * 0.05)(D, D)),
        }
    _A_in = _A_setup()

    def _B_setup():
        B, S, D, F = 1, 2048, 576, 4608
        return {
            "x": _w((lambda *s: torch.randn(*s, dtype=torch.bfloat16) * 0.05)(B, S, D)),
            "w1": _w((lambda *s: torch.randn(*s, dtype=torch.bfloat16) * 3.2)(D, F) * (D ** -0.5)),
            "b1": _w((lambda *s: torch.randn(*s, dtype=torch.bfloat16) * 0.8)(F)),
            "w2": _w((lambda *s: torch.randn(*s, dtype=torch.bfloat16) * 0.2)(F, D) * (F ** -0.5)),
            "b2": _w((lambda *s: torch.randn(*s, dtype=torch.bfloat16) * 0.2)(D)),
        }
    _B_in = _B_setup()

    return {
        "A_x": _A_in["x"],
        "A_wqkv": _A_in["wqkv"],
        "A_wo": _A_in["wo"],
        "B_x": _B_in["x"],
        "B_w1": _B_in["w1"],
        "B_b1": _B_in["b1"],
        "B_w2": _B_in["w2"],
        "B_b2": _B_in["b2"],
    }

def reference(A_x, A_wqkv, A_wo, B_x, B_w1, B_b1, B_w2, B_b2):
    def _A_ref(x, wqkv, wo):
        B, S, D = x.shape
        H = 32; Dh = D // H
        W, dil = 8, 2
        qkv = (lambda x, *d: x.permute(*d))((x @ wqkv).reshape(B, S, 3, H, Dh), 2, 0, 3, 1, 4)
        q, k, v = qkv[0], qkv[1], qkv[2]
        scale = Dh ** -0.5
        pos = torch.arange(S)
        off = torch.arange(W) * dil
        idx = pos[:, None] - off[None, :]
        mask = idx >= 0
        idx_c = torch.where(mask, idx, 0).reshape(-1)
        kg = k[:, :, idx_c, :].reshape(B, H, S, W, Dh)
        vg = v[:, :, idx_c, :].reshape(B, H, S, W, Dh)
        logits = torch.einsum("bhsd,bhswd->bhsw", q, kg) * scale
        logits = torch.where(mask[None, None, :, :], logits, -1e9)
        attn = _softmax(logits, axis=-1)
        o = torch.einsum("bhsw,bhswd->bhsd", attn, vg)
        return (lambda x, *d: x.permute(*d))(o, 0, 2, 1, 3).reshape(B, S, D) @ wo

    def _B_ref(x, w1, b1, w2, b2):
        y = _layernorm(x, axis=-1)
        h = _gelu(torch.einsum("bsd,df->bsf", y, w1) + b1)
        return torch.einsum("bsf,fd->bsd", h, w2) + b2

    x = A_x
    x = x + _A_ref(_layernorm(x, axis=-1), A_wqkv, A_wo)
    x = x + _B_ref(_layernorm(x, axis=-1), B_w1, B_b1, B_w2, B_b2)
    x = x + _A_ref(_layernorm(x, axis=-1), A_wqkv, A_wo)
    x = x + _B_ref(_layernorm(x, axis=-1), B_w1, B_b1, B_w2, B_b2)
    return x
```

```asm
; @launch kernel=p0_kernel grid=(248,1,1) block=(256,1,1) lds=86016
; @launch kernel=main_kernel grid=(256,1,1) block=(256,1,1) lds=163840
.amdgcn_target "amdgcn-amd-amdhsa--gfx950"
.text
.globl p0_kernel
.p2align 8
.type p0_kernel,@function
p0_kernel:
    s_mov_b32 s59, 0
p0_kernel_body:
    s_cmp_ge_u32 s2, 248
    s_cbranch_scc1 p0_kernel_end
    s_load_dwordx4 s[16:19], s[0:1], 0
    s_load_dwordx2 s[20:21], s[0:1], 16
    s_load_dwordx4 s[24:27], s[0:1], 32
    s_load_dwordx2 s[28:29], s[0:1], 48
    s_load_dwordx2 s[30:31], s[0:1], 80
    v_and_b32 v1, 63, v0
    v_lshrrev_b32 v2, 6, v0
    s_nop 0
    v_readfirstlane_b32 s3, v2
    v_lshlrev_b32 v3, 4, v1
    v_and_b32 v4, 15, v1
    v_lshrrev_b32 v5, 4, v1
    v_lshrrev_b32 v6, 3, v1
    v_and_b32 v7, 7, v1
    s_mul_i32 s40, s3, 18432
    v_lshrrev_b32 v11, 2, v1
    v_lshlrev_b32 v11, 7, v11
    v_and_b32 v12, 3, v1
    v_lshl_add_u32 v11, v12, 3, v11
    s_lshl_b32 s38, s3, 5
    v_add_u32 v11, s38, v11
    s_waitcnt lgkmcnt(0)
    s_getpc_b64 s[52:53]
p0_kernel_pc:
    s_lshr_b32 s54, s2, 3
    s_lshl_b32 s54, s54, 2
    s_add_u32 s54, s54, s3
    s_mul_i32 s54, s54, 512
    s_add_u32 s54, s54, main_kernel-p0_kernel_pc
    s_min_u32 s54, s54, code_end-p0_kernel_pc-448
    s_add_u32 s52, s52, s54
    s_addc_u32 s53, s53, 0
    s_getpc_b64 s[56:57]
    s_lshr_b32 s58, s2, 3
    s_lshl_b32 s58, s58, 2
    s_add_u32 s58, s58, s3
    s_lshl_b32 s58, s58, 6
    s_load_dword s55, s[56:57], s58
    s_load_dword s55, s[52:53], 0
    s_load_dword s55, s[52:53], 64
    s_load_dword s55, s[52:53], 128
    s_load_dword s55, s[52:53], 192
    s_load_dword s55, s[52:53], 256
    s_load_dword s55, s[52:53], 320
    s_load_dword s55, s[52:53], 384
    s_load_dword s55, s[52:53], 448
    s_mov_b32 s4, s30
    s_and_b32 s5, s31, 0xffff
    s_mov_b32 s6, 201326592
    s_mov_b32 s7, 0x00020000
    s_mov_b32 s36, 268435456
    s_mov_b32 s37, 268435456
    v_lshlrev_b32 v9, 2, v4
    v_mov_b32 v10, 0
    s_cmp_ge_u32 s2, 76
    s_cselect_b32 s44, 44971008, 0
    s_lshl_b32 s45, s2, 8
    s_add_u32 s44, s44, s45
    s_cmp_ge_u32 s2, 152
    s_cselect_b32 s44, 268435456, s44
    s_cmp_lg_u32 s3, 1
    s_cselect_b32 s44, 268435456, s44
    v_lshlrev_b32 v12, 2, v1
    buffer_store_dword v10, v12, s[4:7], s44 offen
    s_cmp_ge_u32 s2, 216
    s_nop 0
    s_cbranch_scc1 p0_kernel_x
    s_cmp_ge_u32 s2, 198
    s_cbranch_scc1 p0_kernel_wo
    s_cmp_ge_u32 s2, 144
    s_cbranch_scc1 p0_kernel_wq
    s_and_b32 s41, s2, 7
    s_lshr_b32 s42, s2, 3
    s_cmp_ge_u32 s42, 9
    s_cbranch_scc1 p0_kernel_rw2
    s_mov_b32 s12, s24
    s_and_b32 s13, s25, 0xffff
    s_mov_b32 s14, 5308416
    s_mov_b32 s15, 0x00020000
    s_mul_i32 s41, s2, 2731
    s_lshr_b32 s41, s41, 16
    s_mul_i32 s42, s41, 24
    s_sub_u32 s42, s2, s42
    s_mul_i32 s56, s42, 43691
    s_lshr_b32 s56, s56, 17
    v_mul_u32_u24 v8, 9216, v6
    v_lshl_add_u32 v8, v7, 4, v8
    s_mul_i32 s32, s42, 384
    s_add_u32 s45, s32, s38
    s_mul_i32 s44, s41, 1769472
    s_add_u32 s32, s32, s44
    s_mul_i32 s44, s3, 73728
    s_add_u32 s32, s32, s44
    s_mov_b32 s48, s26
    s_and_b32 s49, s27, 0xffff
    s_mov_b32 s50, 9216
    s_mov_b32 s51, 0x00020000
    v_lshlrev_b32 v12, 1, v4
    buffer_load_ushort v88, v12, s[48:51], s45 offen offset:0
    buffer_load_ushort v89, v12, s[48:51], s45 offen offset:128
    buffer_load_ushort v90, v12, s[48:51], s45 offen offset:256
    s_lshl_b32 s44, s3, 10
    s_add_u32 m0, s44, 0
    s_add_u32 s33, s32, 0
    buffer_load_dwordx4 v8, s[12:15], s33 offen nt lds
    s_add_u32 m0, s44, 24576
    s_add_u32 s33, s32, 128
    buffer_load_dwordx4 v8, s[12:15], s33 offen nt lds
    s_add_u32 m0, s44, 49152
    s_add_u32 s33, s32, 256
    buffer_load_dwordx4 v8, s[12:15], s33 offen nt lds
    s_add_u32 m0, s44, 4096
    s_add_u32 s33, s32, 294912
    buffer_load_dwordx4 v8, s[12:15], s33 offen nt lds
    s_add_u32 m0, s44, 28672
    s_add_u32 s33, s32, 295040
    buffer_load_dwordx4 v8, s[12:15], s33 offen nt lds
    s_add_u32 m0, s44, 53248
    s_add_u32 s33, s32, 295168
    buffer_load_dwordx4 v8, s[12:15], s33 offen nt lds
    s_add_u32 m0, s44, 8192
    s_add_u32 s33, s32, 589824
    buffer_load_dwordx4 v8, s[12:15], s33 offen nt lds
    s_add_u32 m0, s44, 32768
    s_add_u32 s33, s32, 589952
    buffer_load_dwordx4 v8, s[12:15], s33 offen nt lds
    s_add_u32 m0, s44, 57344
    s_add_u32 s33, s32, 590080
    buffer_load_dwordx4 v8, s[12:15], s33 offen nt lds
    s_add_u32 m0, s44, 12288
    s_add_u32 s33, s32, 884736
    buffer_load_dwordx4 v8, s[12:15], s33 offen nt lds
    s_add_u32 m0, s44, 36864
    s_add_u32 s33, s32, 884864
    buffer_load_dwordx4 v8, s[12:15], s33 offen nt lds
    s_add_u32 m0, s44, 61440
    s_add_u32 s33, s32, 884992
    buffer_load_dwordx4 v8, s[12:15], s33 offen nt lds
    s_add_u32 m0, s44, 16384
    s_add_u32 s33, s32, 1179648
    buffer_load_dwordx4 v8, s[12:15], s33 offen nt lds
    s_add_u32 m0, s44, 40960
    s_add_u32 s33, s32, 1179776
    buffer_load_dwordx4 v8, s[12:15], s33 offen nt lds
    s_add_u32 m0, s44, 65536
    s_add_u32 s33, s32, 1179904
    buffer_load_dwordx4 v8, s[12:15], s33 offen nt lds
    s_add_u32 m0, s44, 20480
    s_add_u32 s33, s32, 1474560
    buffer_load_dwordx4 v8, s[12:15], s33 offen nt lds
    s_add_u32 m0, s44, 45056
    s_add_u32 s33, s32, 1474688
    buffer_load_dwordx4 v8, s[12:15], s33 offen nt lds
    s_add_u32 m0, s44, 69632
    s_add_u32 s33, s32, 1474816
    buffer_load_dwordx4 v8, s[12:15], s33 offen nt lds
    s_mul_i32 s43, s42, 6
    s_lshr_b32 s44, s3, 1
    s_add_u32 s43, s43, s44
    s_add_u32 s43, s43, 0
    s_mul_i32 s46, s43, 7282
    s_lshr_b32 s46, s46, 16
    s_mul_i32 s47, s46, 9
    s_sub_u32 s47, s43, s47
    s_mul_i32 s34, s46, 737280
    s_mul_i32 s44, s47, 19
    s_cmp_lt_u32 s47, 2
    s_cselect_b32 s44, s47, s44
    s_cselect_b32 s45, 2, 1
    s_lshl_b32 s44, s44, 11
    s_add_u32 s34, s34, s44
    s_lshl_b32 s35, s45, 11
    s_and_b32 s44, s3, 1
    s_lshl_b32 s44, s44, 10
    s_add_u32 s34, s34, s44
    s_add_u32 s34, s34, 92708864
    s_mul_i32 s44, s35, 18
    s_add_u32 s52, s34, s44
    s_mul_i32 s44, s41, 6
    s_mul_i32 s44, s44, s35
    s_add_u32 s34, s34, s44
    s_mul_i32 s43, s42, 6
    s_lshr_b32 s44, s3, 1
    s_add_u32 s43, s43, s44
    s_add_u32 s43, s43, 2
    s_mul_i32 s46, s43, 7282
    s_lshr_b32 s46, s46, 16
    s_mul_i32 s47, s46, 9
    s_sub_u32 s47, s43, s47
    s_mul_i32 s36, s46, 737280
    s_mul_i32 s44, s47, 19
    s_cmp_lt_u32 s47, 2
    s_cselect_b32 s44, s47, s44
    s_cselect_b32 s45, 2, 1
    s_lshl_b32 s44, s44, 11
    s_add_u32 s36, s36, s44
    s_lshl_b32 s37, s45, 11
    s_and_b32 s44, s3, 1
    s_lshl_b32 s44, s44, 10
    s_add_u32 s36, s36, s44
    s_add_u32 s36, s36, 92708864
    s_mul_i32 s44, s37, 18
    s_add_u32 s53, s36, s44
    s_mul_i32 s44, s41, 6
    s_mul_i32 s44, s44, s37
    s_add_u32 s36, s36, s44
    s_mul_i32 s43, s42, 6
    s_lshr_b32 s44, s3, 1
    s_add_u32 s43, s43, s44
    s_add_u32 s43, s43, 4
    s_mul_i32 s46, s43, 7282
    s_lshr_b32 s46, s46, 16
    s_mul_i32 s47, s46, 9
    s_sub_u32 s47, s43, s47
    s_mul_i32 s39, s46, 737280
    s_mul_i32 s44, s47, 19
    s_cmp_lt_u32 s47, 2
    s_cselect_b32 s44, s47, s44
    s_cselect_b32 s45, 2, 1
    s_lshl_b32 s44, s44, 11
    s_add_u32 s39, s39, s44
    s_lshl_b32 s40, s45, 11
    s_and_b32 s44, s3, 1
    s_lshl_b32 s44, s44, 10
    s_add_u32 s39, s39, s44
    s_add_u32 s39, s39, 92708864
    s_mul_i32 s44, s40, 18
    s_add_u32 s54, s39, s44
    s_mul_i32 s44, s41, 6
    s_mul_i32 s44, s44, s40
    s_add_u32 s39, s39, s44
    v_add_u32 v15, 24576, v11
    v_mov_b32 v12, 0x3f803f80
    v_mov_b32 v92, 0
    v_mov_b32 v93, 0
    v_mov_b32 v94, 0
    s_waitcnt vmcnt(15)
    s_barrier
    ds_read_b64_tr_b16 v[16:17], v11 offset:0
    ds_read_b64_tr_b16 v[18:19], v11 offset:2048
    ds_read_b64_tr_b16 v[20:21], v11 offset:24576
    ds_read_b64_tr_b16 v[22:23], v11 offset:26624
    ds_read_b64_tr_b16 v[24:25], v15 offset:24576
    ds_read_b64_tr_b16 v[26:27], v15 offset:26624
    s_waitcnt lgkmcnt(0)
    buffer_store_dwordx4 v[16:19], v3, s[4:7], s34 offen sc1
    s_add_u32 s34, s34, s35
    v_dot2c_f32_bf16 v92, v16, v12
    v_dot2c_f32_bf16 v92, v17, v12
    v_dot2c_f32_bf16 v92, v18, v12
    v_dot2c_f32_bf16 v92, v19, v12
    buffer_store_dwordx4 v[20:23], v3, s[4:7], s36 offen sc1
    s_add_u32 s36, s36, s37
    v_dot2c_f32_bf16 v93, v20, v12
    v_dot2c_f32_bf16 v93, v21, v12
    v_dot2c_f32_bf16 v93, v22, v12
    v_dot2c_f32_bf16 v93, v23, v12
    buffer_store_dwordx4 v[24:27], v3, s[4:7], s39 offen sc1
    s_add_u32 s39, s39, s40
    v_dot2c_f32_bf16 v94, v24, v12
    v_dot2c_f32_bf16 v94, v25, v12
    v_dot2c_f32_bf16 v94, v26, v12
    v_dot2c_f32_bf16 v94, v27, v12
    s_waitcnt vmcnt(15)
    s_barrier
    ds_read_b64_tr_b16 v[28:29], v11 offset:4096
    ds_read_b64_tr_b16 v[30:31], v11 offset:6144
    ds_read_b64_tr_b16 v[32:33], v11 offset:28672
    ds_read_b64_tr_b16 v[34:35], v11 offset:30720
    ds_read_b64_tr_b16 v[36:37], v15 offset:28672
    ds_read_b64_tr_b16 v[38:39], v15 offset:30720
    s_waitcnt lgkmcnt(0)
    buffer_store_dwordx4 v[28:31], v3, s[4:7], s34 offen sc1
    s_add_u32 s34, s34, s35
    v_dot2c_f32_bf16 v92, v28, v12
    v_dot2c_f32_bf16 v92, v29, v12
    v_dot2c_f32_bf16 v92, v30, v12
    v_dot2c_f32_bf16 v92, v31, v12
    buffer_store_dwordx4 v[32:35], v3, s[4:7], s36 offen sc1
    s_add_u32 s36, s36, s37
    v_dot2c_f32_bf16 v93, v32, v12
    v_dot2c_f32_bf16 v93, v33, v12
    v_dot2c_f32_bf16 v93, v34, v12
    v_dot2c_f32_bf16 v93, v35, v12
    buffer_store_dwordx4 v[36:39], v3, s[4:7], s39 offen sc1
    s_add_u32 s39, s39, s40
    v_dot2c_f32_bf16 v94, v36, v12
    v_dot2c_f32_bf16 v94, v37, v12
    v_dot2c_f32_bf16 v94, v38, v12
    v_dot2c_f32_bf16 v94, v39, v12
    s_waitcnt vmcnt(15)
    s_barrier
    ds_read_b64_tr_b16 v[40:41], v11 offset:8192
    ds_read_b64_tr_b16 v[42:43], v11 offset:10240
    ds_read_b64_tr_b16 v[44:45], v11 offset:32768
    ds_read_b64_tr_b16 v[46:47], v11 offset:34816
    ds_read_b64_tr_b16 v[48:49], v15 offset:32768
    ds_read_b64_tr_b16 v[50:51], v15 offset:34816
    s_waitcnt lgkmcnt(0)
    buffer_store_dwordx4 v[40:43], v3, s[4:7], s34 offen sc1
    s_add_u32 s34, s34, s35
    v_dot2c_f32_bf16 v92, v40, v12
    v_dot2c_f32_bf16 v92, v41, v12
    v_dot2c_f32_bf16 v92, v42, v12
    v_dot2c_f32_bf16 v92, v43, v12
    buffer_store_dwordx4 v[44:47], v3, s[4:7], s36 offen sc1
    s_add_u32 s36, s36, s37
    v_dot2c_f32_bf16 v93, v44, v12
    v_dot2c_f32_bf16 v93, v45, v12
    v_dot2c_f32_bf16 v93, v46, v12
    v_dot2c_f32_bf16 v93, v47, v12
    buffer_store_dwordx4 v[48:51], v3, s[4:7], s39 offen sc1
    s_add_u32 s39, s39, s40
    v_dot2c_f32_bf16 v94, v48, v12
    v_dot2c_f32_bf16 v94, v49, v12
    v_dot2c_f32_bf16 v94, v50, v12
    v_dot2c_f32_bf16 v94, v51, v12
    s_waitcnt vmcnt(15)
    s_barrier
    ds_read_b64_tr_b16 v[52:53], v11 offset:12288
    ds_read_b64_tr_b16 v[54:55], v11 offset:14336
    ds_read_b64_tr_b16 v[56:57], v11 offset:36864
    ds_read_b64_tr_b16 v[58:59], v11 offset:38912
    ds_read_b64_tr_b16 v[60:61], v15 offset:36864
    ds_read_b64_tr_b16 v[62:63], v15 offset:38912
    s_waitcnt lgkmcnt(0)
    buffer_store_dwordx4 v[52:55], v3, s[4:7], s34 offen sc1
    s_add_u32 s34, s34, s35
    v_dot2c_f32_bf16 v92, v52, v12
    v_dot2c_f32_bf16 v92, v53, v12
    v_dot2c_f32_bf16 v92, v54, v12
    v_dot2c_f32_bf16 v92, v55, v12
    buffer_store_dwordx4 v[56:59], v3, s[4:7], s36 offen sc1
    s_add_u32 s36, s36, s37
    v_dot2c_f32_bf16 v93, v56, v12
    v_dot2c_f32_bf16 v93, v57, v12
    v_dot2c_f32_bf16 v93, v58, v12
    v_dot2c_f32_bf16 v93, v59, v12
    buffer_store_dwordx4 v[60:63], v3, s[4:7], s39 offen sc1
    s_add_u32 s39, s39, s40
    v_dot2c_f32_bf16 v94, v60, v12
    v_dot2c_f32_bf16 v94, v61, v12
    v_dot2c_f32_bf16 v94, v62, v12
    v_dot2c_f32_bf16 v94, v63, v12
    s_waitcnt vmcnt(15)
    s_barrier
    ds_read_b64_tr_b16 v[64:65], v11 offset:16384
    ds_read_b64_tr_b16 v[66:67], v11 offset:18432
    ds_read_b64_tr_b16 v[68:69], v11 offset:40960
    ds_read_b64_tr_b16 v[70:71], v11 offset:43008
    ds_read_b64_tr_b16 v[72:73], v15 offset:40960
    ds_read_b64_tr_b16 v[74:75], v15 offset:43008
    s_waitcnt lgkmcnt(0)
    buffer_store_dwordx4 v[64:67], v3, s[4:7], s34 offen sc1
    s_add_u32 s34, s34, s35
    v_dot2c_f32_bf16 v92, v64, v12
    v_dot2c_f32_bf16 v92, v65, v12
    v_dot2c_f32_bf16 v92, v66, v12
    v_dot2c_f32_bf16 v92, v67, v12
    buffer_store_dwordx4 v[68:71], v3, s[4:7], s36 offen sc1
    s_add_u32 s36, s36, s37
    v_dot2c_f32_bf16 v93, v68, v12
    v_dot2c_f32_bf16 v93, v69, v12
    v_dot2c_f32_bf16 v93, v70, v12
    v_dot2c_f32_bf16 v93, v71, v12
    buffer_store_dwordx4 v[72:75], v3, s[4:7], s39 offen sc1
    s_add_u32 s39, s39, s40
    v_dot2c_f32_bf16 v94, v72, v12
    v_dot2c_f32_bf16 v94, v73, v12
    v_dot2c_f32_bf16 v94, v74, v12
    v_dot2c_f32_bf16 v94, v75, v12
    s_waitcnt vmcnt(15)
    s_barrier
    ds_read_b64_tr_b16 v[76:77], v11 offset:20480
    ds_read_b64_tr_b16 v[78:79], v11 offset:22528
    ds_read_b64_tr_b16 v[80:81], v11 offset:45056
    ds_read_b64_tr_b16 v[82:83], v11 offset:47104
    ds_read_b64_tr_b16 v[84:85], v15 offset:45056
    ds_read_b64_tr_b16 v[86:87], v15 offset:47104
    s_waitcnt lgkmcnt(0)
    buffer_store_dwordx4 v[76:79], v3, s[4:7], s34 offen sc1
    s_add_u32 s34, s34, s35
    v_dot2c_f32_bf16 v92, v76, v12
    v_dot2c_f32_bf16 v92, v77, v12
    v_dot2c_f32_bf16 v92, v78, v12
    v_dot2c_f32_bf16 v92, v79, v12
    buffer_store_dwordx4 v[80:83], v3, s[4:7], s36 offen sc1
    s_add_u32 s36, s36, s37
    v_dot2c_f32_bf16 v93, v80, v12
    v_dot2c_f32_bf16 v93, v81, v12
    v_dot2c_f32_bf16 v93, v82, v12
    v_dot2c_f32_bf16 v93, v83, v12
    buffer_store_dwordx4 v[84:87], v3, s[4:7], s39 offen sc1
    s_add_u32 s39, s39, s40
    v_dot2c_f32_bf16 v94, v84, v12
    v_dot2c_f32_bf16 v94, v85, v12
    v_dot2c_f32_bf16 v94, v86, v12
    v_dot2c_f32_bf16 v94, v87, v12
    v_cmp_eq_u32 s[46:47], s41, v5
    s_cmp_eq_u32 s41, 0
    s_cselect_b32 s44, 3, s41
    s_cselect_b32 s45, -1, 0
    v_cmp_eq_u32 vcc, s44, v5
    s_nop 0
    s_or_b64 vcc, vcc, s[46:47]
    v_mov_b32 v8, 0x40000000
    v_cndmask_b32 v9, v8, v3, vcc
    v_mov_b32 v8, v92
    s_nop 1
    v_permlane16_swap_b32 v92, v8
    v_add_f32 v92, v92, v8
    v_mov_b32 v8, v92
    s_nop 1
    v_permlane32_swap_b32 v92, v8
    v_add_f32 v92, v92, v8
    v_lshl_or_b32 v16, v88, 16, v88
    v_and_b32 v16, s45, v16
    v_cvt_pk_bf16_f32 v18, v92, v92
    v_and_b32 v8, 0xffff0000, v18
    v_sub_f32 v8, v92, v8
    v_cvt_pk_bf16_f32 v17, v92, v8
    v_and_b32 v18, 0xffff, v18
    v_mov_b32 v19, 0
    v_cndmask_b32 v16, 0, v16, s[46:47]
    v_cndmask_b32 v17, 0, v17, s[46:47]
    v_cndmask_b32 v18, 0, v18, s[46:47]
    buffer_store_dwordx4 v[16:19], v9, s[4:7], s52 offen sc1
    v_mov_b32 v8, v93
    s_nop 1
    v_permlane16_swap_b32 v93, v8
    v_add_f32 v93, v93, v8
    v_mov_b32 v8, v93
    s_nop 1
    v_permlane32_swap_b32 v93, v8
    v_add_f32 v93, v93, v8
    v_lshl_or_b32 v20, v89, 16, v89
    v_and_b32 v20, s45, v20
    v_cvt_pk_bf16_f32 v22, v93, v93
    v_and_b32 v8, 0xffff0000, v22
    v_sub_f32 v8, v93, v8
    v_cvt_pk_bf16_f32 v21, v93, v8
    v_and_b32 v22, 0xffff, v22
    v_mov_b32 v23, 0
    v_cndmask_b32 v20, 0, v20, s[46:47]
    v_cndmask_b32 v21, 0, v21, s[46:47]
    v_cndmask_b32 v22, 0, v22, s[46:47]
    buffer_store_dwordx4 v[20:23], v9, s[4:7], s53 offen sc1
    v_mov_b32 v8, v94
    s_nop 1
    v_permlane16_swap_b32 v94, v8
    v_add_f32 v94, v94, v8
    v_mov_b32 v8, v94
    s_nop 1
    v_permlane32_swap_b32 v94, v8
    v_add_f32 v94, v94, v8
    v_lshl_or_b32 v24, v90, 16, v90
    v_and_b32 v24, s45, v24
    v_cvt_pk_bf16_f32 v26, v94, v94
    v_and_b32 v8, 0xffff0000, v26
    v_sub_f32 v8, v94, v8
    v_cvt_pk_bf16_f32 v25, v94, v8
    v_and_b32 v26, 0xffff, v26
    v_mov_b32 v27, 0
    v_cndmask_b32 v24, 0, v24, s[46:47]
    v_cndmask_b32 v25, 0, v25, s[46:47]
    v_cndmask_b32 v26, 0, v26, s[46:47]
    buffer_store_dwordx4 v[24:27], v9, s[4:7], s54 offen sc1
    s_endpgm
    s_nop 0
p0_kernel_rw2:
    s_mov_b32 s12, s28
    s_and_b32 s13, s29, 0xffff
    s_mov_b32 s14, 5308416
    s_mov_b32 s15, 0x00020000
    s_mov_b32 s56, s41
    s_sub_u32 s42, s42, 9
    v_mul_u32_u24 v8, 1152, v6
    v_lshl_add_u32 v8, v7, 4, v8
    s_mul_i32 s32, s41, 663552
    s_lshl_b32 s44, s42, 7
    s_add_u32 s32, s32, s44
    s_mul_i32 s44, s3, 9216
    s_add_u32 s32, s32, s44
    s_mov_b32 s33, 36864
    s_lshl_b32 s44, s3, 10
    s_mov_b32 m0, s44
    s_nop 0
    buffer_load_dwordx4 v8, s[12:15], s32 offen nt lds
    s_add_u32 s32, s32, s33
    s_add_u32 m0, m0, 4096
    s_nop 0
    buffer_load_dwordx4 v8, s[12:15], s32 offen nt lds
    s_add_u32 s32, s32, s33
    s_add_u32 m0, m0, 4096
    s_nop 0
    buffer_load_dwordx4 v8, s[12:15], s32 offen nt lds
    s_add_u32 s32, s32, s33
    s_add_u32 m0, m0, 4096
    s_nop 0
    buffer_load_dwordx4 v8, s[12:15], s32 offen nt lds
    s_add_u32 s32, s32, s33
    s_add_u32 m0, m0, 4096
    s_nop 0
    buffer_load_dwordx4 v8, s[12:15], s32 offen nt lds
    s_add_u32 s32, s32, s33
    s_add_u32 m0, m0, 4096
    s_nop 0
    buffer_load_dwordx4 v8, s[12:15], s32 offen nt lds
    s_add_u32 s32, s32, s33
    s_add_u32 m0, m0, 4096
    s_nop 0
    buffer_load_dwordx4 v8, s[12:15], s32 offen nt lds
    s_add_u32 s32, s32, s33
    s_add_u32 m0, m0, 4096
    s_nop 0
    buffer_load_dwordx4 v8, s[12:15], s32 offen nt lds
    s_add_u32 s32, s32, s33
    s_add_u32 m0, m0, 4096
    s_nop 0
    buffer_load_dwordx4 v8, s[12:15], s32 offen nt lds
    s_add_u32 s32, s32, s33
    s_add_u32 m0, m0, 4096
    s_nop 0
    buffer_load_dwordx4 v8, s[12:15], s32 offen nt lds
    s_add_u32 s32, s32, s33
    s_add_u32 m0, m0, 4096
    s_nop 0
    buffer_load_dwordx4 v8, s[12:15], s32 offen nt lds
    s_add_u32 s32, s32, s33
    s_add_u32 m0, m0, 4096
    s_nop 0
    buffer_load_dwordx4 v8, s[12:15], s32 offen nt lds
    s_add_u32 s32, s32, s33
    s_add_u32 m0, m0, 4096
    s_nop 0
    buffer_load_dwordx4 v8, s[12:15], s32 offen nt lds
    s_add_u32 s32, s32, s33
    s_add_u32 m0, m0, 4096
    s_nop 0
    buffer_load_dwordx4 v8, s[12:15], s32 offen nt lds
    s_add_u32 s32, s32, s33
    s_add_u32 m0, m0, 4096
    s_nop 0
    buffer_load_dwordx4 v8, s[12:15], s32 offen nt lds
    s_add_u32 s32, s32, s33
    s_add_u32 m0, m0, 4096
    s_nop 0
    buffer_load_dwordx4 v8, s[12:15], s32 offen nt lds
    s_add_u32 s32, s32, s33
    s_add_u32 m0, m0, 4096
    s_nop 0
    buffer_load_dwordx4 v8, s[12:15], s32 offen nt lds
    s_add_u32 s32, s32, s33
    s_add_u32 m0, m0, 4096
    s_nop 0
    buffer_load_dwordx4 v8, s[12:15], s32 offen nt lds
    s_add_u32 s32, s32, s33
    s_add_u32 m0, m0, 4096
    s_lshl_b32 s43, s42, 1
    s_lshr_b32 s44, s3, 1
    s_add_u32 s43, s43, s44
    s_cmp_ge_u32 s43, 9
    s_cselect_b32 s46, 1, 0
    s_mul_i32 s47, s46, 9
    s_sub_u32 s47, s43, s47
    s_cmp_ge_u32 s47, 5
    s_cselect_b32 s45, 1, 0
    s_lshl_b32 s46, s46, 1
    s_add_u32 s46, s46, s45
    s_mul_i32 s45, s45, 5
    s_sub_u32 s47, s47, s45
    v_add_u32 v15, 36864, v11
    s_lshr_b32 s34, s41, 1
    s_lshl_b32 s34, s34, 2
    s_add_u32 s34, s34, s46
    s_mul_i32 s34, s34, 737280
    s_and_b32 s44, s3, 1
    s_lshl_b32 s44, s44, 10
    s_add_u32 s34, s34, s44
    s_add_u32 s34, s34, 93059072
    s_lshl_b32 s44, s47, 11
    s_add_u32 s35, s34, s44
    s_mul_i32 s44, s47, 24576
    s_add_u32 s36, s34, s44
    s_add_u32 s36, s36, 196608
    s_and_b32 s37, s41, 1
    s_lshl_b32 s37, s37, 1
    s_add_u32 s37, s37, 0
    s_xor_b32 s37, s37, s46
    s_mul_i32 s39, s37, 3
    s_add_u32 s40, s39, 6
    s_cmp_eq_u32 s37, 0
    s_cselect_b32 s40, 0, s40
    s_mul_i32 s44, s40, 10240
    s_add_u32 s44, s44, s35
    s_lshl_b32 s45, s40, 11
    s_add_u32 s45, s45, s36
    s_cmp_lt_u32 s40, 24
    s_cselect_b32 s60, s44, s45
    s_mul_i32 s39, s37, 3
    s_add_u32 s40, s39, 7
    s_cmp_eq_u32 s37, 0
    s_cselect_b32 s40, 1, s40
    s_mul_i32 s44, s40, 10240
    s_add_u32 s44, s44, s35
    s_lshl_b32 s45, s40, 11
    s_add_u32 s45, s45, s36
    s_cmp_lt_u32 s40, 24
    s_cselect_b32 s61, s44, s45
    s_mul_i32 s39, s37, 3
    s_add_u32 s40, s39, 8
    s_cmp_eq_u32 s37, 0
    s_cselect_b32 s40, 2, s40
    s_mul_i32 s44, s40, 10240
    s_add_u32 s44, s44, s35
    s_lshl_b32 s45, s40, 11
    s_add_u32 s45, s45, s36
    s_cmp_lt_u32 s40, 24
    s_cselect_b32 s62, s44, s45
    s_mul_i32 s39, s37, 3
    s_add_u32 s40, s39, 15
    s_cmp_eq_u32 s37, 0
    s_cselect_b32 s40, 3, s40
    s_mul_i32 s44, s40, 10240
    s_add_u32 s44, s44, s35
    s_lshl_b32 s45, s40, 11
    s_add_u32 s45, s45, s36
    s_cmp_lt_u32 s40, 24
    s_cselect_b32 s63, s44, s45
    s_mul_i32 s39, s37, 3
    s_add_u32 s40, s39, 16
    s_cmp_eq_u32 s37, 0
    s_cselect_b32 s40, 4, s40
    s_mul_i32 s44, s40, 10240
    s_add_u32 s44, s44, s35
    s_lshl_b32 s45, s40, 11
    s_add_u32 s45, s45, s36
    s_cmp_lt_u32 s40, 24
    s_cselect_b32 s64, s44, s45
    s_mul_i32 s39, s37, 3
    s_add_u32 s40, s39, 17
    s_cmp_eq_u32 s37, 0
    s_cselect_b32 s40, 5, s40
    s_mul_i32 s44, s40, 10240
    s_add_u32 s44, s44, s35
    s_lshl_b32 s45, s40, 11
    s_add_u32 s45, s45, s36
    s_cmp_lt_u32 s40, 24
    s_cselect_b32 s65, s44, s45
    s_mul_i32 s39, s37, 3
    s_add_u32 s40, s39, 24
    s_cmp_eq_u32 s37, 0
    s_cselect_b32 s40, 6, s40
    s_mul_i32 s44, s40, 10240
    s_add_u32 s44, s44, s35
    s_lshl_b32 s45, s40, 11
    s_add_u32 s45, s45, s36
    s_cmp_lt_u32 s40, 24
    s_cselect_b32 s66, s44, s45
    s_mul_i32 s39, s37, 3
    s_add_u32 s40, s39, 25
    s_cmp_eq_u32 s37, 0
    s_cselect_b32 s40, 7, s40
    s_mul_i32 s44, s40, 10240
    s_add_u32 s44, s44, s35
    s_lshl_b32 s45, s40, 11
    s_add_u32 s45, s45, s36
    s_cmp_lt_u32 s40, 24
    s_cselect_b32 s67, s44, s45
    s_mul_i32 s39, s37, 3
    s_add_u32 s40, s39, 26
    s_cmp_eq_u32 s37, 0
    s_cselect_b32 s40, 8, s40
    s_mul_i32 s44, s40, 10240
    s_add_u32 s44, s44, s35
    s_lshl_b32 s45, s40, 11
    s_add_u32 s45, s45, s36
    s_cmp_lt_u32 s40, 24
    s_cselect_b32 s68, s44, s45
    s_and_b32 s37, s41, 1
    s_lshl_b32 s37, s37, 1
    s_add_u32 s37, s37, 1
    s_xor_b32 s37, s37, s46
    s_mul_i32 s39, s37, 3
    s_add_u32 s40, s39, 6
    s_cmp_eq_u32 s37, 0
    s_cselect_b32 s40, 0, s40
    s_mul_i32 s44, s40, 10240
    s_add_u32 s44, s44, s35
    s_lshl_b32 s45, s40, 11
    s_add_u32 s45, s45, s36
    s_cmp_lt_u32 s40, 24
    s_cselect_b32 s69, s44, s45
    s_mul_i32 s39, s37, 3
    s_add_u32 s40, s39, 7
    s_cmp_eq_u32 s37, 0
    s_cselect_b32 s40, 1, s40
    s_mul_i32 s44, s40, 10240
    s_add_u32 s44, s44, s35
    s_lshl_b32 s45, s40, 11
    s_add_u32 s45, s45, s36
    s_cmp_lt_u32 s40, 24
    s_cselect_b32 s70, s44, s45
    s_mul_i32 s39, s37, 3
    s_add_u32 s40, s39, 8
    s_cmp_eq_u32 s37, 0
    s_cselect_b32 s40, 2, s40
    s_mul_i32 s44, s40, 10240
    s_add_u32 s44, s44, s35
    s_lshl_b32 s45, s40, 11
    s_add_u32 s45, s45, s36
    s_cmp_lt_u32 s40, 24
    s_cselect_b32 s71, s44, s45
    s_mul_i32 s39, s37, 3
    s_add_u32 s40, s39, 15
    s_cmp_eq_u32 s37, 0
    s_cselect_b32 s40, 3, s40
    s_mul_i32 s44, s40, 10240
    s_add_u32 s44, s44, s35
    s_lshl_b32 s45, s40, 11
    s_add_u32 s45, s45, s36
    s_cmp_lt_u32 s40, 24
    s_cselect_b32 s72, s44, s45
    s_mul_i32 s39, s37, 3
    s_add_u32 s40, s39, 16
    s_cmp_eq_u32 s37, 0
    s_cselect_b32 s40, 4, s40
    s_mul_i32 s44, s40, 10240
    s_add_u32 s44, s44, s35
    s_lshl_b32 s45, s40, 11
    s_add_u32 s45, s45, s36
    s_cmp_lt_u32 s40, 24
    s_cselect_b32 s73, s44, s45
    s_mul_i32 s39, s37, 3
    s_add_u32 s40, s39, 17
    s_cmp_eq_u32 s37, 0
    s_cselect_b32 s40, 5, s40
    s_mul_i32 s44, s40, 10240
    s_add_u32 s44, s44, s35
    s_lshl_b32 s45, s40, 11
    s_add_u32 s45, s45, s36
    s_cmp_lt_u32 s40, 24
    s_cselect_b32 s74, s44, s45
    s_mul_i32 s39, s37, 3
    s_add_u32 s40, s39, 24
    s_cmp_eq_u32 s37, 0
    s_cselect_b32 s40, 6, s40
    s_mul_i32 s44, s40, 10240
    s_add_u32 s44, s44, s35
    s_lshl_b32 s45, s40, 11
    s_add_u32 s45, s45, s36
    s_cmp_lt_u32 s40, 24
    s_cselect_b32 s75, s44, s45
    s_mul_i32 s39, s37, 3
    s_add_u32 s40, s39, 25
    s_cmp_eq_u32 s37, 0
    s_cselect_b32 s40, 7, s40
    s_mul_i32 s44, s40, 10240
    s_add_u32 s44, s44, s35
    s_lshl_b32 s45, s40, 11
    s_add_u32 s45, s45, s36
    s_cmp_lt_u32 s40, 24
    s_cselect_b32 s76, s44, s45
    s_mul_i32 s39, s37, 3
    s_add_u32 s40, s39, 26
    s_cmp_eq_u32 s37, 0
    s_cselect_b32 s40, 8, s40
    s_mul_i32 s44, s40, 10240
    s_add_u32 s44, s44, s35
    s_lshl_b32 s45, s40, 11
    s_add_u32 s45, s45, s36
    s_cmp_lt_u32 s40, 24
    s_cselect_b32 s77, s44, s45
    s_cmp_lg_u32 s47, 4
    s_cbranch_scc1 p0_kernel_w2a
    s_add_u32 s46, s46, 1
    s_lshr_b32 s34, s41, 1
    s_lshl_b32 s34, s34, 2
    s_add_u32 s34, s34, s46
    s_mul_i32 s34, s34, 737280
    s_and_b32 s44, s3, 1
    s_lshl_b32 s44, s44, 10
    s_add_u32 s34, s34, s44
    s_add_u32 s34, s34, 93059072
    s_lshl_b32 s44, s47, 11
    s_add_u32 s35, s34, s44
    s_mul_i32 s44, s47, 24576
    s_add_u32 s36, s34, s44
    s_add_u32 s36, s36, 196608
    s_and_b32 s37, s41, 1
    s_lshl_b32 s37, s37, 1
    s_add_u32 s37, s37, 0
    s_xor_b32 s37, s37, s46
    s_mul_i32 s39, s37, 3
    s_add_u32 s40, s39, 6
    s_cmp_eq_u32 s37, 0
    s_cselect_b32 s40, 0, s40
    s_mul_i32 s44, s40, 10240
    s_add_u32 s44, s44, s35
    s_lshl_b32 s45, s40, 11
    s_add_u32 s45, s45, s36
    s_cmp_lt_u32 s40, 24
    s_cselect_b32 s78, s44, s45
    s_mul_i32 s39, s37, 3
    s_add_u32 s40, s39, 7
    s_cmp_eq_u32 s37, 0
    s_cselect_b32 s40, 1, s40
    s_mul_i32 s44, s40, 10240
    s_add_u32 s44, s44, s35
    s_lshl_b32 s45, s40, 11
    s_add_u32 s45, s45, s36
    s_cmp_lt_u32 s40, 24
    s_cselect_b32 s79, s44, s45
    s_mul_i32 s39, s37, 3
    s_add_u32 s40, s39, 8
    s_cmp_eq_u32 s37, 0
    s_cselect_b32 s40, 2, s40
    s_mul_i32 s44, s40, 10240
    s_add_u32 s44, s44, s35
    s_lshl_b32 s45, s40, 11
    s_add_u32 s45, s45, s36
    s_cmp_lt_u32 s40, 24
    s_cselect_b32 s80, s44, s45
    s_mul_i32 s39, s37, 3
    s_add_u32 s40, s39, 15
    s_cmp_eq_u32 s37, 0
    s_cselect_b32 s40, 3, s40
    s_mul_i32 s44, s40, 10240
    s_add_u32 s44, s44, s35
    s_lshl_b32 s45, s40, 11
    s_add_u32 s45, s45, s36
    s_cmp_lt_u32 s40, 24
    s_cselect_b32 s81, s44, s45
    s_mul_i32 s39, s37, 3
    s_add_u32 s40, s39, 16
    s_cmp_eq_u32 s37, 0
    s_cselect_b32 s40, 4, s40
    s_mul_i32 s44, s40, 10240
    s_add_u32 s44, s44, s35
    s_lshl_b32 s45, s40, 11
    s_add_u32 s45, s45, s36
    s_cmp_lt_u32 s40, 24
    s_cselect_b32 s82, s44, s45
    s_mul_i32 s39, s37, 3
    s_add_u32 s40, s39, 17
    s_cmp_eq_u32 s37, 0
    s_cselect_b32 s40, 5, s40
    s_mul_i32 s44, s40, 10240
    s_add_u32 s44, s44, s35
    s_lshl_b32 s45, s40, 11
    s_add_u32 s45, s45, s36
    s_cmp_lt_u32 s40, 24
    s_cselect_b32 s83, s44, s45
    s_mul_i32 s39, s37, 3
    s_add_u32 s40, s39, 24
    s_cmp_eq_u32 s37, 0
    s_cselect_b32 s40, 6, s40
    s_mul_i32 s44, s40, 10240
    s_add_u32 s44, s44, s35
    s_lshl_b32 s45, s40, 11
    s_add_u32 s45, s45, s36
    s_cmp_lt_u32 s40, 24
    s_cselect_b32 s84, s44, s45
    s_mul_i32 s39, s37, 3
    s_add_u32 s40, s39, 25
    s_cmp_eq_u32 s37, 0
    s_cselect_b32 s40, 7, s40
    s_mul_i32 s44, s40, 10240
    s_add_u32 s44, s44, s35
    s_lshl_b32 s45, s40, 11
    s_add_u32 s45, s45, s36
    s_cmp_lt_u32 s40, 24
    s_cselect_b32 s85, s44, s45
    s_mul_i32 s39, s37, 3
    s_add_u32 s40, s39, 26
    s_cmp_eq_u32 s37, 0
    s_cselect_b32 s40, 8, s40
    s_mul_i32 s44, s40, 10240
    s_add_u32 s44, s44, s35
    s_lshl_b32 s45, s40, 11
    s_add_u32 s45, s45, s36
    s_cmp_lt_u32 s40, 24
    s_cselect_b32 s86, s44, s45
    s_and_b32 s37, s41, 1
    s_lshl_b32 s37, s37, 1
    s_add_u32 s37, s37, 1
    s_xor_b32 s37, s37, s46
    s_mul_i32 s39, s37, 3
    s_add_u32 s40, s39, 6
    s_cmp_eq_u32 s37, 0
    s_cselect_b32 s40, 0, s40
    s_mul_i32 s44, s40, 10240
    s_add_u32 s44, s44, s35
    s_lshl_b32 s45, s40, 11
    s_add_u32 s45, s45, s36
    s_cmp_lt_u32 s40, 24
    s_cselect_b32 s87, s44, s45
    s_mul_i32 s39, s37, 3
    s_add_u32 s40, s39, 7
    s_cmp_eq_u32 s37, 0
    s_cselect_b32 s40, 1, s40
    s_mul_i32 s44, s40, 10240
    s_add_u32 s44, s44, s35
    s_lshl_b32 s45, s40, 11
    s_add_u32 s45, s45, s36
    s_cmp_lt_u32 s40, 24
    s_cselect_b32 s88, s44, s45
    s_mul_i32 s39, s37, 3
    s_add_u32 s40, s39, 8
    s_cmp_eq_u32 s37, 0
    s_cselect_b32 s40, 2, s40
    s_mul_i32 s44, s40, 10240
    s_add_u32 s44, s44, s35
    s_lshl_b32 s45, s40, 11
    s_add_u32 s45, s45, s36
    s_cmp_lt_u32 s40, 24
    s_cselect_b32 s89, s44, s45
    s_mul_i32 s39, s37, 3
    s_add_u32 s40, s39, 15
    s_cmp_eq_u32 s37, 0
    s_cselect_b32 s40, 3, s40
    s_mul_i32 s44, s40, 10240
    s_add_u32 s44, s44, s35
    s_lshl_b32 s45, s40, 11
    s_add_u32 s45, s45, s36
    s_cmp_lt_u32 s40, 24
    s_cselect_b32 s90, s44, s45
    s_mul_i32 s39, s37, 3
    s_add_u32 s40, s39, 16
    s_cmp_eq_u32 s37, 0
    s_cselect_b32 s40, 4, s40
    s_mul_i32 s44, s40, 10240
    s_add_u32 s44, s44, s35
    s_lshl_b32 s45, s40, 11
    s_add_u32 s45, s45, s36
    s_cmp_lt_u32 s40, 24
    s_cselect_b32 s91, s44, s45
    s_mul_i32 s39, s37, 3
    s_add_u32 s40, s39, 17
    s_cmp_eq_u32 s37, 0
    s_cselect_b32 s40, 5, s40
    s_mul_i32 s44, s40, 10240
    s_add_u32 s44, s44, s35
    s_lshl_b32 s45, s40, 11
    s_add_u32 s45, s45, s36
    s_cmp_lt_u32 s40, 24
    s_cselect_b32 s92, s44, s45
    s_mul_i32 s39, s37, 3
    s_add_u32 s40, s39, 24
    s_cmp_eq_u32 s37, 0
    s_cselect_b32 s40, 6, s40
    s_mul_i32 s44, s40, 10240
    s_add_u32 s44, s44, s35
    s_lshl_b32 s45, s40, 11
    s_add_u32 s45, s45, s36
    s_cmp_lt_u32 s40, 24
    s_cselect_b32 s93, s44, s45
    s_mul_i32 s39, s37, 3
    s_add_u32 s40, s39, 25
    s_cmp_eq_u32 s37, 0
    s_cselect_b32 s40, 7, s40
    s_mul_i32 s44, s40, 10240
    s_add_u32 s44, s44, s35
    s_lshl_b32 s45, s40, 11
    s_add_u32 s45, s45, s36
    s_cmp_lt_u32 s40, 24
    s_cselect_b32 s94, s44, s45
    s_mul_i32 s39, s37, 3
    s_add_u32 s40, s39, 26
    s_cmp_eq_u32 s37, 0
    s_cselect_b32 s40, 8, s40
    s_mul_i32 s44, s40, 10240
    s_add_u32 s44, s44, s35
    s_lshl_b32 s45, s40, 11
    s_add_u32 s45, s45, s36
    s_cmp_lt_u32 s40, 24
    s_cselect_b32 s95, s44, s45
p0_kernel_w2a:
    s_waitcnt vmcnt(15)
    s_barrier
    ds_read_b64_tr_b16 v[16:17], v11 offset:0
    ds_read_b64_tr_b16 v[18:19], v11 offset:2048
    ds_read_b64_tr_b16 v[20:21], v11 offset:4096
    ds_read_b64_tr_b16 v[22:23], v11 offset:6144
    ds_read_b64_tr_b16 v[24:25], v11 offset:8192
    ds_read_b64_tr_b16 v[26:27], v11 offset:10240
    s_waitcnt lgkmcnt(0)
    buffer_store_dwordx4 v[16:19], v3, s[4:7], s60 offen sc1
    buffer_store_dwordx4 v[20:23], v3, s[4:7], s61 offen sc1
    buffer_store_dwordx4 v[24:27], v3, s[4:7], s62 offen sc1
    s_waitcnt vmcnt(15)
    s_barrier
    ds_read_b64_tr_b16 v[28:29], v11 offset:12288
    ds_read_b64_tr_b16 v[30:31], v11 offset:14336
    ds_read_b64_tr_b16 v[32:33], v11 offset:16384
    ds_read_b64_tr_b16 v[34:35], v11 offset:18432
    ds_read_b64_tr_b16 v[36:37], v11 offset:20480
    ds_read_b64_tr_b16 v[38:39], v11 offset:22528
    s_waitcnt lgkmcnt(0)
    buffer_store_dwordx4 v[28:31], v3, s[4:7], s63 offen sc1
    buffer_store_dwordx4 v[32:35], v3, s[4:7], s64 offen sc1
    buffer_store_dwordx4 v[36:39], v3, s[4:7], s65 offen sc1
    s_waitcnt vmcnt(15)
    s_barrier
    ds_read_b64_tr_b16 v[40:41], v11 offset:24576
    ds_read_b64_tr_b16 v[42:43], v11 offset:26624
    ds_read_b64_tr_b16 v[44:45], v11 offset:28672
    ds_read_b64_tr_b16 v[46:47], v11 offset:30720
    ds_read_b64_tr_b16 v[48:49], v11 offset:32768
    ds_read_b64_tr_b16 v[50:51], v11 offset:34816
    s_waitcnt lgkmcnt(0)
    buffer_store_dwordx4 v[40:43], v3, s[4:7], s66 offen sc1
    buffer_store_dwordx4 v[44:47], v3, s[4:7], s67 offen sc1
    buffer_store_dwordx4 v[48:51], v3, s[4:7], s68 offen sc1
    s_waitcnt vmcnt(15)
    s_barrier
    ds_read_b64_tr_b16 v[52:53], v15 offset:0
    ds_read_b64_tr_b16 v[54:55], v15 offset:2048
    ds_read_b64_tr_b16 v[56:57], v15 offset:4096
    ds_read_b64_tr_b16 v[58:59], v15 offset:6144
    ds_read_b64_tr_b16 v[60:61], v15 offset:8192
    ds_read_b64_tr_b16 v[62:63], v15 offset:10240
    s_waitcnt lgkmcnt(0)
    buffer_store_dwordx4 v[52:55], v3, s[4:7], s69 offen sc1
    buffer_store_dwordx4 v[56:59], v3, s[4:7], s70 offen sc1
    buffer_store_dwordx4 v[60:63], v3, s[4:7], s71 offen sc1
    s_waitcnt vmcnt(15)
    s_barrier
    ds_read_b64_tr_b16 v[64:65], v15 offset:12288
    ds_read_b64_tr_b16 v[66:67], v15 offset:14336
    ds_read_b64_tr_b16 v[68:69], v15 offset:16384
    ds_read_b64_tr_b16 v[70:71], v15 offset:18432
    ds_read_b64_tr_b16 v[72:73], v15 offset:20480
    ds_read_b64_tr_b16 v[74:75], v15 offset:22528
    s_waitcnt lgkmcnt(0)
    buffer_store_dwordx4 v[64:67], v3, s[4:7], s72 offen sc1
    buffer_store_dwordx4 v[68:71], v3, s[4:7], s73 offen sc1
    buffer_store_dwordx4 v[72:75], v3, s[4:7], s74 offen sc1
    s_waitcnt vmcnt(15)
    s_barrier
    ds_read_b64_tr_b16 v[76:77], v15 offset:24576
    ds_read_b64_tr_b16 v[78:79], v15 offset:26624
    ds_read_b64_tr_b16 v[80:81], v15 offset:28672
    ds_read_b64_tr_b16 v[82:83], v15 offset:30720
    ds_read_b64_tr_b16 v[84:85], v15 offset:32768
    ds_read_b64_tr_b16 v[86:87], v15 offset:34816
    s_waitcnt lgkmcnt(0)
    buffer_store_dwordx4 v[76:79], v3, s[4:7], s75 offen sc1
    buffer_store_dwordx4 v[80:83], v3, s[4:7], s76 offen sc1
    buffer_store_dwordx4 v[84:87], v3, s[4:7], s77 offen sc1
    s_cmp_lg_u32 s47, 4
    s_nop 0
    s_cbranch_scc1 p0_kernel_w2d
    buffer_store_dwordx4 v[16:19], v3, s[4:7], s78 offen sc1
    buffer_store_dwordx4 v[20:23], v3, s[4:7], s79 offen sc1
    buffer_store_dwordx4 v[24:27], v3, s[4:7], s80 offen sc1
    buffer_store_dwordx4 v[28:31], v3, s[4:7], s81 offen sc1
    buffer_store_dwordx4 v[32:35], v3, s[4:7], s82 offen sc1
    buffer_store_dwordx4 v[36:39], v3, s[4:7], s83 offen sc1
    buffer_store_dwordx4 v[40:43], v3, s[4:7], s84 offen sc1
    buffer_store_dwordx4 v[44:47], v3, s[4:7], s85 offen sc1
    buffer_store_dwordx4 v[48:51], v3, s[4:7], s86 offen sc1
    buffer_store_dwordx4 v[52:55], v3, s[4:7], s87 offen sc1
    buffer_store_dwordx4 v[56:59], v3, s[4:7], s88 offen sc1
    buffer_store_dwordx4 v[60:63], v3, s[4:7], s89 offen sc1
    buffer_store_dwordx4 v[64:67], v3, s[4:7], s90 offen sc1
    buffer_store_dwordx4 v[68:71], v3, s[4:7], s91 offen sc1
    buffer_store_dwordx4 v[72:75], v3, s[4:7], s92 offen sc1
    buffer_store_dwordx4 v[76:79], v3, s[4:7], s93 offen sc1
    buffer_store_dwordx4 v[80:83], v3, s[4:7], s94 offen sc1
    buffer_store_dwordx4 v[84:87], v3, s[4:7], s95 offen sc1
    s_nop 1
p0_kernel_w2d:
    s_endpgm
p0_kernel_wo:
    s_mov_b32 s12, s20
    s_and_b32 s13, s21, 0xffff
    s_mov_b32 s14, 663552
    s_mov_b32 s15, 0x00020000
    s_sub_u32 s41, s2, 198
    s_lshl_b32 s44, s3, 3
    v_add_u32 v12, s44, v6
    v_lshrrev_b32 v13, 4, v12
    v_mul_u32_u24 v13, 18, v13
    v_and_b32 v14, 15, v12
    v_add_u32 v13, v13, v14
    v_lshrrev_b32 v14, 2, v12
    v_mul_u32_u24 v14, 36, v14
    v_and_b32 v15, 3, v12
    v_lshrrev_b32 v2, 1, v15
    v_lshlrev_b32 v2, 4, v2
    v_add3_u32 v14, v14, v15, v2
    v_add_u32 v14, 16, v14
    s_mul_i32 s32, s41, 36
    s_sub_u32 s33, s41, 16
    s_mul_i32 s33, s33, 288
    s_cmp_lt_u32 s41, 16
    s_cselect_b32 s32, s32, s33
    s_cselect_b64 vcc, -1, 0
    v_cndmask_b32 v13, v14, v13, vcc
    s_mul_i32 s32, s32, 1152
    v_mul_u32_u24 v8, 1152, v13
    v_lshl_add_u32 v8, v7, 4, v8
    s_lshl_b32 s44, s3, 10
    s_mov_b32 m0, s44
    s_nop 0
    buffer_load_dwordx4 v8, s[12:15], s32 offen nt lds
    s_add_u32 s32, s32, 128
    s_add_u32 m0, m0, 4096
    s_nop 0
    buffer_load_dwordx4 v8, s[12:15], s32 offen nt lds
    s_add_u32 s32, s32, 128
    s_add_u32 m0, m0, 4096
    s_nop 0
    buffer_load_dwordx4 v8, s[12:15], s32 offen nt lds
    s_add_u32 s32, s32, 128
    s_add_u32 m0, m0, 4096
    s_nop 0
    buffer_load_dwordx4 v8, s[12:15], s32 offen nt lds
    s_add_u32 s32, s32, 128
    s_add_u32 m0, m0, 4096
    s_nop 0
    buffer_load_dwordx4 v8, s[12:15], s32 offen nt lds
    s_add_u32 s32, s32, 128
    s_add_u32 m0, m0, 4096
    s_nop 0
    buffer_load_dwordx4 v8, s[12:15], s32 offen nt lds
    s_add_u32 s32, s32, 128
    s_add_u32 m0, m0, 4096
    s_nop 0
    buffer_load_dwordx4 v8, s[12:15], s32 offen nt lds
    s_add_u32 s32, s32, 128
    s_add_u32 m0, m0, 4096
    s_nop 0
    buffer_load_dwordx4 v8, s[12:15], s32 offen nt lds
    s_add_u32 s32, s32, 128
    s_add_u32 m0, m0, 4096
    s_nop 0
    buffer_load_dwordx4 v8, s[12:15], s32 offen nt lds
    s_add_u32 s32, s32, 128
    s_add_u32 m0, m0, 4096
    s_mul_i32 s34, s3, 18432
    s_lshl_b32 s44, s41, 10
    s_add_u32 s34, s34, s44
    s_add_u32 s34, s34, 92045312
    s_waitcnt vmcnt(0)
    s_barrier
    ds_read_b64_tr_b16 v[16:17], v11 offset:0
    ds_read_b64_tr_b16 v[18:19], v11 offset:2048
    ds_read_b64_tr_b16 v[20:21], v11 offset:4096
    ds_read_b64_tr_b16 v[22:23], v11 offset:6144
    ds_read_b64_tr_b16 v[24:25], v11 offset:8192
    ds_read_b64_tr_b16 v[26:27], v11 offset:10240
    ds_read_b64_tr_b16 v[28:29], v11 offset:12288
    ds_read_b64_tr_b16 v[30:31], v11 offset:14336
    ds_read_b64_tr_b16 v[32:33], v11 offset:16384
    ds_read_b64_tr_b16 v[34:35], v11 offset:18432
    ds_read_b64_tr_b16 v[36:37], v11 offset:20480
    ds_read_b64_tr_b16 v[38:39], v11 offset:22528
    ds_read_b64_tr_b16 v[40:41], v11 offset:24576
    ds_read_b64_tr_b16 v[42:43], v11 offset:26624
    s_waitcnt lgkmcnt(0)
    ds_read_b64_tr_b16 v[44:45], v11 offset:28672
    ds_read_b64_tr_b16 v[46:47], v11 offset:30720
    ds_read_b64_tr_b16 v[48:49], v11 offset:32768
    ds_read_b64_tr_b16 v[50:51], v11 offset:34816
    s_waitcnt lgkmcnt(0)
    buffer_store_dwordx4 v[16:19], v3, s[4:7], s34 offen sc1
    s_add_u32 s34, s34, 73728
    buffer_store_dwordx4 v[20:23], v3, s[4:7], s34 offen sc1
    s_add_u32 s34, s34, 73728
    buffer_store_dwordx4 v[24:27], v3, s[4:7], s34 offen sc1
    s_add_u32 s34, s34, 73728
    buffer_store_dwordx4 v[28:31], v3, s[4:7], s34 offen sc1
    s_add_u32 s34, s34, 73728
    buffer_store_dwordx4 v[32:35], v3, s[4:7], s34 offen sc1
    s_add_u32 s34, s34, 73728
    buffer_store_dwordx4 v[36:39], v3, s[4:7], s34 offen sc1
    s_add_u32 s34, s34, 73728
    buffer_store_dwordx4 v[40:43], v3, s[4:7], s34 offen sc1
    s_add_u32 s34, s34, 73728
    buffer_store_dwordx4 v[44:47], v3, s[4:7], s34 offen sc1
    s_add_u32 s34, s34, 73728
    buffer_store_dwordx4 v[48:51], v3, s[4:7], s34 offen sc1
    s_add_u32 s34, s34, 73728
    s_endpgm
p0_kernel_wq:
    s_mov_b32 s12, s18
    s_and_b32 s13, s19, 0xffff
    s_mov_b32 s14, 1990656
    s_mov_b32 s15, 0x00020000
    s_sub_u32 s41, s2, 144
    s_mul_i32 s42, s41, 43691
    s_lshr_b32 s42, s42, 17
    s_mul_i32 s43, s42, 3
    s_sub_u32 s43, s41, s43
    s_mul_i32 s32, s42, 110592
    s_mul_i32 s44, s43, 1152
    s_add_u32 s32, s32, s44
    s_mul_i32 s44, s3, 27648
    s_add_u32 s32, s32, s44
    s_add_u32 s33, s32, 32
    v_lshrrev_b32 v8, 1, v1
    v_mul_u32_u24 v8, 36, v8
    v_and_b32 v12, 1, v1
    v_lshl_add_u32 v8, v12, 4, v8
    v_and_b32 v12, 31, v1
    v_mul_u32_u24 v12, 36, v12
    v_lshrrev_b32 v13, 5, v1
    v_mul_u32_u24 v13, 3456, v13
    v_add_u32 v12, v12, v13
    s_lshl_b32 s44, s3, 13
    s_mov_b32 m0, s44
    s_nop 0
    buffer_load_dwordx4 v8, s[12:15], s32 offen nt lds
    s_add_u32 s32, s32, 3456
    s_add_u32 m0, m0, 1024
    s_nop 0
    buffer_load_dwordx4 v8, s[12:15], s32 offen nt lds
    s_add_u32 s32, s32, 3456
    s_add_u32 m0, m0, 1024
    s_nop 0
    buffer_load_dwordx4 v8, s[12:15], s32 offen nt lds
    s_add_u32 s32, s32, 3456
    s_add_u32 m0, m0, 1024
    s_nop 0
    buffer_load_dwordx4 v8, s[12:15], s32 offen nt lds
    s_add_u32 s32, s32, 3456
    s_add_u32 m0, m0, 1024
    s_nop 0
    buffer_load_dwordx4 v8, s[12:15], s32 offen nt lds
    s_add_u32 s32, s32, 3456
    s_add_u32 m0, m0, 1024
    s_nop 0
    buffer_load_dwordx4 v8, s[12:15], s32 offen nt lds
    s_add_u32 s32, s32, 3456
    s_add_u32 m0, m0, 1024
    s_nop 0
    buffer_load_dwordx4 v8, s[12:15], s32 offen nt lds
    s_add_u32 s32, s32, 3456
    s_add_u32 m0, m0, 1024
    s_nop 0
    buffer_load_dwordx4 v8, s[12:15], s32 offen nt lds
    s_add_u32 s32, s32, 3456
    s_add_u32 m0, m0, 1024
    s_lshl_b32 s44, s3, 10
    s_add_u32 m0, s44, 32768
    s_nop 0
    buffer_load_dword v12, s[12:15], s33 offen nt lds
    s_add_u32 s33, s33, 6912
    s_add_u32 m0, m0, 256
    s_nop 0
    buffer_load_dword v12, s[12:15], s33 offen nt lds
    s_add_u32 s33, s33, 6912
    s_add_u32 m0, m0, 256
    s_nop 0
    buffer_load_dword v12, s[12:15], s33 offen nt lds
    s_add_u32 s33, s33, 6912
    s_add_u32 m0, m0, 256
    s_nop 0
    buffer_load_dword v12, s[12:15], s33 offen nt lds
    s_add_u32 s33, s33, 6912
    s_add_u32 m0, m0, 256
    v_lshrrev_b32 v13, 2, v1
    v_lshlrev_b32 v13, 10, v13
    v_and_b32 v14, 3, v1
    v_lshl_add_u32 v13, v14, 3, v13
    s_lshl_b32 s44, s3, 8
    v_add_u32 v13, s44, v13
    s_mul_i32 s34, s3, 516096
    s_mul_i32 s44, s42, 7168
    s_add_u32 s34, s34, s44
    s_add_u32 s35, s34, 89987072
    s_lshl_b32 s44, s43, 11
    s_add_u32 s34, s34, s44
    s_add_u32 s34, s34, 89980928
    v_lshrrev_b32 v14, 2, v4
    s_mov_b32 s44, 129024
    v_mul_lo_u32 v14, v14, s44
    v_lshrrev_b32 v15, 1, v4
    v_and_b32 v15, 1, v15
    s_cmp_eq_u32 s43, 2
    s_cselect_b32 s44, 1, 2
    s_lshl_b32 s45, s43, 1
    s_cmp_eq_u32 s43, 2
    s_cselect_b32 s45, 8, s45
    v_lshlrev_b32 v15, s44, v15
    v_and_b32 v2, 1, v4
    v_add3_u32 v15, v15, v2, s45
    v_lshl_add_u32 v15, v5, 4, v15
    v_lshl_add_u32 v14, v15, 4, v14
    s_waitcnt vmcnt(0)
    s_barrier
    ds_read_b64_tr_b16 v[16:17], v13 offset:0
    ds_read_b64_tr_b16 v[18:19], v13 offset:16384
    ds_read_b64_tr_b16 v[20:21], v13 offset:32
    ds_read_b64_tr_b16 v[22:23], v13 offset:16416
    ds_read_b64_tr_b16 v[24:25], v13 offset:64
    ds_read_b64_tr_b16 v[26:27], v13 offset:16448
    ds_read_b64_tr_b16 v[28:29], v13 offset:96
    ds_read_b64_tr_b16 v[30:31], v13 offset:16480
    ds_read_b64_tr_b16 v[32:33], v13 offset:128
    ds_read_b64_tr_b16 v[34:35], v13 offset:16512
    ds_read_b64_tr_b16 v[36:37], v13 offset:160
    ds_read_b64_tr_b16 v[38:39], v13 offset:16544
    ds_read_b64_tr_b16 v[40:41], v13 offset:192
    ds_read_b64_tr_b16 v[42:43], v13 offset:16576
    s_waitcnt lgkmcnt(0)
    ds_read_b64_tr_b16 v[44:45], v13 offset:224
    ds_read_b64_tr_b16 v[46:47], v13 offset:16608
    ds_read_b64_tr_b16 v[48:49], v11 offset:32768
    ds_read_b64_tr_b16 v[50:51], v11 offset:34816
    v_mov_b32 v52, 0
    v_mov_b32 v53, 0
    v_mov_b32 v54, 0
    v_mov_b32 v55, 0
    s_waitcnt lgkmcnt(0)
    buffer_store_dwordx4 v[16:19], v3, s[4:7], s34 offen offset:0 sc1
    buffer_store_dwordx4 v[20:23], v3, s[4:7], s34 offen offset:1024 sc1
    s_add_u32 s34, s34, 129024
    buffer_store_dwordx4 v[24:27], v3, s[4:7], s34 offen offset:0 sc1
    buffer_store_dwordx4 v[28:31], v3, s[4:7], s34 offen offset:1024 sc1
    s_add_u32 s34, s34, 129024
    buffer_store_dwordx4 v[32:35], v3, s[4:7], s34 offen offset:0 sc1
    buffer_store_dwordx4 v[36:39], v3, s[4:7], s34 offen offset:1024 sc1
    s_add_u32 s34, s34, 129024
    buffer_store_dwordx4 v[40:43], v3, s[4:7], s34 offen offset:0 sc1
    buffer_store_dwordx4 v[44:47], v3, s[4:7], s34 offen offset:1024 sc1
    s_add_u32 s34, s34, 129024
    buffer_store_dwordx4 v[48:51], v14, s[4:7], s35 offen
    s_cmp_eq_u32 s43, 2
    s_cselect_b32 s35, s35, 268435456
    buffer_store_dwordx4 v[52:55], v14, s[4:7], s35 offen offset:64
    s_endpgm
    s_nop 0
p0_kernel_x:
    s_mov_b32 s12, s16
    s_and_b32 s13, s17, 0xffff
    s_mov_b32 s14, 2359296
    s_mov_b32 s15, 0x00020000
    s_sub_u32 s41, s2, 216
    s_lshl_b32 s41, s41, 2
    s_add_u32 s41, s41, s3
    s_mul_i32 s33, s41, 18432
    s_add_u32 s34, s33, 32768
    s_mov_b32 m0, s40
    s_nop 0
    buffer_load_dwordx4 v3, s[12:15], s33 offen offset:0 nt lds
    buffer_load_dwordx4 v3, s[12:15], s33 offen offset:1024 nt lds
    buffer_load_dwordx4 v3, s[12:15], s33 offen offset:2048 nt lds
    s_add_u32 s33, s33, 3072
    s_add_u32 m0, m0, 3072
    s_nop 0
    buffer_load_dwordx4 v3, s[12:15], s33 offen offset:0 nt lds
    buffer_load_dwordx4 v3, s[12:15], s33 offen offset:1024 nt lds
    buffer_load_dwordx4 v3, s[12:15], s33 offen offset:2048 nt lds
    s_add_u32 s33, s33, 3072
    s_add_u32 m0, m0, 3072
    s_nop 0
    buffer_load_dwordx4 v3, s[12:15], s33 offen offset:0 nt lds
    buffer_load_dwordx4 v3, s[12:15], s33 offen offset:1024 nt lds
    buffer_load_dwordx4 v3, s[12:15], s33 offen offset:2048 nt lds
    s_add_u32 s33, s33, 3072
    s_add_u32 m0, m0, 3072
    s_nop 0
    buffer_load_dwordx4 v3, s[12:15], s33 offen offset:0 nt lds
    buffer_load_dwordx4 v3, s[12:15], s33 offen offset:1024 nt lds
    buffer_load_dwordx4 v3, s[12:15], s33 offen offset:2048 nt lds
    s_add_u32 s33, s33, 3072
    s_add_u32 m0, m0, 3072
    s_nop 0
    buffer_load_dwordx4 v3, s[12:15], s33 offen offset:0 nt lds
    buffer_load_dwordx4 v3, s[12:15], s33 offen offset:1024 nt lds
    buffer_load_dwordx4 v3, s[12:15], s33 offen offset:2048 nt lds
    s_add_u32 s33, s33, 3072
    s_add_u32 m0, m0, 3072
    s_nop 0
    buffer_load_dwordx4 v3, s[12:15], s33 offen offset:0 nt lds
    buffer_load_dwordx4 v3, s[12:15], s33 offen offset:1024 nt lds
    buffer_load_dwordx4 v3, s[12:15], s33 offen offset:2048 nt lds
    s_add_u32 s33, s33, 3072
    s_add_u32 m0, m0, 3072
    v_mul_u32_u24 v8, 1152, v4
    v_lshl_add_u32 v8, v5, 3, v8
    v_add_u32 v8, s40, v8
    v_mov_b32 v12, 0x3f803f80
    v_mov_b32 v14, 0
    v_mov_b32 v15, 0
    s_waitcnt vmcnt(0)
    ds_read_b64 v[16:17], v8 offset:0
    ds_read_b64 v[18:19], v8 offset:32
    ds_read_b64 v[20:21], v8 offset:64
    ds_read_b64 v[22:23], v8 offset:96
    ds_read_b64 v[24:25], v8 offset:128
    ds_read_b64 v[26:27], v8 offset:160
    ds_read_b64 v[28:29], v8 offset:192
    ds_read_b64 v[30:31], v8 offset:224
    ds_read_b64 v[32:33], v8 offset:256
    ds_read_b64 v[34:35], v8 offset:288
    ds_read_b64 v[36:37], v8 offset:320
    ds_read_b64 v[38:39], v8 offset:352
    s_waitcnt lgkmcnt(0)
    buffer_store_dwordx4 v[16:19], v3, s[4:7], s34 offen sc1
    s_add_u32 s34, s34, 1024
    buffer_store_dwordx4 v[20:23], v3, s[4:7], s34 offen sc1
    s_add_u32 s34, s34, 1024
    buffer_store_dwordx4 v[24:27], v3, s[4:7], s34 offen sc1
    s_add_u32 s34, s34, 1024
    buffer_store_dwordx4 v[28:31], v3, s[4:7], s34 offen sc1
    s_add_u32 s34, s34, 1024
    buffer_store_dwordx4 v[32:35], v3, s[4:7], s34 offen sc1
    s_add_u32 s34, s34, 1024
    buffer_store_dwordx4 v[36:39], v3, s[4:7], s34 offen sc1
    s_add_u32 s34, s34, 1024
    ds_read_b64 v[40:41], v8 offset:384
    ds_read_b64 v[42:43], v8 offset:416
    ds_read_b64 v[44:45], v8 offset:448
    ds_read_b64 v[46:47], v8 offset:480
    ds_read_b64 v[48:49], v8 offset:512
    ds_read_b64 v[50:51], v8 offset:544
    ds_read_b64 v[52:53], v8 offset:576
    ds_read_b64 v[54:55], v8 offset:608
    ds_read_b64 v[56:57], v8 offset:640
    ds_read_b64 v[58:59], v8 offset:672
    ds_read_b64 v[60:61], v8 offset:704
    ds_read_b64 v[62:63], v8 offset:736
    s_waitcnt lgkmcnt(0)
    buffer_store_dwordx4 v[40:43], v3, s[4:7], s34 offen sc1
    s_add_u32 s34, s34, 1024
    buffer_store_dwordx4 v[44:47], v3, s[4:7], s34 offen sc1
    s_add_u32 s34, s34, 1024
    buffer_store_dwordx4 v[48:51], v3, s[4:7], s34 offen sc1
    s_add_u32 s34, s34, 1024
    buffer_store_dwordx4 v[52:55], v3, s[4:7], s34 offen sc1
    s_add_u32 s34, s34, 1024
    buffer_store_dwordx4 v[56:59], v3, s[4:7], s34 offen sc1
    s_add_u32 s34, s34, 1024
    buffer_store_dwordx4 v[60:63], v3, s[4:7], s34 offen sc1
    s_add_u32 s34, s34, 1024
    ds_read_b64 v[64:65], v8 offset:768
    ds_read_b64 v[66:67], v8 offset:800
    ds_read_b64 v[68:69], v8 offset:832
    ds_read_b64 v[70:71], v8 offset:864
    ds_read_b64 v[72:73], v8 offset:896
    ds_read_b64 v[74:75], v8 offset:928
    ds_read_b64 v[76:77], v8 offset:960
    ds_read_b64 v[78:79], v8 offset:992
    ds_read_b64 v[80:81], v8 offset:1024
    ds_read_b64 v[82:83], v8 offset:1056
    ds_read_b64 v[84:85], v8 offset:1088
    ds_read_b64 v[86:87], v8 offset:1120
    s_waitcnt lgkmcnt(0)
    buffer_store_dwordx4 v[64:67], v3, s[4:7], s34 offen sc1
    s_add_u32 s34, s34, 1024
    buffer_store_dwordx4 v[68:71], v3, s[4:7], s34 offen sc1
    s_add_u32 s34, s34, 1024
    buffer_store_dwordx4 v[72:75], v3, s[4:7], s34 offen sc1
    s_add_u32 s34, s34, 1024
    buffer_store_dwordx4 v[76:79], v3, s[4:7], s34 offen sc1
    s_add_u32 s34, s34, 1024
    buffer_store_dwordx4 v[80:83], v3, s[4:7], s34 offen sc1
    s_add_u32 s34, s34, 1024
    buffer_store_dwordx4 v[84:87], v3, s[4:7], s34 offen sc1
    s_add_u32 s34, s34, 1024
    v_dot2c_f32_bf16 v14, v16, v12
    v_dot2c_f32_bf16 v15, v16, v16
    v_dot2c_f32_bf16 v14, v17, v12
    v_dot2c_f32_bf16 v15, v17, v17
    v_dot2c_f32_bf16 v14, v18, v12
    v_dot2c_f32_bf16 v15, v18, v18
    v_dot2c_f32_bf16 v14, v19, v12
    v_dot2c_f32_bf16 v15, v19, v19
    v_dot2c_f32_bf16 v14, v20, v12
    v_dot2c_f32_bf16 v15, v20, v20
    v_dot2c_f32_bf16 v14, v21, v12
    v_dot2c_f32_bf16 v15, v21, v21
    v_dot2c_f32_bf16 v14, v22, v12
    v_dot2c_f32_bf16 v15, v22, v22
    v_dot2c_f32_bf16 v14, v23, v12
    v_dot2c_f32_bf16 v15, v23, v23
    v_dot2c_f32_bf16 v14, v24, v12
    v_dot2c_f32_bf16 v15, v24, v24
    v_dot2c_f32_bf16 v14, v25, v12
    v_dot2c_f32_bf16 v15, v25, v25
    v_dot2c_f32_bf16 v14, v26, v12
    v_dot2c_f32_bf16 v15, v26, v26
    v_dot2c_f32_bf16 v14, v27, v12
    v_dot2c_f32_bf16 v15, v27, v27
    v_dot2c_f32_bf16 v14, v28, v12
    v_dot2c_f32_bf16 v15, v28, v28
    v_dot2c_f32_bf16 v14, v29, v12
    v_dot2c_f32_bf16 v15, v29, v29
    v_dot2c_f32_bf16 v14, v30, v12
    v_dot2c_f32_bf16 v15, v30, v30
    v_dot2c_f32_bf16 v14, v31, v12
    v_dot2c_f32_bf16 v15, v31, v31
    v_dot2c_f32_bf16 v14, v32, v12
    v_dot2c_f32_bf16 v15, v32, v32
    v_dot2c_f32_bf16 v14, v33, v12
    v_dot2c_f32_bf16 v15, v33, v33
    v_dot2c_f32_bf16 v14, v34, v12
    v_dot2c_f32_bf16 v15, v34, v34
    v_dot2c_f32_bf16 v14, v35, v12
    v_dot2c_f32_bf16 v15, v35, v35
    v_dot2c_f32_bf16 v14, v36, v12
    v_dot2c_f32_bf16 v15, v36, v36
    v_dot2c_f32_bf16 v14, v37, v12
    v_dot2c_f32_bf16 v15, v37, v37
    v_dot2c_f32_bf16 v14, v38, v12
    v_dot2c_f32_bf16 v15, v38, v38
    v_dot2c_f32_bf16 v14, v39, v12
    v_dot2c_f32_bf16 v15, v39, v39
    v_dot2c_f32_bf16 v14, v40, v12
    v_dot2c_f32_bf16 v15, v40, v40
    v_dot2c_f32_bf16 v14, v41, v12
    v_dot2c_f32_bf16 v15, v41, v41
    v_dot2c_f32_bf16 v14, v42, v12
    v_dot2c_f32_bf16 v15, v42, v42
    v_dot2c_f32_bf16 v14, v43, v12
    v_dot2c_f32_bf16 v15, v43, v43
    v_dot2c_f32_bf16 v14, v44, v12
    v_dot2c_f32_bf16 v15, v44, v44
    v_dot2c_f32_bf16 v14, v45, v12
    v_dot2c_f32_bf16 v15, v45, v45
    v_dot2c_f32_bf16 v14, v46, v12
    v_dot2c_f32_bf16 v15, v46, v46
    v_dot2c_f32_bf16 v14, v47, v12
    v_dot2c_f32_bf16 v15, v47, v47
    v_dot2c_f32_bf16 v14, v48, v12
    v_dot2c_f32_bf16 v15, v48, v48
    v_dot2c_f32_bf16 v14, v49, v12
    v_dot2c_f32_bf16 v15, v49, v49
    v_dot2c_f32_bf16 v14, v50, v12
    v_dot2c_f32_bf16 v15, v50, v50
    v_dot2c_f32_bf16 v14, v51, v12
    v_dot2c_f32_bf16 v15, v51, v51
    v_dot2c_f32_bf16 v14, v52, v12
    v_dot2c_f32_bf16 v15, v52, v52
    v_dot2c_f32_bf16 v14, v53, v12
    v_dot2c_f32_bf16 v15, v53, v53
    v_dot2c_f32_bf16 v14, v54, v12
    v_dot2c_f32_bf16 v15, v54, v54
    v_dot2c_f32_bf16 v14, v55, v12
    v_dot2c_f32_bf16 v15, v55, v55
    v_dot2c_f32_bf16 v14, v56, v12
    v_dot2c_f32_bf16 v15, v56, v56
    v_dot2c_f32_bf16 v14, v57, v12
    v_dot2c_f32_bf16 v15, v57, v57
    v_dot2c_f32_bf16 v14, v58, v12
    v_dot2c_f32_bf16 v15, v58, v58
    v_dot2c_f32_bf16 v14, v59, v12
    v_dot2c_f32_bf16 v15, v59, v59
    v_dot2c_f32_bf16 v14, v60, v12
    v_dot2c_f32_bf16 v15, v60, v60
    v_dot2c_f32_bf16 v14, v61, v12
    v_dot2c_f32_bf16 v15, v61, v61
    v_dot2c_f32_bf16 v14, v62, v12
    v_dot2c_f32_bf16 v15, v62, v62
    v_dot2c_f32_bf16 v14, v63, v12
    v_dot2c_f32_bf16 v15, v63, v63
    v_dot2c_f32_bf16 v14, v64, v12
    v_dot2c_f32_bf16 v15, v64, v64
    v_dot2c_f32_bf16 v14, v65, v12
    v_dot2c_f32_bf16 v15, v65, v65
    v_dot2c_f32_bf16 v14, v66, v12
    v_dot2c_f32_bf16 v15, v66, v66
    v_dot2c_f32_bf16 v14, v67, v12
    v_dot2c_f32_bf16 v15, v67, v67
    v_dot2c_f32_bf16 v14, v68, v12
    v_dot2c_f32_bf16 v15, v68, v68
    v_dot2c_f32_bf16 v14, v69, v12
    v_dot2c_f32_bf16 v15, v69, v69
    v_dot2c_f32_bf16 v14, v70, v12
    v_dot2c_f32_bf16 v15, v70, v70
    v_dot2c_f32_bf16 v14, v71, v12
    v_dot2c_f32_bf16 v15, v71, v71
    v_dot2c_f32_bf16 v14, v72, v12
    v_dot2c_f32_bf16 v15, v72, v72
    v_dot2c_f32_bf16 v14, v73, v12
    v_dot2c_f32_bf16 v15, v73, v73
    v_dot2c_f32_bf16 v14, v74, v12
    v_dot2c_f32_bf16 v15, v74, v74
    v_dot2c_f32_bf16 v14, v75, v12
    v_dot2c_f32_bf16 v15, v75, v75
    v_dot2c_f32_bf16 v14, v76, v12
    v_dot2c_f32_bf16 v15, v76, v76
    v_dot2c_f32_bf16 v14, v77, v12
    v_dot2c_f32_bf16 v15, v77, v77
    v_dot2c_f32_bf16 v14, v78, v12
    v_dot2c_f32_bf16 v15, v78, v78
    v_dot2c_f32_bf16 v14, v79, v12
    v_dot2c_f32_bf16 v15, v79, v79
    v_dot2c_f32_bf16 v14, v80, v12
    v_dot2c_f32_bf16 v15, v80, v80
    v_dot2c_f32_bf16 v14, v81, v12
    v_dot2c_f32_bf16 v15, v81, v81
    v_dot2c_f32_bf16 v14, v82, v12
    v_dot2c_f32_bf16 v15, v82, v82
    v_dot2c_f32_bf16 v14, v83, v12
    v_dot2c_f32_bf16 v15, v83, v83
    v_dot2c_f32_bf16 v14, v84, v12
    v_dot2c_f32_bf16 v15, v84, v84
    v_dot2c_f32_bf16 v14, v85, v12
    v_dot2c_f32_bf16 v15, v85, v85
    v_dot2c_f32_bf16 v14, v86, v12
    v_dot2c_f32_bf16 v15, v86, v86
    v_dot2c_f32_bf16 v14, v87, v12
    v_dot2c_f32_bf16 v15, v87, v87
    v_lshlrev_b32 v9, 3, v1
    s_lshl_b32 s36, s41, 9
    s_add_u32 s36, s36, 2392064
    buffer_store_dwordx2 v[14:15], v9, s[4:7], s36 offen
p0_kernel_end:
    s_endpgm

.globl main_kernel
.p2align 8
.type main_kernel,@function
main_kernel:
    s_cmp_ge_u32 s2, 256
    s_cbranch_scc1 main_kernel_end
    s_load_dwordx2 s[4:5], s[0:1], 80
    s_mov_b32 s59, 0
    s_mov_b32 s57, 0
    v_and_b32 v1, 63, v0
    v_lshrrev_b32 v2, 6, v0
    s_nop 0
    v_readfirstlane_b32 s3, v2
    v_lshlrev_b32 v3, 4, v1
    s_and_b32 s12, s2, 7
    s_lshr_b32 s13, s2, 3
    s_lshr_b32 s8, s12, 2
    s_lshl_b32 s8, s8, 3
    s_lshr_b32 s14, s13, 2
    s_add_u32 s8, s8, s14
    s_and_b32 s9, s12, 3
    s_lshl_b32 s9, s9, 2
    s_and_b32 s14, s13, 3
    s_add_u32 s9, s9, s14
    s_lshl_b32 s10, s8, 7
    s_add_u32 s10, s10, 16384
    s_sub_u32 s11, s10, 128
    s_cmp_eq_u32 s8, 0
    s_cselect_b32 s11, s10, s11
    s_sub_u32 s12, s10, s11
    v_mov_b32 v254, s12
    v_cmp_eq_u32 vcc, 0, v1
    s_nop 1
    v_cndmask_b32 v254, 0, v254, vcc
    s_getpc_b64 s[98:99]
main_kernel_pc:
    s_lshl_b32 s12, s13, 2
    s_add_u32 s12, s12, s3
    s_lshl_b32 s12, s12, 7
    s_add_u32 s98, s98, s12
    s_addc_u32 s99, s99, 0
    s_lshr_b32 s12, s9, 1
    s_lshl_b32 s12, s12, 7
    s_add_u32 s12, s12, 18496
    s_sub_u32 s12, s12, s11
    v_writelane_b32 v254, s12, 2
    s_waitcnt lgkmcnt(0)
    s_and_b32 s5, s5, 0xffff
    s_mov_b32 s6, 201326592
    s_mov_b32 s7, 0x00020000
main_kernel_p1a:
    v_and_b32 v4, 15, v1
    v_lshrrev_b32 v5, 4, v1
    s_lshl_b32 s16, s8, 3
    s_lshl_b32 s17, s3, 1
    s_add_u32 s17, s17, s16
    s_mul_i32 s18, s17, 18432
    s_add_u32 s18, s18, 32768
    s_mul_i32 s22, s16, 18432
    s_add_u32 s22, s22, 14336
    s_cmp_eq_u32 s8, 0
    s_cselect_b32 s22, 268435456, s22
    s_lshl_b32 s25, s17, 9
    s_add_u32 s25, s25, 2392064
    s_lshl_b32 s26, s16, 9
    s_add_u32 s26, s26, 2391552
    s_cmp_eq_u32 s8, 0
    s_cselect_b32 s26, 268435456, s26
    s_sub_u32 s23, s25, 512
    s_cmp_eq_u32 s17, 0
    s_cselect_b32 s23, 268435456, s23
    s_lshl_b32 s27, s3, 2
    s_lshr_b32 s28, 0x1654, s27
    s_and_b32 s28, s28, 15
    s_lshr_b32 s27, 0x0632, s27
    s_and_b32 s27, s27, 15
    v_lshlrev_b32 v6, 3, v1
    v_lshlrev_b32 v7, 4, v5
    v_lshlrev_b32 v8, 2, v4
    v_add_u32 v15, 18432, v3
    s_mul_i32 s20, s9, 129024
    s_lshl_b32 s21, s3, 11
    s_add_u32 s20, s20, s21
    s_add_u32 s20, s20, 89980928
    s_sub_u32 s20, s20, s59
    s_sub_u32 s22, s22, 1024
    s_mov_b32 s52, 7168
    s_mov_b32 s44, 0xfffefffe
    s_cmp_eq_u32 s3, 3
    s_cselect_b32 s22, s22, s20
    s_cselect_b32 s52, 1024, s52
    s_cselect_b32 s44, s44, -1
    s_mov_b32 s45, s44
    s_mov_b32 s24, s21
    buffer_load_dwordx2 v[200:201], v6, s[4:7], s25 offen offset:0 sc1
    buffer_load_dwordx2 v[202:203], v6, s[4:7], s25 offen offset:512 sc1
    buffer_load_dwordx2 v[204:205], v6, s[4:7], s26 offen offset:0 sc1
    buffer_load_dwordx2 v[206:207], v6, s[4:7], s23 offen offset:0 sc1
    s_mov_b32 m0, s24
    s_add_u32 s24, s24, 8192
    buffer_load_dwordx4 v3, s[4:7], s20 offen lds
    s_add_u32 s20, s20, 7168
    s_mov_b64 exec, s[44:45]
    buffer_load_dwordx4 v3, s[4:7], s22 offen offset:1024 lds
    s_mov_b64 exec, -1
    s_add_u32 s22, s22, s52
    buffer_load_dwordx4 a[0:3], v3, s[4:7], s18 offen offset:0 sc1
    buffer_load_dwordx4 a[72:75], v15, s[4:7], s18 offen offset:0 sc1
    s_mov_b32 m0, s24
    s_add_u32 s24, s24, 8192
    buffer_load_dwordx4 v3, s[4:7], s20 offen lds
    s_add_u32 s20, s20, 7168
    s_mov_b64 exec, s[44:45]
    buffer_load_dwordx4 v3, s[4:7], s22 offen offset:1024 lds
    s_mov_b64 exec, -1
    s_add_u32 s22, s22, s52
    buffer_load_dwordx4 a[4:7], v3, s[4:7], s18 offen offset:1024 sc1
    buffer_load_dwordx4 a[76:79], v15, s[4:7], s18 offen offset:1024 sc1
    v_min_u32 v12, 71, v0
    v_lshrrev_b32 v13, 2, v12
    v_lshlrev_b32 v13, 13, v13
    v_and_b32 v12, 3, v12
    v_lshl_add_u32 v13, v12, 8, v13
    v_mov_b32 v16, 0x3f803f80
    v_mov_b32 v17, 0x3f803f80
    v_mov_b32 v18, 0x3f803f80
    v_mov_b32 v19, 0x3f803f80
    ds_write_b128 v13, v[16:19] offset:7168
    v_mov_b32 v9, v3
    s_lshl_b32 s32, s27, 10
    v_add_u32 v10, s32, v3
    s_lshl_b32 s32, s28, 10
    v_add_u32 v11, s32, v3
    v_mov_b32 v12, 0xee013f39
    v_lshlrev_b32 v13, 2, v5
    v_sub_u32 v13, v4, v13
    s_cmp_eq_u32 s17, 0
    s_cselect_b32 s33, -100, -2
    v_subrev_u32 v14, 0, v13
    v_and_b32 v2, 1, v14
    v_cmp_eq_u32 s[34:35], 0, v2
    v_cmp_le_i32 vcc, 0, v14
    s_nop 0
    s_and_b64 vcc, vcc, s[34:35]
    v_cndmask_b32 v228, v12, 0, vcc
    v_cmp_ge_i32 vcc, -2, v14
    s_nop 0
    s_and_b64 vcc, vcc, s[34:35]
    v_cndmask_b32 v236, v12, 0, vcc
    v_cmp_ge_i32 vcc, s33, v14
    s_nop 0
    s_and_b64 vcc, vcc, s[34:35]
    v_cndmask_b32 v232, v12, 0, vcc
    v_subrev_u32 v14, 1, v13
    v_and_b32 v2, 1, v14
    v_cmp_eq_u32 s[34:35], 0, v2
    v_cmp_le_i32 vcc, 0, v14
    s_nop 0
    s_and_b64 vcc, vcc, s[34:35]
    v_cndmask_b32 v229, v12, 0, vcc
    v_cmp_ge_i32 vcc, -2, v14
    s_nop 0
    s_and_b64 vcc, vcc, s[34:35]
    v_cndmask_b32 v237, v12, 0, vcc
    v_cmp_ge_i32 vcc, s33, v14
    s_nop 0
    s_and_b64 vcc, vcc, s[34:35]
    v_cndmask_b32 v233, v12, 0, vcc
    v_subrev_u32 v14, 2, v13
    v_and_b32 v2, 1, v14
    v_cmp_eq_u32 s[34:35], 0, v2
    v_cmp_le_i32 vcc, 0, v14
    s_nop 0
    s_and_b64 vcc, vcc, s[34:35]
    v_cndmask_b32 v230, v12, 0, vcc
    v_cmp_ge_i32 vcc, -2, v14
    s_nop 0
    s_and_b64 vcc, vcc, s[34:35]
    v_cndmask_b32 v238, v12, 0, vcc
    v_cmp_ge_i32 vcc, s33, v14
    s_nop 0
    s_and_b64 vcc, vcc, s[34:35]
    v_cndmask_b32 v234, v12, 0, vcc
    v_subrev_u32 v14, 3, v13
    v_and_b32 v2, 1, v14
    v_cmp_eq_u32 s[34:35], 0, v2
    v_cmp_le_i32 vcc, 0, v14
    s_nop 0
    s_and_b64 vcc, vcc, s[34:35]
    v_cndmask_b32 v231, v12, 0, vcc
    v_cmp_ge_i32 vcc, -2, v14
    s_nop 0
    s_and_b64 vcc, vcc, s[34:35]
    v_cndmask_b32 v239, v12, 0, vcc
    v_cmp_ge_i32 vcc, s33, v14
    s_nop 0
    s_and_b64 vcc, vcc, s[34:35]
    v_cndmask_b32 v235, v12, 0, vcc
    v_and_b32 v2, 1, v4
    v_cmp_eq_u32 s[30:31], 1, v2
    v_lshlrev_b32 v14, 4, v2
    v_mov_b32 v12, 0xffff
    v_lshlrev_b32 v14, v14, v12
    v_sub_u32 v13, v13, v2
    v_cmp_le_i32 vcc, 0, v13
    s_nop 1
    v_cndmask_b32 v248, 0, v14, vcc
    v_cndmask_b32 v250, v14, 0, vcc
    v_cmp_le_i32 vcc, 2, v13
    s_nop 1
    v_cndmask_b32 v249, 0, v14, vcc
    v_cndmask_b32 v251, v14, 0, vcc
    s_lshl_b32 s32, s3, 9
    s_add_u32 s32, s32, 147456
    v_add_u32 v12, s32, v8
    v_add_u32 v13, s32, v7
    v_add_u32 v240, 4096, v3
    v_add_u32 v241, 8192, v3
    v_add_u32 v242, 12288, v3
    v_add_u32 v243, 16384, v3
    s_and_b32 s40, s9, 3
    s_and_b32 s41, s40, 1
    s_mul_i32 s42, s40, 9
    s_add_u32 s42, s42, s41
    s_lshr_b32 s42, s42, 1
    s_add_u32 s43, s42, s3
    s_lshr_b32 s46, s40, 1
    s_mul_i32 s46, s46, 9
    s_add_u32 s46, s46, 4
    s_mul_i32 s47, s43, 36864
    s_add_u32 s47, s47, 92045312
    s_sub_u32 s47, s47, s59
    s_add_u32 s48, s47, 18432
    s_lshl_b32 s49, s46, 1
    s_add_u32 s49, s49, s3
    s_mul_i32 s49, s49, 18432
    s_add_u32 s49, s49, 92045312
    s_sub_u32 s49, s49, s59
    s_cmp_ge_u32 s3, 2
    s_cselect_b32 s49, 268435456, s49
    s_mov_b32 m0, s24
    s_add_u32 s24, s24, 8192
    buffer_load_dwordx4 v3, s[4:7], s20 offen lds
    s_add_u32 s20, s20, 7168
    s_mov_b64 exec, s[44:45]
    buffer_load_dwordx4 v3, s[4:7], s22 offen offset:1024 lds
    s_mov_b64 exec, -1
    s_add_u32 s22, s22, s52
    buffer_load_dwordx4 a[8:11], v3, s[4:7], s18 offen offset:2048 sc1
    buffer_load_dwordx4 a[80:83], v15, s[4:7], s18 offen offset:2048 sc1
    s_mov_b32 m0, s24
    s_add_u32 s24, s24, 8192
    buffer_load_dwordx4 v3, s[4:7], s20 offen lds
    s_add_u32 s20, s20, 7168
    s_mov_b64 exec, s[44:45]
    buffer_load_dwordx4 v3, s[4:7], s22 offen offset:1024 lds
    s_mov_b64 exec, -1
    s_add_u32 s22, s22, s52
    buffer_load_dwordx4 a[12:15], v3, s[4:7], s18 offen offset:3072 sc1
    buffer_load_dwordx4 a[84:87], v15, s[4:7], s18 offen offset:3072 sc1
    s_add_u32 s18, s18, 4096
    s_mov_b32 m0, s24
    s_add_u32 s24, s24, 8192
    buffer_load_dwordx4 v3, s[4:7], s20 offen lds
    s_add_u32 s20, s20, 7168
    s_mov_b64 exec, s[44:45]
    buffer_load_dwordx4 v3, s[4:7], s22 offen offset:1024 lds
    s_mov_b64 exec, -1
    s_add_u32 s22, s22, s52
    buffer_load_dwordx4 a[16:19], v3, s[4:7], s18 offen offset:0 sc1
    buffer_load_dwordx4 a[88:91], v15, s[4:7], s18 offen offset:0 sc1
    s_waitcnt vmcnt(12)
    s_waitcnt lgkmcnt(0)
    s_barrier
    ds_read_b128 v[116:119], v9 offset:7168
    ds_read_b128 v[120:123], v10 offset:0
    ds_read_b128 v[124:127], v11 offset:0
    ds_read_b128 v[88:91], v9 offset:0
    ds_read_b128 v[92:95], v9 offset:1024
    ds_read_b128 v[96:99], v9 offset:2048
    ds_read_b128 v[100:103], v9 offset:3072
    ds_read_b128 v[112:115], v9 offset:6144
    ds_read_b128 v[104:107], v9 offset:4096
    ds_read_b128 v[108:111], v9 offset:5120
    s_waitcnt lgkmcnt(0)
    v_mfma_f32_16x16x32_bf16 v[80:83], v[120:123], v[116:119], 0
    ds_read_b128 v[156:159], v9 offset:15360
    v_mfma_f32_16x16x32_bf16 v[84:87], v[116:119], v[124:127], 0
    ds_read_b128 v[160:163], v10 offset:8192
    v_mfma_f32_16x16x32_bf16 v[16:19], v[88:91], a[0:3], 0
    ds_read_b128 v[164:167], v11 offset:8192
    v_mfma_f32_16x16x32_bf16 v[48:51], v[88:91], a[72:75], 0
    ds_read_b128 v[128:131], v9 offset:8192
    v_mfma_f32_16x16x32_bf16 v[20:23], v[92:95], a[0:3], 0
    ds_read_b128 v[132:135], v9 offset:9216
    v_mfma_f32_16x16x32_bf16 v[52:55], v[92:95], a[72:75], 0
    ds_read_b128 v[136:139], v9 offset:10240
    v_mfma_f32_16x16x32_bf16 v[24:27], v[96:99], a[0:3], 0
    ds_read_b128 v[140:143], v9 offset:11264
    v_mfma_f32_16x16x32_bf16 v[56:59], v[96:99], a[72:75], 0
    ds_read_b128 v[152:155], v9 offset:14336
    v_mfma_f32_16x16x32_bf16 v[28:31], v[100:103], a[0:3], 0
    ds_read_b128 v[144:147], v9 offset:12288
    v_mfma_f32_16x16x32_bf16 v[60:63], v[100:103], a[72:75], 0
    ds_read_b128 v[148:151], v9 offset:13312
    v_mfma_f32_16x16x32_bf16 v[32:35], v[112:115], a[0:3], 0
    s_mov_b32 m0, s24
    s_add_u32 s24, s24, 8192
    buffer_load_dwordx4 v3, s[4:7], s20 offen lds
    s_add_u32 s20, s20, 7168
    v_mfma_f32_16x16x32_bf16 v[64:67], v[112:115], a[72:75], 0
    v_mfma_f32_16x16x32_bf16 v[36:39], a[0:3], v[104:107], 0
    s_mov_b64 exec, s[44:45]
    buffer_load_dwordx4 v3, s[4:7], s22 offen offset:1024 lds
    s_mov_b64 exec, -1
    s_add_u32 s22, s22, s52
    v_mfma_f32_16x16x32_bf16 v[68:71], a[72:75], v[104:107], 0
    v_mfma_f32_16x16x32_bf16 v[40:43], a[0:3], v[108:111], 0
    buffer_load_dwordx4 a[20:23], v3, s[4:7], s18 offen offset:1024 sc1
    v_mfma_f32_16x16x32_bf16 v[72:75], a[72:75], v[108:111], 0
    v_mfma_f32_16x16x32_bf16 v[44:47], a[0:3], v[112:115], 0
    buffer_load_dwordx4 a[92:95], v15, s[4:7], s18 offen offset:1024 sc1
    v_mfma_f32_16x16x32_bf16 v[76:79], a[72:75], v[112:115], 0
    s_waitcnt lgkmcnt(0)
    s_waitcnt vmcnt(8)
    s_barrier
    v_mfma_f32_16x16x32_bf16 v[80:83], v[160:163], v[156:159], v[80:83]
    ds_read_b128 v[116:119], v9 offset:23552
    v_mov_b32 v208, v200
    v_mfma_f32_16x16x32_bf16 v[84:87], v[156:159], v[164:167], v[84:87]
    ds_read_b128 v[120:123], v10 offset:16384
    v_mov_b32 v209, v201
    v_mfma_f32_16x16x32_bf16 v[16:19], v[128:131], a[4:7], v[16:19]
    ds_read_b128 v[124:127], v11 offset:16384
    v_mov_b32 v210, v202
    v_mfma_f32_16x16x32_bf16 v[48:51], v[128:131], a[76:79], v[48:51]
    ds_read_b128 v[88:91], v9 offset:16384
    v_mov_b32 v211, v203
    v_mfma_f32_16x16x32_bf16 v[20:23], v[132:135], a[4:7], v[20:23]
    ds_read_b128 v[92:95], v9 offset:17408
    v_mov_b32 v212, v204
    v_mfma_f32_16x16x32_bf16 v[52:55], v[132:135], a[76:79], v[52:55]
    ds_read_b128 v[96:99], v9 offset:18432
    v_mov_b32 v213, v205
    v_mfma_f32_16x16x32_bf16 v[24:27], v[136:139], a[4:7], v[24:27]
    ds_read_b128 v[100:103], v9 offset:19456
    v_mov_b32 v214, v206
    v_mfma_f32_16x16x32_bf16 v[56:59], v[136:139], a[76:79], v[56:59]
    ds_read_b128 v[112:115], v9 offset:22528
    v_mov_b32 v215, v207
    v_mfma_f32_16x16x32_bf16 v[28:31], v[140:143], a[4:7], v[28:31]
    ds_read_b128 v[104:107], v9 offset:20480
    v_permlane16_swap_b32 v200, v208
    v_mfma_f32_16x16x32_bf16 v[60:63], v[140:143], a[76:79], v[60:63]
    ds_read_b128 v[108:111], v9 offset:21504
    v_permlane16_swap_b32 v201, v209
    v_mfma_f32_16x16x32_bf16 v[32:35], v[152:155], a[4:7], v[32:35]
    v_permlane16_swap_b32 v202, v210
    s_mov_b32 m0, s24
    s_add_u32 s24, s24, 8192
    buffer_load_dwordx4 v3, s[4:7], s20 offen lds
    s_add_u32 s20, s20, 7168
    v_mfma_f32_16x16x32_bf16 v[64:67], v[152:155], a[76:79], v[64:67]
    v_permlane16_swap_b32 v203, v211
    v_mfma_f32_16x16x32_bf16 v[36:39], a[4:7], v[144:147], v[36:39]
    v_permlane16_swap_b32 v204, v212
    s_mov_b64 exec, s[44:45]
    buffer_load_dwordx4 v3, s[4:7], s22 offen offset:1024 lds
    s_mov_b64 exec, -1
    s_add_u32 s22, s22, s52
    v_mfma_f32_16x16x32_bf16 v[68:71], a[76:79], v[144:147], v[68:71]
    v_permlane16_swap_b32 v205, v213
    v_mfma_f32_16x16x32_bf16 v[40:43], a[4:7], v[148:151], v[40:43]
    v_permlane16_swap_b32 v206, v214
    buffer_load_dwordx4 a[24:27], v3, s[4:7], s18 offen offset:2048 sc1
    v_mfma_f32_16x16x32_bf16 v[72:75], a[76:79], v[148:151], v[72:75]
    v_permlane16_swap_b32 v207, v215
    v_mfma_f32_16x16x32_bf16 v[44:47], a[4:7], v[152:155], v[44:47]
    buffer_load_dwordx4 a[96:99], v15, s[4:7], s18 offen offset:2048 sc1
    v_mfma_f32_16x16x32_bf16 v[76:79], a[76:79], v[152:155], v[76:79]
    s_waitcnt lgkmcnt(0)
    v_mfma_f32_16x16x32_bf16 v[80:83], v[120:123], v[116:119], v[80:83]
    ds_read_b128 v[156:159], v9 offset:31744
    v_add_f32 v200, v200, v208
    v_mfma_f32_16x16x32_bf16 v[84:87], v[116:119], v[124:127], v[84:87]
    ds_read_b128 v[160:163], v10 offset:24576
    v_add_f32 v201, v201, v209
    v_mfma_f32_16x16x32_bf16 v[16:19], v[88:91], a[8:11], v[16:19]
    ds_read_b128 v[164:167], v11 offset:24576
    v_add_f32 v202, v202, v210
    v_mfma_f32_16x16x32_bf16 v[48:51], v[88:91], a[80:83], v[48:51]
    ds_read_b128 v[128:131], v9 offset:24576
    v_add_f32 v203, v203, v211
    v_mfma_f32_16x16x32_bf16 v[20:23], v[92:95], a[8:11], v[20:23]
    ds_read_b128 v[132:135], v9 offset:25600
    v_add_f32 v204, v204, v212
    v_mfma_f32_16x16x32_bf16 v[52:55], v[92:95], a[80:83], v[52:55]
    ds_read_b128 v[136:139], v9 offset:26624
    v_add_f32 v205, v205, v213
    v_mfma_f32_16x16x32_bf16 v[24:27], v[96:99], a[8:11], v[24:27]
    ds_read_b128 v[140:143], v9 offset:27648
    v_add_f32 v206, v206, v214
    v_mfma_f32_16x16x32_bf16 v[56:59], v[96:99], a[80:83], v[56:59]
    ds_read_b128 v[152:155], v9 offset:30720
    v_add_f32 v207, v207, v215
    v_mfma_f32_16x16x32_bf16 v[28:31], v[100:103], a[8:11], v[28:31]
    ds_read_b128 v[144:147], v9 offset:28672
    v_mov_b32 v208, v200
    v_mfma_f32_16x16x32_bf16 v[60:63], v[100:103], a[80:83], v[60:63]
    ds_read_b128 v[148:151], v9 offset:29696
    v_mov_b32 v209, v201
    v_mfma_f32_16x16x32_bf16 v[32:35], v[112:115], a[8:11], v[32:35]
    v_mov_b32 v210, v202
    s_mov_b32 m0, s24
    s_add_u32 s24, s24, 8192
    buffer_load_dwordx4 v3, s[4:7], s20 offen lds
    s_add_u32 s20, s20, 7168
    v_mfma_f32_16x16x32_bf16 v[64:67], v[112:115], a[80:83], v[64:67]
    v_mov_b32 v211, v203
    v_mfma_f32_16x16x32_bf16 v[36:39], a[8:11], v[104:107], v[36:39]
    v_mov_b32 v212, v204
    s_mov_b64 exec, s[44:45]
    buffer_load_dwordx4 v3, s[4:7], s22 offen offset:1024 lds
    s_mov_b64 exec, -1
    s_add_u32 s22, s22, s52
    v_mfma_f32_16x16x32_bf16 v[68:71], a[80:83], v[104:107], v[68:71]
    v_mov_b32 v213, v205
    v_mfma_f32_16x16x32_bf16 v[40:43], a[8:11], v[108:111], v[40:43]
    v_mov_b32 v214, v206
    buffer_load_dwordx4 a[28:31], v3, s[4:7], s18 offen offset:3072 sc1
    v_mfma_f32_16x16x32_bf16 v[72:75], a[80:83], v[108:111], v[72:75]
    v_mov_b32 v215, v207
    v_mfma_f32_16x16x32_bf16 v[44:47], a[8:11], v[112:115], v[44:47]
    buffer_load_dwordx4 a[100:103], v15, s[4:7], s18 offen offset:3072 sc1
    s_add_u32 s18, s18, 4096
    v_mfma_f32_16x16x32_bf16 v[76:79], a[80:83], v[112:115], v[76:79]
    s_waitcnt lgkmcnt(0)
    s_waitcnt vmcnt(8)
    s_barrier
    v_mfma_f32_16x16x32_bf16 v[80:83], v[160:163], v[156:159], v[80:83]
    ds_read_b128 v[116:119], v9 offset:39936
    v_permlane32_swap_b32 v200, v208
    v_mfma_f32_16x16x32_bf16 v[84:87], v[156:159], v[164:167], v[84:87]
    ds_read_b128 v[120:123], v10 offset:32768
    v_permlane32_swap_b32 v201, v209
    v_mfma_f32_16x16x32_bf16 v[16:19], v[128:131], a[12:15], v[16:19]
    ds_read_b128 v[124:127], v11 offset:32768
    v_permlane32_swap_b32 v202, v210
    v_mfma_f32_16x16x32_bf16 v[48:51], v[128:131], a[84:87], v[48:51]
    ds_read_b128 v[88:91], v9 offset:32768
    v_permlane32_swap_b32 v203, v211
    v_mfma_f32_16x16x32_bf16 v[20:23], v[132:135], a[12:15], v[20:23]
    ds_read_b128 v[92:95], v9 offset:33792
    v_permlane32_swap_b32 v204, v212
    v_mfma_f32_16x16x32_bf16 v[52:55], v[132:135], a[84:87], v[52:55]
    ds_read_b128 v[96:99], v9 offset:34816
    v_permlane32_swap_b32 v205, v213
    v_mfma_f32_16x16x32_bf16 v[24:27], v[136:139], a[12:15], v[24:27]
    ds_read_b128 v[100:103], v9 offset:35840
    v_permlane32_swap_b32 v206, v214
    v_mfma_f32_16x16x32_bf16 v[56:59], v[136:139], a[84:87], v[56:59]
    ds_read_b128 v[112:115], v9 offset:38912
    v_permlane32_swap_b32 v207, v215
    v_mfma_f32_16x16x32_bf16 v[28:31], v[140:143], a[12:15], v[28:31]
    ds_read_b128 v[104:107], v9 offset:36864
    v_add_f32 v200, v200, v208
    v_mfma_f32_16x16x32_bf16 v[60:63], v[140:143], a[84:87], v[60:63]
    ds_read_b128 v[108:111], v9 offset:37888
    v_add_f32 v201, v201, v209
    v_mfma_f32_16x16x32_bf16 v[32:35], v[152:155], a[12:15], v[32:35]
    v_add_f32 v202, v202, v210
    s_mov_b32 m0, s24
    s_add_u32 s24, s24, 8192
    buffer_load_dwordx4 v3, s[4:7], s20 offen lds
    s_add_u32 s20, s20, 7168
    v_mfma_f32_16x16x32_bf16 v[64:67], v[152:155], a[84:87], v[64:67]
    v_add_f32 v203, v203, v211
    v_mfma_f32_16x16x32_bf16 v[36:39], a[12:15], v[144:147], v[36:39]
    v_add_f32 v204, v204, v212
    s_mov_b64 exec, s[44:45]
    buffer_load_dwordx4 v3, s[4:7], s22 offen offset:1024 lds
    s_mov_b64 exec, -1
    s_add_u32 s22, s22, s52
    v_mfma_f32_16x16x32_bf16 v[68:71], a[84:87], v[144:147], v[68:71]
    v_add_f32 v205, v205, v213
    v_mfma_f32_16x16x32_bf16 v[40:43], a[12:15], v[148:151], v[40:43]
    v_add_f32 v206, v206, v214
    buffer_load_dwordx4 a[32:35], v3, s[4:7], s18 offen offset:0 sc1
    v_mfma_f32_16x16x32_bf16 v[72:75], a[84:87], v[148:151], v[72:75]
    v_add_f32 v207, v207, v215
    v_mfma_f32_16x16x32_bf16 v[44:47], a[12:15], v[152:155], v[44:47]
    buffer_load_dwordx4 a[104:107], v15, s[4:7], s18 offen offset:0 sc1
    v_mfma_f32_16x16x32_bf16 v[76:79], a[84:87], v[152:155], v[76:79]
    s_waitcnt lgkmcnt(0)
    v_mfma_f32_16x16x32_bf16 v[80:83], v[120:123], v[116:119], v[80:83]
    ds_read_b128 v[156:159], v9 offset:48128
    v_mul_f32 v200, 0x3ae38e39, v200
    v_mfma_f32_16x16x32_bf16 v[84:87], v[116:119], v[124:127], v[84:87]
    ds_read_b128 v[160:163], v10 offset:40960
    v_mul_f32 v201, 0x3ae38e39, v201
    v_mfma_f32_16x16x32_bf16 v[16:19], v[88:91], a[16:19], v[16:19]
    ds_read_b128 v[164:167], v11 offset:40960
    v_fma_f32 v201, -v200, v200, v201
    v_mfma_f32_16x16x32_bf16 v[48:51], v[88:91], a[88:91], v[48:51]
    ds_read_b128 v[128:131], v9 offset:40960
    v_max_f32 v201, 0, v201
    v_mfma_f32_16x16x32_bf16 v[20:23], v[92:95], a[16:19], v[20:23]
    ds_read_b128 v[132:135], v9 offset:41984
    v_add_f32 v208, 0x3727c5ac, v201
    v_mfma_f32_16x16x32_bf16 v[52:55], v[92:95], a[88:91], v[52:55]
    ds_read_b128 v[136:139], v9 offset:43008
    v_rsq_f32 v168, v208
    v_mfma_f32_16x16x32_bf16 v[24:27], v[96:99], a[16:19], v[24:27]
    ds_read_b128 v[140:143], v9 offset:44032
    v_mul_f32 v212, v200, v168
    v_mfma_f32_16x16x32_bf16 v[56:59], v[96:99], a[88:91], v[56:59]
    ds_read_b128 v[152:155], v9 offset:47104
    v_mov_b32 v169, v200
    v_mfma_f32_16x16x32_bf16 v[28:31], v[100:103], a[16:19], v[28:31]
    ds_read_b128 v[144:147], v9 offset:45056
    ds_write_b32 v12, v168 offset:0
    v_mfma_f32_16x16x32_bf16 v[60:63], v[100:103], a[88:91], v[60:63]
    ds_read_b128 v[148:151], v9 offset:46080
    ds_write_b32 v12, v212 offset:64
    v_mfma_f32_16x16x32_bf16 v[32:35], v[112:115], a[16:19], v[32:35]
    v_mul_f32 v202, 0x3ae38e39, v202
    s_mov_b32 m0, s24
    s_add_u32 s24, s24, 8192
    buffer_load_dwordx4 v3, s[4:7], s20 offen lds
    s_add_u32 s20, s20, 7168
    v_mfma_f32_16x16x32_bf16 v[64:67], v[112:115], a[88:91], v[64:67]
    v_mul_f32 v203, 0x3ae38e39, v203
    v_mfma_f32_16x16x32_bf16 v[36:39], a[16:19], v[104:107], v[36:39]
    v_fma_f32 v203, -v202, v202, v203
    s_mov_b64 exec, s[44:45]
    buffer_load_dwordx4 v3, s[4:7], s22 offen offset:1024 lds
    s_mov_b64 exec, -1
    s_add_u32 s22, s22, s52
    v_mfma_f32_16x16x32_bf16 v[68:71], a[88:91], v[104:107], v[68:71]
    v_max_f32 v203, 0, v203
    v_mfma_f32_16x16x32_bf16 v[40:43], a[16:19], v[108:111], v[40:43]
    v_add_f32 v209, 0x3727c5ac, v203
    buffer_load_dwordx4 a[36:39], v3, s[4:7], s18 offen offset:1024 sc1
    v_mfma_f32_16x16x32_bf16 v[72:75], a[88:91], v[108:111], v[72:75]
    v_rsq_f32 v170, v209
    v_mfma_f32_16x16x32_bf16 v[44:47], a[16:19], v[112:115], v[44:47]
    buffer_load_dwordx4 a[108:111], v15, s[4:7], s18 offen offset:1024 sc1
    v_mfma_f32_16x16x32_bf16 v[76:79], a[88:91], v[112:115], v[76:79]
    s_waitcnt lgkmcnt(0)
    s_waitcnt vmcnt(8)
    s_barrier
    v_mfma_f32_16x16x32_bf16 v[80:83], v[160:163], v[156:159], v[80:83]
    ds_read_b128 v[116:119], v9 offset:56320
    v_mul_f32 v213, v202, v170
    v_mfma_f32_16x16x32_bf16 v[84:87], v[156:159], v[164:167], v[84:87]
    ds_read_b128 v[120:123], v10 offset:49152
    v_mov_b32 v171, v202
    v_mfma_f32_16x16x32_bf16 v[16:19], v[128:131], a[20:23], v[16:19]
    ds_read_b128 v[124:127], v11 offset:49152
    ds_write_b32 v12, v170 offset:128
    v_mfma_f32_16x16x32_bf16 v[48:51], v[128:131], a[92:95], v[48:51]
    ds_read_b128 v[88:91], v9 offset:49152
    ds_write_b32 v12, v213 offset:192
    v_mfma_f32_16x16x32_bf16 v[20:23], v[132:135], a[20:23], v[20:23]
    ds_read_b128 v[92:95], v9 offset:50176
    v_mul_f32 v204, 0x3ae38e39, v204
    v_mfma_f32_16x16x32_bf16 v[52:55], v[132:135], a[92:95], v[52:55]
    ds_read_b128 v[96:99], v9 offset:51200
    v_mul_f32 v205, 0x3ae38e39, v205
    v_mfma_f32_16x16x32_bf16 v[24:27], v[136:139], a[20:23], v[24:27]
    ds_read_b128 v[100:103], v9 offset:52224
    v_fma_f32 v205, -v204, v204, v205
    v_mfma_f32_16x16x32_bf16 v[56:59], v[136:139], a[92:95], v[56:59]
    ds_read_b128 v[112:115], v9 offset:55296
    v_max_f32 v205, 0, v205
    v_mfma_f32_16x16x32_bf16 v[28:31], v[140:143], a[20:23], v[28:31]
    ds_read_b128 v[104:107], v9 offset:53248
    v_add_f32 v210, 0x3727c5ac, v205
    v_mfma_f32_16x16x32_bf16 v[60:63], v[140:143], a[92:95], v[60:63]
    ds_read_b128 v[108:111], v9 offset:54272
    v_rsq_f32 v172, v210
    v_mfma_f32_16x16x32_bf16 v[32:35], v[152:155], a[20:23], v[32:35]
    v_mul_f32 v214, v204, v172
    s_mov_b32 m0, s24
    s_add_u32 s24, s24, 8192
    buffer_load_dwordx4 v3, s[4:7], s20 offen lds
    s_add_u32 s20, s20, 7168
    v_mfma_f32_16x16x32_bf16 v[64:67], v[152:155], a[92:95], v[64:67]
    v_mov_b32 v173, v204
    v_mfma_f32_16x16x32_bf16 v[36:39], a[20:23], v[144:147], v[36:39]
    ds_write_b32 v12, v172 offset:256
    s_mov_b64 exec, s[44:45]
    buffer_load_dwordx4 v3, s[4:7], s22 offen offset:1024 lds
    s_mov_b64 exec, -1
    s_add_u32 s22, s22, s52
    v_mfma_f32_16x16x32_bf16 v[68:71], a[92:95], v[144:147], v[68:71]
    ds_write_b32 v12, v214 offset:320
    v_mfma_f32_16x16x32_bf16 v[40:43], a[20:23], v[148:151], v[40:43]
    v_mul_f32 v206, 0x3ae38e39, v206
    buffer_load_dwordx4 a[40:43], v3, s[4:7], s18 offen offset:2048 sc1
    v_mfma_f32_16x16x32_bf16 v[72:75], a[92:95], v[148:151], v[72:75]
    v_mul_f32 v207, 0x3ae38e39, v207
    v_mfma_f32_16x16x32_bf16 v[44:47], a[20:23], v[152:155], v[44:47]
    buffer_load_dwordx4 a[112:115], v15, s[4:7], s18 offen offset:2048 sc1
    v_mfma_f32_16x16x32_bf16 v[76:79], a[92:95], v[152:155], v[76:79]
    s_waitcnt lgkmcnt(0)
    v_mfma_f32_16x16x32_bf16 v[80:83], v[120:123], v[116:119], v[80:83]
    ds_read_b128 v[156:159], v9 offset:64512
    v_fma_f32 v207, -v206, v206, v207
    v_mfma_f32_16x16x32_bf16 v[84:87], v[116:119], v[124:127], v[84:87]
    ds_read_b128 v[160:163], v10 offset:57344
    v_max_f32 v207, 0, v207
    v_mfma_f32_16x16x32_bf16 v[16:19], v[88:91], a[24:27], v[16:19]
    ds_read_b128 v[164:167], v11 offset:57344
    v_add_f32 v211, 0x3727c5ac, v207
    v_mfma_f32_16x16x32_bf16 v[48:51], v[88:91], a[96:99], v[48:51]
    ds_read_b128 v[128:131], v9 offset:57344
    v_rsq_f32 v174, v211
    v_mfma_f32_16x16x32_bf16 v[20:23], v[92:95], a[24:27], v[20:23]
    ds_read_b128 v[132:135], v9 offset:58368
    v_mul_f32 v215, v206, v174
    v_mfma_f32_16x16x32_bf16 v[52:55], v[92:95], a[96:99], v[52:55]
    ds_read_b128 v[136:139], v9 offset:59392
    v_mov_b32 v175, v206
    v_mfma_f32_16x16x32_bf16 v[24:27], v[96:99], a[24:27], v[24:27]
    ds_read_b128 v[140:143], v9 offset:60416
    ds_write_b32 v12, v174 offset:384
    v_mfma_f32_16x16x32_bf16 v[56:59], v[96:99], a[96:99], v[56:59]
    ds_read_b128 v[152:155], v9 offset:63488
    ds_read_b128 v[176:179], v13 offset:0
    v_mfma_f32_16x16x32_bf16 v[28:31], v[100:103], a[24:27], v[28:31]
    ds_read_b128 v[144:147], v9 offset:61440
    ds_read_b128 v[180:183], v13 offset:64
    v_mfma_f32_16x16x32_bf16 v[60:63], v[100:103], a[96:99], v[60:63]
    ds_read_b128 v[148:151], v9 offset:62464
    ds_read_b128 v[184:187], v13 offset:128
    v_mfma_f32_16x16x32_bf16 v[32:35], v[112:115], a[24:27], v[32:35]
    ds_read_b128 v[188:191], v13 offset:192
    s_mov_b32 m0, s24
    s_add_u32 s24, s24, 8192
    buffer_load_dwordx4 v3, s[4:7], s20 offen lds
    s_add_u32 s20, s20, 7168
    v_mfma_f32_16x16x32_bf16 v[64:67], v[112:115], a[96:99], v[64:67]
    ds_read_b128 v[192:195], v13 offset:256
    v_mfma_f32_16x16x32_bf16 v[36:39], a[24:27], v[104:107], v[36:39]
    ds_read_b128 v[196:199], v13 offset:320
    s_mov_b64 exec, s[44:45]
    buffer_load_dwordx4 v3, s[4:7], s22 offen offset:1024 lds
    s_mov_b64 exec, -1
    s_add_u32 s22, s22, s52
    v_mfma_f32_16x16x32_bf16 v[68:71], a[96:99], v[104:107], v[68:71]
    ds_read_b128 v[216:219], v13 offset:384
    v_mfma_f32_16x16x32_bf16 v[40:43], a[24:27], v[108:111], v[40:43]
    buffer_load_dwordx4 a[44:47], v3, s[4:7], s18 offen offset:3072 sc1
    v_mfma_f32_16x16x32_bf16 v[72:75], a[96:99], v[108:111], v[72:75]
    v_mfma_f32_16x16x32_bf16 v[44:47], a[24:27], v[112:115], v[44:47]
    buffer_load_dwordx4 a[116:119], v15, s[4:7], s18 offen offset:3072 sc1
    s_add_u32 s18, s18, 4096
    v_mfma_f32_16x16x32_bf16 v[76:79], a[96:99], v[112:115], v[76:79]
    s_waitcnt lgkmcnt(0)
    s_waitcnt vmcnt(8)
    s_barrier
    v_add_u32 v9, 0x10000, v9
    v_add_u32 v10, 0x10000, v10
    v_add_u32 v11, 0x10000, v11
    v_mfma_f32_16x16x32_bf16 v[80:83], v[160:163], v[156:159], v[80:83]
    ds_read_b128 v[116:119], v9 offset:7168
    v_mfma_f32_16x16x32_bf16 v[84:87], v[156:159], v[164:167], v[84:87]
    ds_read_b128 v[120:123], v10 offset:0
    v_mfma_f32_16x16x32_bf16 v[16:19], v[128:131], a[28:31], v[16:19]
    ds_read_b128 v[124:127], v11 offset:0
    v_mfma_f32_16x16x32_bf16 v[48:51], v[128:131], a[100:103], v[48:51]
    ds_read_b128 v[88:91], v9 offset:0
    v_mfma_f32_16x16x32_bf16 v[20:23], v[132:135], a[28:31], v[20:23]
    ds_read_b128 v[92:95], v9 offset:1024
    v_mfma_f32_16x16x32_bf16 v[52:55], v[132:135], a[100:103], v[52:55]
    ds_read_b128 v[96:99], v9 offset:2048
    v_mfma_f32_16x16x32_bf16 v[24:27], v[136:139], a[28:31], v[24:27]
    ds_read_b128 v[100:103], v9 offset:3072
    v_mfma_f32_16x16x32_bf16 v[56:59], v[136:139], a[100:103], v[56:59]
    ds_read_b128 v[112:115], v9 offset:6144
    v_mfma_f32_16x16x32_bf16 v[28:31], v[140:143], a[28:31], v[28:31]
    ds_read_b128 v[104:107], v9 offset:4096
    v_mfma_f32_16x16x32_bf16 v[60:63], v[140:143], a[100:103], v[60:63]
    ds_read_b128 v[108:111], v9 offset:5120
    v_mfma_f32_16x16x32_bf16 v[32:35], v[152:155], a[28:31], v[32:35]
    s_mov_b32 m0, s24
    s_add_u32 s24, s24, 8192
    buffer_load_dwordx4 v3, s[4:7], s20 offen lds
    s_add_u32 s20, s20, 7168
    v_mfma_f32_16x16x32_bf16 v[64:67], v[152:155], a[100:103], v[64:67]
    v_mfma_f32_16x16x32_bf16 v[36:39], a[28:31], v[144:147], v[36:39]
    s_mov_b64 exec, s[44:45]
    buffer_load_dwordx4 v3, s[4:7], s22 offen offset:1024 lds
    s_mov_b64 exec, -1
    s_add_u32 s22, s22, s52
    v_mfma_f32_16x16x32_bf16 v[68:71], a[100:103], v[144:147], v[68:71]
    v_mfma_f32_16x16x32_bf16 v[40:43], a[28:31], v[148:151], v[40:43]
    buffer_load_dwordx4 a[48:51], v3, s[4:7], s18 offen offset:0 sc1
    v_mfma_f32_16x16x32_bf16 v[72:75], a[100:103], v[148:151], v[72:75]
    v_mfma_f32_16x16x32_bf16 v[44:47], a[28:31], v[152:155], v[44:47]
    buffer_load_dwordx4 a[120:123], v15, s[4:7], s18 offen offset:0 sc1
    v_mfma_f32_16x16x32_bf16 v[76:79], a[100:103], v[152:155], v[76:79]
    s_waitcnt lgkmcnt(0)
    v_mfma_f32_16x16x32_bf16 v[80:83], v[120:123], v[116:119], v[80:83]
    ds_read_b128 v[156:159], v9 offset:15360
    v_mfma_f32_16x16x32_bf16 v[84:87], v[116:119], v[124:127], v[84:87]
    ds_read_b128 v[160:163], v10 offset:8192
    v_mfma_f32_16x16x32_bf16 v[16:19], v[88:91], a[32:35], v[16:19]
    ds_read_b128 v[164:167], v11 offset:8192
    v_mfma_f32_16x16x32_bf16 v[48:51], v[88:91], a[104:107], v[48:51]
    ds_read_b128 v[128:131], v9 offset:8192
    v_mfma_f32_16x16x32_bf16 v[20:23], v[92:95], a[32:35], v[20:23]
    ds_read_b128 v[132:135], v9 offset:9216
    v_mfma_f32_16x16x32_bf16 v[52:55], v[92:95], a[104:107], v[52:55]
    ds_read_b128 v[136:139], v9 offset:10240
    v_mfma_f32_16x16x32_bf16 v[24:27], v[96:99], a[32:35], v[24:27]
    ds_read_b128 v[140:143], v9 offset:11264
    v_mfma_f32_16x16x32_bf16 v[56:59], v[96:99], a[104:107], v[56:59]
    ds_read_b128 v[152:155], v9 offset:14336
    v_mfma_f32_16x16x32_bf16 v[28:31], v[100:103], a[32:35], v[28:31]
    ds_read_b128 v[144:147], v9 offset:12288
    v_mfma_f32_16x16x32_bf16 v[60:63], v[100:103], a[104:107], v[60:63]
    ds_read_b128 v[148:151], v9 offset:13312
    v_mfma_f32_16x16x32_bf16 v[32:35], v[112:115], a[32:35], v[32:35]
    s_mov_b32 m0, s24
    s_add_u32 s24, s24, 8192
    buffer_load_dwordx4 v3, s[4:7], s20 offen lds
    s_add_u32 s20, s20, 7168
    v_mfma_f32_16x16x32_bf16 v[64:67], v[112:115], a[104:107], v[64:67]
    v_mfma_f32_16x16x32_bf16 v[36:39], a[32:35], v[104:107], v[36:39]
    s_mov_b64 exec, s[44:45]
    buffer_load_dwordx4 v3, s[4:7], s22 offen offset:1024 lds
    s_mov_b64 exec, -1
    s_add_u32 s22, s22, s52
    v_mfma_f32_16x16x32_bf16 v[68:71], a[104:107], v[104:107], v[68:71]
    v_mfma_f32_16x16x32_bf16 v[40:43], a[32:35], v[108:111], v[40:43]
    buffer_load_dwordx4 a[52:55], v3, s[4:7], s18 offen offset:1024 sc1
    v_mfma_f32_16x16x32_bf16 v[72:75], a[104:107], v[108:111], v[72:75]
    v_mfma_f32_16x16x32_bf16 v[44:47], a[32:35], v[112:115], v[44:47]
    buffer_load_dwordx4 a[124:127], v15, s[4:7], s18 offen offset:1024 sc1
    v_mfma_f32_16x16x32_bf16 v[76:79], a[104:107], v[112:115], v[76:79]
    s_waitcnt lgkmcnt(0)
    s_waitcnt vmcnt(8)
    s_barrier
    v_mfma_f32_16x16x32_bf16 v[80:83], v[160:163], v[156:159], v[80:83]
    ds_read_b128 v[116:119], v9 offset:23552
    v_mfma_f32_16x16x32_bf16 v[84:87], v[156:159], v[164:167], v[84:87]
    ds_read_b128 v[120:123], v10 offset:16384
    v_mfma_f32_16x16x32_bf16 v[16:19], v[128:131], a[36:39], v[16:19]
    ds_read_b128 v[124:127], v11 offset:16384
    v_mfma_f32_16x16x32_bf16 v[48:51], v[128:131], a[108:111], v[48:51]
    ds_read_b128 v[88:91], v9 offset:16384
    v_mfma_f32_16x16x32_bf16 v[20:23], v[132:135], a[36:39], v[20:23]
    ds_read_b128 v[92:95], v9 offset:17408
    v_mfma_f32_16x16x32_bf16 v[52:55], v[132:135], a[108:111], v[52:55]
    ds_read_b128 v[96:99], v9 offset:18432
    v_mfma_f32_16x16x32_bf16 v[24:27], v[136:139], a[36:39], v[24:27]
    ds_read_b128 v[100:103], v9 offset:19456
    v_mfma_f32_16x16x32_bf16 v[56:59], v[136:139], a[108:111], v[56:59]
    ds_read_b128 v[112:115], v9 offset:22528
    v_mfma_f32_16x16x32_bf16 v[28:31], v[140:143], a[36:39], v[28:31]
    ds_read_b128 v[104:107], v9 offset:20480
    v_mfma_f32_16x16x32_bf16 v[60:63], v[140:143], a[108:111], v[60:63]
    ds_read_b128 v[108:111], v9 offset:21504
    v_mfma_f32_16x16x32_bf16 v[32:35], v[152:155], a[36:39], v[32:35]
    s_mov_b32 m0, s24
    s_add_u32 s24, s24, 8192
    buffer_load_dwordx4 v3, s[4:7], s20 offen lds
    s_add_u32 s20, s20, 7168
    v_mfma_f32_16x16x32_bf16 v[64:67], v[152:155], a[108:111], v[64:67]
    v_mfma_f32_16x16x32_bf16 v[36:39], a[36:39], v[144:147], v[36:39]
    s_mov_b64 exec, s[44:45]
    buffer_load_dwordx4 v3, s[4:7], s22 offen offset:1024 lds
    s_mov_b64 exec, -1
    s_add_u32 s22, s22, s52
    v_mfma_f32_16x16x32_bf16 v[68:71], a[108:111], v[144:147], v[68:71]
    v_mfma_f32_16x16x32_bf16 v[40:43], a[36:39], v[148:151], v[40:43]
    buffer_load_dwordx4 a[56:59], v3, s[4:7], s18 offen offset:2048 sc1
    v_mfma_f32_16x16x32_bf16 v[72:75], a[108:111], v[148:151], v[72:75]
    v_mfma_f32_16x16x32_bf16 v[44:47], a[36:39], v[152:155], v[44:47]
    buffer_load_dwordx4 a[128:131], v15, s[4:7], s18 offen offset:2048 sc1
    v_mfma_f32_16x16x32_bf16 v[76:79], a[108:111], v[152:155], v[76:79]
    s_waitcnt lgkmcnt(0)
    v_mfma_f32_16x16x32_bf16 v[80:83], v[120:123], v[116:119], v[80:83]
    ds_read_b128 v[156:159], v9 offset:31744
    v_mfma_f32_16x16x32_bf16 v[84:87], v[116:119], v[124:127], v[84:87]
    ds_read_b128 v[160:163], v10 offset:24576
    v_mfma_f32_16x16x32_bf16 v[16:19], v[88:91], a[40:43], v[16:19]
    ds_read_b128 v[164:167], v11 offset:24576
    v_mfma_f32_16x16x32_bf16 v[48:51], v[88:91], a[112:115], v[48:51]
    ds_read_b128 v[128:131], v9 offset:24576
    v_mfma_f32_16x16x32_bf16 v[20:23], v[92:95], a[40:43], v[20:23]
    ds_read_b128 v[132:135], v9 offset:25600
    v_mfma_f32_16x16x32_bf16 v[52:55], v[92:95], a[112:115], v[52:55]
    ds_read_b128 v[136:139], v9 offset:26624
    v_mfma_f32_16x16x32_bf16 v[24:27], v[96:99], a[40:43], v[24:27]
    ds_read_b128 v[140:143], v9 offset:27648
    v_mfma_f32_16x16x32_bf16 v[56:59], v[96:99], a[112:115], v[56:59]
    ds_read_b128 v[152:155], v9 offset:30720
    v_mfma_f32_16x16x32_bf16 v[28:31], v[100:103], a[40:43], v[28:31]
    ds_read_b128 v[144:147], v9 offset:28672
    v_mfma_f32_16x16x32_bf16 v[60:63], v[100:103], a[112:115], v[60:63]
    ds_read_b128 v[148:151], v9 offset:29696
    v_mfma_f32_16x16x32_bf16 v[32:35], v[112:115], a[40:43], v[32:35]
    s_mov_b32 m0, s24
    s_add_u32 s24, s24, 8192
    buffer_load_dwordx4 v3, s[4:7], s20 offen lds
    s_add_u32 s20, s20, 7168
    v_mfma_f32_16x16x32_bf16 v[64:67], v[112:115], a[112:115], v[64:67]
    v_mfma_f32_16x16x32_bf16 v[36:39], a[40:43], v[104:107], v[36:39]
    s_mov_b64 exec, s[44:45]
    buffer_load_dwordx4 v3, s[4:7], s22 offen offset:1024 lds
    s_mov_b64 exec, -1
    s_add_u32 s22, s22, s52
    v_mfma_f32_16x16x32_bf16 v[68:71], a[112:115], v[104:107], v[68:71]
    v_mfma_f32_16x16x32_bf16 v[40:43], a[40:43], v[108:111], v[40:43]
    buffer_load_dwordx4 a[60:63], v3, s[4:7], s18 offen offset:3072 sc1
    v_mfma_f32_16x16x32_bf16 v[72:75], a[112:115], v[108:111], v[72:75]
    v_mfma_f32_16x16x32_bf16 v[44:47], a[40:43], v[112:115], v[44:47]
    buffer_load_dwordx4 a[132:135], v15, s[4:7], s18 offen offset:3072 sc1
    s_add_u32 s18, s18, 4096
    v_mfma_f32_16x16x32_bf16 v[76:79], a[112:115], v[112:115], v[76:79]
    s_waitcnt lgkmcnt(0)
    s_waitcnt vmcnt(8)
    s_barrier
    v_mfma_f32_16x16x32_bf16 v[80:83], v[160:163], v[156:159], v[80:83]
    ds_read_b128 v[116:119], v9 offset:39936
    v_mfma_f32_16x16x32_bf16 v[84:87], v[156:159], v[164:167], v[84:87]
    ds_read_b128 v[120:123], v10 offset:32768
    v_mfma_f32_16x16x32_bf16 v[16:19], v[128:131], a[44:47], v[16:19]
    ds_read_b128 v[124:127], v11 offset:32768
    v_mfma_f32_16x16x32_bf16 v[48:51], v[128:131], a[116:119], v[48:51]
    ds_read_b128 v[88:91], v9 offset:32768
    v_mfma_f32_16x16x32_bf16 v[20:23], v[132:135], a[44:47], v[20:23]
    ds_read_b128 v[92:95], v9 offset:33792
    v_mfma_f32_16x16x32_bf16 v[52:55], v[132:135], a[116:119], v[52:55]
    ds_read_b128 v[96:99], v9 offset:34816
    v_mfma_f32_16x16x32_bf16 v[24:27], v[136:139], a[44:47], v[24:27]
    ds_read_b128 v[100:103], v9 offset:35840
    v_mfma_f32_16x16x32_bf16 v[56:59], v[136:139], a[116:119], v[56:59]
    ds_read_b128 v[112:115], v9 offset:38912
    v_mfma_f32_16x16x32_bf16 v[28:31], v[140:143], a[44:47], v[28:31]
    ds_read_b128 v[104:107], v9 offset:36864
    v_mfma_f32_16x16x32_bf16 v[60:63], v[140:143], a[116:119], v[60:63]
    ds_read_b128 v[108:111], v9 offset:37888
    v_mfma_f32_16x16x32_bf16 v[32:35], v[152:155], a[44:47], v[32:35]
    s_mov_b32 m0, s24
    s_add_u32 s24, s24, 8192
    buffer_load_dwordx4 v3, s[4:7], s20 offen lds
    s_add_u32 s20, s20, 7168
    v_mfma_f32_16x16x32_bf16 v[64:67], v[152:155], a[116:119], v[64:67]
    v_mfma_f32_16x16x32_bf16 v[36:39], a[44:47], v[144:147], v[36:39]
    s_mov_b64 exec, s[44:45]
    buffer_load_dwordx4 v3, s[4:7], s22 offen offset:1024 lds
    s_mov_b64 exec, -1
    s_add_u32 s22, s22, s52
    v_mfma_f32_16x16x32_bf16 v[68:71], a[116:119], v[144:147], v[68:71]
    v_mfma_f32_16x16x32_bf16 v[40:43], a[44:47], v[148:151], v[40:43]
    buffer_load_dwordx4 a[64:67], v3, s[4:7], s18 offen offset:0 sc1
    v_mfma_f32_16x16x32_bf16 v[72:75], a[116:119], v[148:151], v[72:75]
    v_mfma_f32_16x16x32_bf16 v[44:47], a[44:47], v[152:155], v[44:47]
    buffer_load_dwordx4 a[136:139], v15, s[4:7], s18 offen offset:0 sc1
    v_mfma_f32_16x16x32_bf16 v[76:79], a[116:119], v[152:155], v[76:79]
    s_waitcnt lgkmcnt(0)
    v_mfma_f32_16x16x32_bf16 v[80:83], v[120:123], v[116:119], v[80:83]
    ds_read_b128 v[156:159], v9 offset:48128
    v_mfma_f32_16x16x32_bf16 v[84:87], v[116:119], v[124:127], v[84:87]
    ds_read_b128 v[160:163], v10 offset:40960
    v_mfma_f32_16x16x32_bf16 v[16:19], v[88:91], a[48:51], v[16:19]
    ds_read_b128 v[164:167], v11 offset:40960
    v_mfma_f32_16x16x32_bf16 v[48:51], v[88:91], a[120:123], v[48:51]
    ds_read_b128 v[128:131], v9 offset:40960
    v_mfma_f32_16x16x32_bf16 v[20:23], v[92:95], a[48:51], v[20:23]
    ds_read_b128 v[132:135], v9 offset:41984
    v_mfma_f32_16x16x32_bf16 v[52:55], v[92:95], a[120:123], v[52:55]
    ds_read_b128 v[136:139], v9 offset:43008
    v_mfma_f32_16x16x32_bf16 v[24:27], v[96:99], a[48:51], v[24:27]
    ds_read_b128 v[140:143], v9 offset:44032
    v_mfma_f32_16x16x32_bf16 v[56:59], v[96:99], a[120:123], v[56:59]
    ds_read_b128 v[152:155], v9 offset:47104
    v_mfma_f32_16x16x32_bf16 v[28:31], v[100:103], a[48:51], v[28:31]
    ds_read_b128 v[144:147], v9 offset:45056
    v_mfma_f32_16x16x32_bf16 v[60:63], v[100:103], a[120:123], v[60:63]
    ds_read_b128 v[148:151], v9 offset:46080
    v_mfma_f32_16x16x32_bf16 v[32:35], v[112:115], a[48:51], v[32:35]
    s_mov_b32 m0, s24
    s_add_u32 s24, s24, 8192
    buffer_load_dwordx4 v3, s[4:7], s20 offen lds
    s_add_u32 s20, s20, 7168
    v_mfma_f32_16x16x32_bf16 v[64:67], v[112:115], a[120:123], v[64:67]
    v_mfma_f32_16x16x32_bf16 v[36:39], a[48:51], v[104:107], v[36:39]
    s_mov_b64 exec, s[44:45]
    buffer_load_dwordx4 v3, s[4:7], s22 offen offset:1024 lds
    s_mov_b64 exec, -1
    s_add_u32 s22, s22, s52
    v_mfma_f32_16x16x32_bf16 v[68:71], a[120:123], v[104:107], v[68:71]
    v_mfma_f32_16x16x32_bf16 v[40:43], a[48:51], v[108:111], v[40:43]
    buffer_load_dwordx4 a[68:71], v3, s[4:7], s18 offen offset:1024 sc1
    v_mfma_f32_16x16x32_bf16 v[72:75], a[120:123], v[108:111], v[72:75]
    v_mfma_f32_16x16x32_bf16 v[44:47], a[48:51], v[112:115], v[44:47]
    buffer_load_dwordx4 a[140:143], v15, s[4:7], s18 offen offset:1024 sc1
    v_mfma_f32_16x16x32_bf16 v[76:79], a[120:123], v[112:115], v[76:79]
    s_waitcnt lgkmcnt(0)
    s_waitcnt vmcnt(8)
    s_barrier
    v_mfma_f32_16x16x32_bf16 v[80:83], v[160:163], v[156:159], v[80:83]
    ds_read_b128 v[116:119], v9 offset:56320
    v_mfma_f32_16x16x32_bf16 v[84:87], v[156:159], v[164:167], v[84:87]
    ds_read_b128 v[120:123], v10 offset:49152
    v_mfma_f32_16x16x32_bf16 v[16:19], v[128:131], a[52:55], v[16:19]
    ds_read_b128 v[124:127], v11 offset:49152
    buffer_load_dwordx4 a[144:147], v3, s[4:7], s49 offen offset:0
    v_mfma_f32_16x16x32_bf16 v[48:51], v[128:131], a[124:127], v[48:51]
    ds_read_b128 v[88:91], v9 offset:49152
    v_mfma_f32_16x16x32_bf16 v[20:23], v[132:135], a[52:55], v[20:23]
    ds_read_b128 v[92:95], v9 offset:50176
    buffer_load_dwordx4 a[148:151], v3, s[4:7], s49 offen offset:1024
    v_mfma_f32_16x16x32_bf16 v[52:55], v[132:135], a[124:127], v[52:55]
    ds_read_b128 v[96:99], v9 offset:51200
    v_mfma_f32_16x16x32_bf16 v[24:27], v[136:139], a[52:55], v[24:27]
    ds_read_b128 v[100:103], v9 offset:52224
    buffer_load_dwordx4 a[152:155], v3, s[4:7], s49 offen offset:2048
    v_mfma_f32_16x16x32_bf16 v[56:59], v[136:139], a[124:127], v[56:59]
    ds_read_b128 v[112:115], v9 offset:55296
    v_mfma_f32_16x16x32_bf16 v[28:31], v[140:143], a[52:55], v[28:31]
    ds_read_b128 v[104:107], v9 offset:53248
    buffer_load_dwordx4 a[156:159], v3, s[4:7], s49 offen offset:3072
    v_mfma_f32_16x16x32_bf16 v[60:63], v[140:143], a[124:127], v[60:63]
    ds_read_b128 v[108:111], v9 offset:54272
    v_mfma_f32_16x16x32_bf16 v[32:35], v[152:155], a[52:55], v[32:35]
    buffer_load_dwordx4 a[160:163], v240, s[4:7], s49 offen offset:0
    v_mfma_f32_16x16x32_bf16 v[64:67], v[152:155], a[124:127], v[64:67]
    v_mfma_f32_16x16x32_bf16 v[36:39], a[52:55], v[144:147], v[36:39]
    buffer_load_dwordx4 a[164:167], v240, s[4:7], s49 offen offset:1024
    v_mfma_f32_16x16x32_bf16 v[68:71], a[124:127], v[144:147], v[68:71]
    v_mfma_f32_16x16x32_bf16 v[40:43], a[52:55], v[148:151], v[40:43]
    buffer_load_dwordx4 a[168:171], v240, s[4:7], s49 offen offset:2048
    v_mfma_f32_16x16x32_bf16 v[72:75], a[124:127], v[148:151], v[72:75]
    v_mfma_f32_16x16x32_bf16 v[44:47], a[52:55], v[152:155], v[44:47]
    buffer_load_dwordx4 a[172:175], v240, s[4:7], s49 offen offset:3072
    v_mfma_f32_16x16x32_bf16 v[76:79], a[124:127], v[152:155], v[76:79]
    s_waitcnt lgkmcnt(0)
    v_mfma_f32_16x16x32_bf16 v[80:83], v[120:123], v[116:119], v[80:83]
    ds_read_b128 v[156:159], v9 offset:64512
    v_mfma_f32_16x16x32_bf16 v[84:87], v[116:119], v[124:127], v[84:87]
    ds_read_b128 v[160:163], v10 offset:57344
    v_mfma_f32_16x16x32_bf16 v[16:19], v[88:91], a[56:59], v[16:19]
    ds_read_b128 v[164:167], v11 offset:57344
    buffer_load_dwordx4 a[176:179], v241, s[4:7], s49 offen offset:0
    v_mfma_f32_16x16x32_bf16 v[48:51], v[88:91], a[128:131], v[48:51]
    ds_read_b128 v[128:131], v9 offset:57344
    v_mfma_f32_16x16x32_bf16 v[20:23], v[92:95], a[56:59], v[20:23]
    ds_read_b128 v[132:135], v9 offset:58368
    buffer_load_dwordx4 a[180:183], v241, s[4:7], s49 offen offset:1024
    v_mfma_f32_16x16x32_bf16 v[52:55], v[92:95], a[128:131], v[52:55]
    ds_read_b128 v[136:139], v9 offset:59392
    v_mfma_f32_16x16x32_bf16 v[24:27], v[96:99], a[56:59], v[24:27]
    ds_read_b128 v[140:143], v9 offset:60416
    buffer_load_dwordx4 a[184:187], v241, s[4:7], s49 offen offset:2048
    v_mfma_f32_16x16x32_bf16 v[56:59], v[96:99], a[128:131], v[56:59]
    ds_read_b128 v[152:155], v9 offset:63488
    v_mfma_f32_16x16x32_bf16 v[28:31], v[100:103], a[56:59], v[28:31]
    ds_read_b128 v[144:147], v9 offset:61440
    buffer_load_dwordx4 a[188:191], v241, s[4:7], s49 offen offset:3072
    v_mfma_f32_16x16x32_bf16 v[60:63], v[100:103], a[128:131], v[60:63]
    ds_read_b128 v[148:151], v9 offset:62464
    v_mfma_f32_16x16x32_bf16 v[32:35], v[112:115], a[56:59], v[32:35]
    buffer_load_dwordx4 a[192:195], v242, s[4:7], s49 offen offset:0
    v_mfma_f32_16x16x32_bf16 v[64:67], v[112:115], a[128:131], v[64:67]
    v_mfma_f32_16x16x32_bf16 v[36:39], a[56:59], v[104:107], v[36:39]
    buffer_load_dwordx4 a[196:199], v242, s[4:7], s49 offen offset:1024
    v_mfma_f32_16x16x32_bf16 v[68:71], a[128:131], v[104:107], v[68:71]
    v_mfma_f32_16x16x32_bf16 v[40:43], a[56:59], v[108:111], v[40:43]
    buffer_load_dwordx4 a[200:203], v242, s[4:7], s49 offen offset:2048
    v_mfma_f32_16x16x32_bf16 v[72:75], a[128:131], v[108:111], v[72:75]
    v_mfma_f32_16x16x32_bf16 v[44:47], a[56:59], v[112:115], v[44:47]
    buffer_load_dwordx4 a[204:207], v242, s[4:7], s49 offen offset:3072
    v_mfma_f32_16x16x32_bf16 v[76:79], a[128:131], v[112:115], v[76:79]
    s_waitcnt lgkmcnt(0)
    s_waitcnt vmcnt(16)
    s_barrier
    v_add_u32 v9, 0x10000, v9
    v_add_u32 v10, 0x10000, v10
    v_add_u32 v11, 0x10000, v11
    v_mfma_f32_16x16x32_bf16 v[80:83], v[160:163], v[156:159], v[80:83]
    ds_read_b128 v[116:119], v9 offset:7168
    v_mfma_f32_16x16x32_bf16 v[84:87], v[156:159], v[164:167], v[84:87]
    ds_read_b128 v[120:123], v10 offset:0
    v_mfma_f32_16x16x32_bf16 v[16:19], v[128:131], a[60:63], v[16:19]
    ds_read_b128 v[124:127], v11 offset:0
    buffer_load_dwordx4 a[208:211], v243, s[4:7], s49 offen offset:0
    v_mfma_f32_16x16x32_bf16 v[48:51], v[128:131], a[132:135], v[48:51]
    ds_read_b128 v[88:91], v9 offset:0
    v_mfma_f32_16x16x32_bf16 v[20:23], v[132:135], a[60:63], v[20:23]
    ds_read_b128 v[92:95], v9 offset:1024
    buffer_load_dwordx4 a[212:215], v243, s[4:7], s49 offen offset:1024
    v_mfma_f32_16x16x32_bf16 v[52:55], v[132:135], a[132:135], v[52:55]
    ds_read_b128 v[96:99], v9 offset:2048
    v_mfma_f32_16x16x32_bf16 v[24:27], v[136:139], a[60:63], v[24:27]
    ds_read_b128 v[100:103], v9 offset:3072
    v_mfma_f32_16x16x32_bf16 v[56:59], v[136:139], a[132:135], v[56:59]
    ds_read_b128 v[112:115], v9 offset:6144
    v_mfma_f32_16x16x32_bf16 v[28:31], v[140:143], a[60:63], v[28:31]
    ds_read_b128 v[104:107], v9 offset:4096
    v_mfma_f32_16x16x32_bf16 v[60:63], v[140:143], a[132:135], v[60:63]
    ds_read_b128 v[108:111], v9 offset:5120
    v_mfma_f32_16x16x32_bf16 v[32:35], v[152:155], a[60:63], v[32:35]
    v_mfma_f32_16x16x32_bf16 v[64:67], v[152:155], a[132:135], v[64:67]
    v_mfma_f32_16x16x32_bf16 v[36:39], a[60:63], v[144:147], v[36:39]
    v_mfma_f32_16x16x32_bf16 v[68:71], a[132:135], v[144:147], v[68:71]
    v_mfma_f32_16x16x32_bf16 v[40:43], a[60:63], v[148:151], v[40:43]
    v_mfma_f32_16x16x32_bf16 v[72:75], a[132:135], v[148:151], v[72:75]
    v_mfma_f32_16x16x32_bf16 v[44:47], a[60:63], v[152:155], v[44:47]
    v_mfma_f32_16x16x32_bf16 v[76:79], a[132:135], v[152:155], v[76:79]
    s_waitcnt lgkmcnt(0)
    v_mfma_f32_16x16x32_bf16 v[80:83], v[120:123], v[116:119], v[80:83]
    ds_read_b128 v[156:159], v9 offset:15360
    v_cndmask_b32 v200, v216, v217, s[30:31]
    v_mfma_f32_16x16x32_bf16 v[84:87], v[116:119], v[124:127], v[84:87]
    ds_read_b128 v[160:163], v10 offset:8192
    v_cndmask_b32 v201, v218, v219, s[30:31]
    v_mfma_f32_16x16x32_bf16 v[16:19], v[88:91], a[64:67], v[16:19]
    ds_read_b128 v[164:167], v11 offset:8192
    v_cndmask_b32 v202, v176, v177, s[30:31]
    v_mfma_f32_16x16x32_bf16 v[48:51], v[88:91], a[136:139], v[48:51]
    ds_read_b128 v[128:131], v9 offset:8192
    v_cndmask_b32 v203, v178, v179, s[30:31]
    v_mfma_f32_16x16x32_bf16 v[20:23], v[92:95], a[64:67], v[20:23]
    ds_read_b128 v[132:135], v9 offset:9216
    v_cndmask_b32 v204, v184, v185, s[30:31]
    v_mfma_f32_16x16x32_bf16 v[52:55], v[92:95], a[136:139], v[52:55]
    ds_read_b128 v[136:139], v9 offset:10240
    v_cndmask_b32 v205, v186, v187, s[30:31]
    v_mfma_f32_16x16x32_bf16 v[24:27], v[96:99], a[64:67], v[24:27]
    ds_read_b128 v[140:143], v9 offset:11264
    v_cmp_ne_u32 vcc, 0, v248
    v_mfma_f32_16x16x32_bf16 v[56:59], v[96:99], a[136:139], v[56:59]
    ds_read_b128 v[152:155], v9 offset:14336
    v_cndmask_b32 v244, v200, v202, vcc
    v_mfma_f32_16x16x32_bf16 v[28:31], v[100:103], a[64:67], v[28:31]
    ds_read_b128 v[144:147], v9 offset:12288
    v_cndmask_b32 v246, v202, v204, vcc
    v_mfma_f32_16x16x32_bf16 v[60:63], v[100:103], a[136:139], v[60:63]
    ds_read_b128 v[148:151], v9 offset:13312
    v_cmp_ne_u32 vcc, 0, v249
    v_mfma_f32_16x16x32_bf16 v[32:35], v[112:115], a[64:67], v[32:35]
    s_nop 0
    v_cndmask_b32 v245, v201, v203, vcc
    v_mfma_f32_16x16x32_bf16 v[64:67], v[112:115], a[136:139], v[64:67]
    v_cndmask_b32 v247, v203, v205, vcc
    v_mfma_f32_16x16x32_bf16 v[36:39], a[64:67], v[104:107], v[36:39]
    v_mul_f32 v206, 0x3eae1a93, v168
    v_mfma_f32_16x16x32_bf16 v[68:71], a[136:139], v[104:107], v[68:71]
    v_mul_f32 v244, v244, v206
    v_mfma_f32_16x16x32_bf16 v[40:43], a[64:67], v[108:111], v[40:43]
    v_mul_f32 v245, v245, v206
    v_mfma_f32_16x16x32_bf16 v[72:75], a[136:139], v[108:111], v[72:75]
    v_mul_f32 v207, 0x3eae1a93, v170
    v_mfma_f32_16x16x32_bf16 v[44:47], a[64:67], v[112:115], v[44:47]
    v_mul_f32 v246, v246, v207
    v_mfma_f32_16x16x32_bf16 v[76:79], a[136:139], v[112:115], v[76:79]
    v_mul_f32 v247, v247, v207
    s_waitcnt lgkmcnt(0)
    s_lshl_b32 s32, s27, 6
    s_add_u32 s32, s32, 162816
    v_add_u32 v12, s32, v7
    s_lshl_b32 s33, s28, 6
    s_add_u32 s33, s33, 162816
    v_add_u32 v13, s33, v8
    s_mov_b32 s34, 0x00010001
    s_mov_b32 s35, 0x00010001
    v_mfma_f32_16x16x32_bf16 v[80:83], v[160:163], v[156:159], v[80:83]
    v_mov_b32 v91, 0
    v_mfma_f32_16x16x32_bf16 v[84:87], v[156:159], v[164:167], v[84:87]
    v_mov_b32 v95, 0
    v_mfma_f32_16x16x32_bf16 v[16:19], v[128:131], a[68:71], v[16:19]
    v_mov_b32 v99, 0
    v_mfma_f32_16x16x32_bf16 v[48:51], v[128:131], a[140:143], v[48:51]
    v_mov_b32 v103, 0
    v_mfma_f32_16x16x32_bf16 v[20:23], v[132:135], a[68:71], v[20:23]
    v_mov_b32 v107, 0
    v_mfma_f32_16x16x32_bf16 v[52:55], v[132:135], a[140:143], v[52:55]
    v_mov_b32 v111, 0
    v_mfma_f32_16x16x32_bf16 v[24:27], v[136:139], a[68:71], v[24:27]
    v_mov_b32 v115, 0
    v_mfma_f32_16x16x32_bf16 v[56:59], v[136:139], a[140:143], v[56:59]
    v_mov_b32 v119, 0
    v_mfma_f32_16x16x32_bf16 v[28:31], v[140:143], a[68:71], v[28:31]
    v_mov_b32 v123, 0
    v_mfma_f32_16x16x32_bf16 v[60:63], v[140:143], a[140:143], v[60:63]
    v_mov_b32 v127, 0
    v_mfma_f32_16x16x32_bf16 v[32:35], v[152:155], a[68:71], v[32:35]
    s_mov_b64 exec, s[34:35]
    ds_write_b128 v12, v[80:83]
    s_mov_b64 exec, 0xffff
    ds_write_b32 v13, v84
    s_mov_b64 exec, -1
    v_mfma_f32_16x16x32_bf16 v[64:67], v[152:155], a[140:143], v[64:67]
    v_mfma_f32_16x16x32_bf16 v[36:39], a[68:71], v[144:147], v[36:39]
    v_mfma_f32_16x16x32_bf16 v[68:71], a[140:143], v[144:147], v[68:71]
    v_mfma_f32_16x16x32_bf16 v[40:43], a[68:71], v[148:151], v[40:43]
    v_mfma_f32_16x16x32_bf16 v[72:75], a[140:143], v[148:151], v[72:75]
    v_mfma_f32_16x16x32_bf16 v[44:47], a[68:71], v[152:155], v[44:47]
    v_mfma_f32_16x16x32_bf16 v[76:79], a[140:143], v[152:155], v[76:79]
    s_waitcnt lgkmcnt(0)
    s_nop 6
main_kernel_epi:
    s_barrier
    v_add_u32 v9, 162816, v7
    v_add_u32 v10, 162816, v8
    ds_read_b128 v[200:203], v9 offset:0
    ds_read_b128 v[204:207], v9 offset:64
    ds_read_b128 v[208:211], v9 offset:128
    ds_read_b128 v[212:215], v9 offset:192
    ds_read_b128 v[216:219], v9 offset:384
    ds_read_b128 v[220:223], v12
    ds_read_b32 v224, v10 offset:256
    ds_read_b32 v225, v10 offset:320
    ds_read_b32 v226, v10 offset:384
    ds_read_b32 v227, v13
    v_mul_f32 v84, v84, v192
    v_mul_f32 v85, v85, v193
    v_mul_f32 v86, v86, v194
    v_mul_f32 v87, v87, v195
    v_mul_f32 v68, v68, v184
    v_mul_f32 v69, v69, v185
    v_mul_f32 v70, v70, v186
    v_mul_f32 v71, v71, v187
    buffer_load_dwordx4 a[0:3], v3, s[4:7], s47 offen offset:0
    v_mul_f32 v72, v72, v184
    v_mul_f32 v73, v73, v185
    v_mul_f32 v74, v74, v186
    v_mul_f32 v75, v75, v187
    v_mul_f32 v76, v76, v184
    v_mul_f32 v77, v77, v185
    v_mul_f32 v78, v78, v186
    v_mul_f32 v79, v79, v187
    buffer_load_dwordx4 a[72:75], v3, s[4:7], s48 offen offset:0
    v_mul_f32 v36, v36, v176
    v_mul_f32 v37, v37, v177
    v_mul_f32 v38, v38, v178
    v_mul_f32 v39, v39, v179
    v_mul_f32 v40, v40, v176
    v_mul_f32 v41, v41, v177
    v_mul_f32 v42, v42, v178
    v_mul_f32 v43, v43, v179
    buffer_load_dwordx4 a[4:7], v3, s[4:7], s47 offen offset:1024
    v_mul_f32 v44, v44, v176
    v_mul_f32 v45, v45, v177
    v_mul_f32 v46, v46, v178
    v_mul_f32 v47, v47, v179
    v_cmp_eq_u32 s[36:37], 0, v5
    v_cmp_eq_u32 s[38:39], 1, v5
    v_lshlrev_b32 v12, 3, v1
    s_mul_i32 s32, s3, 3072
    s_add_u32 s33, s32, 147456
    v_add_u32 v13, s33, v12
    buffer_load_dwordx4 a[76:79], v3, s[4:7], s48 offen offset:1024
    s_lshl_b32 s32, s3, 9
    s_add_u32 s32, s32, 147456
    s_cmp_eq_u32 s3, 3
    s_cselect_b32 s32, 159744, s32
    v_add_u32 v14, s32, v12
    s_waitcnt lgkmcnt(0)
    v_fma_f32 v80, -v173, v220, v80
    v_fma_f32 v81, -v173, v221, v81
    v_fma_f32 v82, -v173, v222, v82
    v_fma_f32 v83, -v173, v223, v83
    v_fma_f32 v84, -v196, v227, v84
    v_fma_f32 v85, -v197, v227, v85
    v_fma_f32 v86, -v198, v227, v86
    buffer_load_dwordx4 a[8:11], v3, s[4:7], s47 offen offset:2048
    v_fma_f32 v87, -v199, v227, v87
    v_cvt_pk_bf16_f32 v164, v80, v81
    v_cvt_pk_bf16_f32 v165, v82, v83
    v_cvt_pk_bf16_f32 v166, v84, v85
    v_cvt_pk_bf16_f32 v167, v86, v87
    ds_write_b64 v14, v[164:165]
    ds_write_b64 v14, v[166:167] offset:1536
    v_fma_f32 v48, -v171, v200, v48
    v_fma_f32 v49, -v171, v201, v49
    v_fma_f32 v50, -v171, v202, v50
    buffer_load_dwordx4 a[80:83], v3, s[4:7], s48 offen offset:2048
    v_fma_f32 v51, -v171, v203, v51
    v_fma_f32 v52, -v171, v204, v52
    v_fma_f32 v53, -v171, v205, v53
    v_fma_f32 v54, -v171, v206, v54
    v_fma_f32 v55, -v171, v207, v55
    v_fma_f32 v56, -v171, v208, v56
    v_fma_f32 v57, -v171, v209, v57
    v_fma_f32 v58, -v171, v210, v58
    buffer_load_dwordx4 a[12:15], v3, s[4:7], s47 offen offset:3072
    v_fma_f32 v59, -v171, v211, v59
    v_fma_f32 v60, -v171, v212, v60
    v_fma_f32 v61, -v171, v213, v61
    v_fma_f32 v62, -v171, v214, v62
    v_fma_f32 v63, -v171, v215, v63
    v_fma_f32 v64, -v171, v216, v64
    v_fma_f32 v65, -v171, v217, v65
    v_fma_f32 v66, -v171, v218, v66
    buffer_load_dwordx4 a[84:87], v3, s[4:7], s48 offen offset:3072
    v_fma_f32 v67, -v171, v219, v67
    v_cvt_pk_bf16_f32 v120, v48, v49
    v_cvt_pk_bf16_f32 v121, v50, v51
    v_cvt_pk_bf16_f32 v104, v56, v57
    v_cvt_pk_bf16_f32 v105, v58, v59
    v_cvt_pk_bf16_f32 v124, v52, v53
    v_cvt_pk_bf16_f32 v125, v54, v55
    v_cvt_pk_bf16_f32 v108, v60, v61
    buffer_load_dwordx4 a[16:19], v240, s[4:7], s47 offen offset:0
    v_cvt_pk_bf16_f32 v109, v62, v63
    v_cvt_pk_bf16_f32 v162, v64, v65
    v_cvt_pk_bf16_f32 v163, v66, v67
    v_mov_b32 v106, v163
    v_cndmask_b32 v122, 0, v162, s[36:37]
    v_mov_b32 v110, v163
    v_cndmask_b32 v126, 0, v162, s[38:39]
    v_fma_f32 v68, -v188, v224, v68
    buffer_load_dwordx4 a[88:91], v240, s[4:7], s48 offen offset:0
    v_fma_f32 v69, -v189, v224, v69
    v_fma_f32 v70, -v190, v224, v70
    v_fma_f32 v71, -v191, v224, v71
    v_cvt_pk_bf16_f32 v132, v68, v69
    v_cvt_pk_bf16_f32 v133, v70, v71
    v_fma_f32 v72, -v188, v225, v72
    v_fma_f32 v73, -v189, v225, v73
    v_fma_f32 v74, -v190, v225, v74
    buffer_load_dwordx4 a[20:23], v240, s[4:7], s47 offen offset:1024
    v_fma_f32 v75, -v191, v225, v75
    v_cvt_pk_bf16_f32 v138, v72, v73
    v_cvt_pk_bf16_f32 v139, v74, v75
    v_fma_f32 v76, -v188, v226, v76
    v_fma_f32 v77, -v189, v226, v77
    v_fma_f32 v78, -v190, v226, v78
    v_fma_f32 v79, -v191, v226, v79
    v_cvt_pk_bf16_f32 v144, v76, v77
    buffer_load_dwordx4 a[92:95], v240, s[4:7], s48 offen offset:1024
    v_cvt_pk_bf16_f32 v145, v78, v79
    ds_write_b64 v13, v[104:105] offset:3072
    ds_write_b64 v13, v[108:109] offset:3584
    ds_write_b64 v13, v[162:163] offset:4096
    ds_write_b64 v13, v[132:133] offset:4608
    ds_write_b64 v13, v[138:139] offset:5120
    ds_write_b64 v13, v[144:145] offset:5632
    v_fma_f32 v16, -v169, v200, v16
    v_fma_f32 v17, -v169, v201, v17
    v_fma_f32 v18, -v169, v202, v18
    v_fma_f32 v19, -v169, v203, v19
    v_fma_f32 v20, -v169, v204, v20
    v_fma_f32 v21, -v169, v205, v21
    v_fma_f32 v22, -v169, v206, v22
    buffer_load_dwordx4 a[24:27], v240, s[4:7], s47 offen offset:2048
    v_fma_f32 v23, -v169, v207, v23
    v_fma_f32 v24, -v169, v208, v24
    v_fma_f32 v25, -v169, v209, v25
    v_fma_f32 v26, -v169, v210, v26
    v_fma_f32 v27, -v169, v211, v27
    v_fma_f32 v28, -v169, v212, v28
    v_fma_f32 v29, -v169, v213, v29
    v_fma_f32 v30, -v169, v214, v30
    buffer_load_dwordx4 a[96:99], v240, s[4:7], s48 offen offset:2048
    v_fma_f32 v31, -v169, v215, v31
    v_fma_f32 v32, -v169, v216, v32
    v_fma_f32 v33, -v169, v217, v33
    v_fma_f32 v34, -v169, v218, v34
    v_fma_f32 v35, -v169, v219, v35
    v_cvt_pk_bf16_f32 v112, v16, v17
    v_cvt_pk_bf16_f32 v113, v18, v19
    v_cvt_pk_bf16_f32 v96, v24, v25
    buffer_load_dwordx4 a[28:31], v240, s[4:7], s47 offen offset:3072
    v_cvt_pk_bf16_f32 v97, v26, v27
    v_cvt_pk_bf16_f32 v116, v20, v21
    v_cvt_pk_bf16_f32 v117, v22, v23
    v_cvt_pk_bf16_f32 v100, v28, v29
    v_cvt_pk_bf16_f32 v101, v30, v31
    v_cvt_pk_bf16_f32 v160, v32, v33
    v_cvt_pk_bf16_f32 v161, v34, v35
    v_mov_b32 v98, v161
    buffer_load_dwordx4 a[100:103], v240, s[4:7], s48 offen offset:3072
    v_cndmask_b32 v114, 0, v160, s[36:37]
    v_mov_b32 v102, v161
    v_cndmask_b32 v118, 0, v160, s[38:39]
    v_fma_f32 v36, -v180, v224, v36
    v_fma_f32 v37, -v181, v224, v37
    v_fma_f32 v38, -v182, v224, v38
    v_fma_f32 v39, -v183, v224, v39
    v_cvt_pk_bf16_f32 v130, v36, v37
    buffer_load_dwordx4 a[32:35], v241, s[4:7], s47 offen offset:0
    v_cvt_pk_bf16_f32 v131, v38, v39
    v_fma_f32 v40, -v180, v225, v40
    v_fma_f32 v41, -v181, v225, v41
    v_fma_f32 v42, -v182, v225, v42
    v_fma_f32 v43, -v183, v225, v43
    v_cvt_pk_bf16_f32 v136, v40, v41
    v_cvt_pk_bf16_f32 v137, v42, v43
    v_fma_f32 v44, -v180, v226, v44
    buffer_load_dwordx4 a[104:107], v241, s[4:7], s48 offen offset:0
    v_fma_f32 v45, -v181, v226, v45
    v_fma_f32 v46, -v182, v226, v46
    v_fma_f32 v47, -v183, v226, v47
    v_cvt_pk_bf16_f32 v142, v44, v45
    v_cvt_pk_bf16_f32 v143, v46, v47
    v_mov_b32 v148, 0x3f803f80
    v_mov_b32 v149, 0x3f803f80
    v_mov_b32 v150, 0x3f803f80
    buffer_load_dwordx4 a[36:39], v241, s[4:7], s47 offen offset:1024
    v_mov_b32 v151, 0x3f803f80
    s_waitcnt lgkmcnt(0)
    s_barrier
    ds_read_b64 v[88:89], v13
    ds_read_b64 v[92:93], v13 offset:512
    ds_read_b32 v90, v13 offset:1028
    ds_read_b32 v94, v13 offset:1028
    ds_read_b64 v[128:129], v13 offset:1536
    ds_read_b64 v[134:135], v13 offset:2048
    ds_read_b64 v[140:141], v13 offset:2560
    v_mfma_f32_16x16x32_bf16 v[16:19], v[96:99], v[120:123], v[236:239]
    v_mfma_f32_16x16x32_bf16 v[20:23], v[104:107], v[120:123], v[228:231]
    v_mfma_f32_16x16x32_bf16 v[24:27], v[100:103], v[124:127], v[236:239]
    v_mfma_f32_16x16x32_bf16 v[28:31], v[108:111], v[124:127], v[228:231]
    s_waitcnt lgkmcnt(0)
    v_mfma_f32_16x16x32_bf16 v[32:35], v[88:91], v[112:115], v[232:235]
    v_mfma_f32_16x16x32_bf16 v[36:39], v[96:99], v[112:115], v[228:231]
    v_mfma_f32_16x16x32_bf16 v[40:43], v[92:95], v[116:119], v[232:235]
    v_mfma_f32_16x16x32_bf16 v[44:47], v[100:103], v[116:119], v[228:231]
    s_mul_i32 s32, s17, 18432
    s_lshl_b32 s33, s9, 10
    s_add_u32 s33, s33, s32
    s_add_u32 s33, s33, 2457600
    s_add_u32 s34, s33, 18432
    s_lshr_b32 s35, s9, 3
    s_lshl_b32 s35, s35, 10
    s_and_b32 s36, s9, 7
    s_lshl_b32 s36, s36, 7
    s_add_u32 s35, s35, s36
    s_add_u32 s35, s35, s32
    s_add_u32 s35, s35, 2473984
    s_add_u32 s36, s35, 18432
    v_max3_f32 v16, v16, v17, v20
    v_max3_f32 v18, v18, v19, v22
    v_max_f32 v16, v16, v21
    v_max_f32 v18, v18, v23
    v_mul_f32 v16, v16, v246
    v_mul_f32 v18, v18, v247
    v_max_f32 v64, v16, v18
    buffer_load_dwordx4 a[108:111], v241, s[4:7], s48 offen offset:1024
    v_max3_f32 v24, v24, v25, v28
    v_max3_f32 v26, v26, v27, v30
    v_max_f32 v24, v24, v29
    v_max_f32 v26, v26, v31
    v_mul_f32 v24, v24, v246
    v_mul_f32 v26, v26, v247
    v_max_f32 v66, v24, v26
    v_max3_f32 v32, v32, v33, v36
    buffer_load_dwordx4 a[40:43], v241, s[4:7], s47 offen offset:2048
    v_max3_f32 v34, v34, v35, v38
    v_max_f32 v32, v32, v37
    v_max_f32 v34, v34, v39
    v_mul_f32 v32, v32, v244
    v_mul_f32 v34, v34, v245
    v_max_f32 v68, v32, v34
    v_max3_f32 v40, v40, v41, v44
    v_max3_f32 v42, v42, v43, v46
    buffer_load_dwordx4 a[112:115], v241, s[4:7], s48 offen offset:2048
    v_max_f32 v40, v40, v45
    v_max_f32 v42, v42, v47
    v_mul_f32 v40, v40, v244
    v_mul_f32 v42, v42, v245
    v_max_f32 v70, v40, v42
    v_mov_b32 v65, v64
    v_mov_b32 v67, v66
    v_mov_b32 v69, v68
    buffer_load_dwordx4 a[44:47], v241, s[4:7], s47 offen offset:3072
    v_mov_b32 v71, v70
    v_permlane16_swap_b32 v64, v65
    v_permlane16_swap_b32 v66, v67
    v_permlane16_swap_b32 v68, v69
    v_permlane16_swap_b32 v70, v71
    v_max_f32 v64, v64, v65
    v_max_f32 v66, v66, v67
    v_max_f32 v68, v68, v69
    buffer_load_dwordx4 a[116:119], v241, s[4:7], s48 offen offset:3072
    v_max_f32 v70, v70, v71
    v_mov_b32 v65, v64
    v_mov_b32 v67, v66
    v_mov_b32 v69, v68
    v_mov_b32 v71, v70
    v_permlane32_swap_b32 v64, v65
    v_permlane32_swap_b32 v66, v67
    v_permlane32_swap_b32 v68, v69
    buffer_load_dwordx4 a[48:51], v242, s[4:7], s47 offen offset:0
    v_permlane32_swap_b32 v70, v71
    v_max_f32 v64, v64, v65
    v_max_f32 v66, v66, v67
    v_max_f32 v68, v68, v69
    v_max_f32 v70, v70, v71
    v_sub_f32 v16, v16, v64
    v_sub_f32 v18, v18, v64
    v_sub_f32 v24, v24, v66
    buffer_load_dwordx4 a[120:123], v242, s[4:7], s48 offen offset:0
    v_sub_f32 v26, v26, v66
    v_sub_f32 v32, v32, v68
    v_sub_f32 v34, v34, v68
    v_sub_f32 v40, v40, v70
    v_sub_f32 v42, v42, v70
    v_exp_f32 v16, v16
    v_exp_f32 v18, v18
    v_exp_f32 v24, v24
    buffer_load_dwordx4 a[52:55], v242, s[4:7], s47 offen offset:1024
    v_exp_f32 v26, v26
    v_exp_f32 v32, v32
    v_exp_f32 v34, v34
    v_exp_f32 v40, v40
    v_exp_f32 v42, v42
    v_cvt_pk_bf16_f32 v16, v16, v16
    v_cvt_pk_bf16_f32 v18, v18, v18
    v_and_b32 v48, v16, v250
    buffer_load_dwordx4 a[124:127], v242, s[4:7], s48 offen offset:1024
    v_and_b32 v50, v16, v248
    v_and_b32 v49, v18, v251
    v_and_b32 v51, v18, v249
    s_nop 1
    v_mfma_f32_16x16x32_bf16 v[176:179], v[148:151], v[48:51], 0
    v_mfma_f32_16x16x32_bf16 v[168:171], v[130:133], v[48:51], 0
    v_mfma_f32_16x16x32_bf16 v[172:175], v[142:145], v[48:51], 0
    v_cvt_pk_bf16_f32 v24, v24, v24
    v_cvt_pk_bf16_f32 v26, v26, v26
    v_and_b32 v52, v24, v250
    v_and_b32 v54, v24, v248
    v_and_b32 v53, v26, v251
    buffer_load_dwordx4 a[56:59], v242, s[4:7], s47 offen offset:2048
    v_and_b32 v55, v26, v249
    s_nop 1
    v_mfma_f32_16x16x32_bf16 v[188:191], v[148:151], v[52:55], 0
    v_mfma_f32_16x16x32_bf16 v[180:183], v[136:139], v[52:55], 0
    v_mfma_f32_16x16x32_bf16 v[184:187], v[142:145], v[52:55], 0
    v_cvt_pk_bf16_f32 v32, v32, v32
    v_cvt_pk_bf16_f32 v34, v34, v34
    v_and_b32 v56, v32, v250
    v_and_b32 v58, v32, v248
    v_and_b32 v57, v34, v251
    v_and_b32 v59, v34, v249
    s_nop 1
    v_mfma_f32_16x16x32_bf16 v[200:203], v[148:151], v[56:59], 0
    v_mfma_f32_16x16x32_bf16 v[192:195], v[128:131], v[56:59], 0
    v_mfma_f32_16x16x32_bf16 v[196:199], v[140:143], v[56:59], 0
    v_cvt_pk_bf16_f32 v40, v40, v40
    buffer_load_dwordx4 a[128:131], v242, s[4:7], s48 offen offset:2048
    v_cvt_pk_bf16_f32 v42, v42, v42
    v_and_b32 v60, v40, v250
    v_and_b32 v62, v40, v248
    v_and_b32 v61, v42, v251
    v_and_b32 v63, v42, v249
    s_nop 1
    v_mfma_f32_16x16x32_bf16 v[212:215], v[148:151], v[60:63], 0
    v_mfma_f32_16x16x32_bf16 v[204:207], v[134:137], v[60:63], 0
    v_mfma_f32_16x16x32_bf16 v[208:211], v[140:143], v[60:63], 0
    v_lshlrev_b32 v12, 3, v4
    v_mov_b32 v13, 0x40000000
    v_cmp_eq_u32 vcc, 2, v5
    s_nop 1
    v_cndmask_b32 v12, v13, v12, vcc
    v_rcp_f32 v176, v176
    s_nop 0
    v_mul_f32 v168, v168, v176
    v_mul_f32 v169, v169, v176
    v_mul_f32 v170, v170, v176
    v_mul_f32 v171, v171, v176
    v_mul_f32 v172, v172, v176
    v_mul_f32 v173, v173, v176
    v_cvt_pk_bf16_f32 v76, v168, v169
    v_cvt_pk_bf16_f32 v77, v170, v171
    v_cvt_pk_bf16_f32 v82, v172, v173
    v_rcp_f32 v188, v188
    s_nop 0
    v_mul_f32 v180, v180, v188
    v_mul_f32 v181, v181, v188
    v_mul_f32 v182, v182, v188
    v_mul_f32 v183, v183, v188
    v_mul_f32 v186, v186, v188
    v_mul_f32 v187, v187, v188
    v_cvt_pk_bf16_f32 v78, v180, v181
    v_cvt_pk_bf16_f32 v79, v182, v183
    v_cvt_pk_bf16_f32 v83, v186, v187
    buffer_store_dwordx4 v[76:79], v3, s[4:7], s34 offen sc1
    buffer_store_dwordx2 v[82:83], v12, s[4:7], s36 offen sc1
    v_rcp_f32 v200, v200
    s_nop 0
    v_mul_f32 v192, v192, v200
    v_mul_f32 v193, v193, v200
    v_mul_f32 v194, v194, v200
    v_mul_f32 v195, v195, v200
    v_mul_f32 v196, v196, v200
    v_mul_f32 v197, v197, v200
    v_cvt_pk_bf16_f32 v72, v192, v193
    v_cvt_pk_bf16_f32 v73, v194, v195
    v_cvt_pk_bf16_f32 v80, v196, v197
    v_rcp_f32 v212, v212
    s_nop 0
    v_mul_f32 v204, v204, v212
    v_mul_f32 v205, v205, v212
    v_mul_f32 v206, v206, v212
    v_mul_f32 v207, v207, v212
    v_mul_f32 v210, v210, v212
    v_mul_f32 v211, v211, v212
    v_cvt_pk_bf16_f32 v74, v204, v205
    v_cvt_pk_bf16_f32 v75, v206, v207
    v_cvt_pk_bf16_f32 v81, v210, v211
    buffer_store_dwordx4 v[72:75], v3, s[4:7], s33 offen sc1
    buffer_store_dwordx2 v[80:81], v12, s[4:7], s35 offen sc1
    v_cmp_eq_u32 vcc, 0, v1
    s_nop 1
    v_cndmask_b32 v252, 0, 1, vcc
    v_mov_b32 v255, 16
    v_sub_u32 v253, v255, v252
    s_waitcnt vmcnt(0)
    s_barrier
    s_cmp_lg_u32 s3, 0
    s_cbranch_scc1 main_kernel_sa0
    s_mov_b64 exec, 1
    buffer_atomic_add v252, v254, s[4:7], s11 offen
    s_mov_b64 exec, -1
main_kernel_sa0:
    s_mul_i32 s54, s3, 6144
    s_mul_i32 s55, s9, 737280
    s_add_u32 s55, s55, s54
    s_add_u32 s55, s55, 92688384
    s_sub_u32 s55, s55, s59
    s_lshr_b32 s12, s9, 2
    s_lshl_b32 s13, s8, 3
    s_lshl_b32 s14, s12, 1
    s_add_u32 s13, s13, s14
    s_mul_i32 s15, s13, 18432
    s_lshl_b32 s16, s43, 10
    s_add_u32 s16, s16, s15
    s_lshl_b32 s17, s46, 10
    s_add_u32 s17, s17, s15
    s_mul_i32 s18, s41, 18432
    s_add_u32 s17, s17, s18
    s_add_u32 s19, s16, 32768
    s_lshl_b32 s20, s3, 3
    s_add_u32 s20, s20, s17
    s_add_u32 s20, s20, 32768
    s_cmp_ge_u32 s3, 2
    s_cselect_b32 s20, 268435456, s20
    s_mul_i32 s21, s3, 9216
    s_add_u32 s22, s15, s21
    s_add_u32 s22, s22, 2457600
    s_add_u32 s21, s21, 98304
    v_add_u32 v9, 98304, v3
    v_add_u32 v10, s18, v9
    v_add_u32 v7, 114688, v6
    v_add_u32 v8, 18432, v7
    v_add_u32 v14, s18, v7
    s_mov_b32 s101, main_kernel_c0-main_kernel_pc
    s_load_dword s100, s[98:99], s101
    s_load_dword s100, s[98:99], s101 offset:64
    buffer_load_dwordx4 v[88:91], v3, s[4:7], s19 offen sc1
    buffer_load_dwordx4 v[92:95], v15, s[4:7], s19 offen sc1
    buffer_load_dwordx2 v[96:97], v3, s[4:7], s20 offen sc1
    buffer_load_dwordx4 a[60:63], v242, s[4:7], s47 offen offset:3072
    buffer_load_dwordx4 a[132:135], v242, s[4:7], s48 offen offset:3072
    buffer_load_dwordx4 a[64:67], v243, s[4:7], s47 offen offset:0
    buffer_load_dwordx4 a[136:139], v243, s[4:7], s48 offen offset:0
    buffer_load_dwordx4 a[68:71], v243, s[4:7], s47 offen offset:1024
    buffer_load_dwordx4 a[140:143], v243, s[4:7], s48 offen offset:1024
    s_cmp_lg_u32 s3, 0
    s_cbranch_scc1 main_kernel_sb0
    s_mov_b64 exec, 1
main_kernel_sp0:
    buffer_load_dword v252, v254, s[4:7], s11 offen sc1
    s_add_u32 s57, s57, 1
    s_waitcnt vmcnt(0)
    v_cmp_gt_u32 vcc, v255, v252
    s_nop 4
    s_cbranch_vccz main_kernel_sq0
    s_cmp_lt_u32 s57, 0x40000
    s_cbranch_scc1 main_kernel_sp0
main_kernel_sq0:
    s_mov_b64 exec, -1
main_kernel_sb0:
    s_waitcnt vmcnt(0) lgkmcnt(0)
    s_barrier
    s_mov_b32 m0, s21
    s_nop 0
    buffer_load_dwordx4 v3, s[4:7], s22 offen offset:0 sc1 lds
    buffer_load_dwordx4 v3, s[4:7], s22 offen offset:1024 sc1 lds
    buffer_load_dwordx4 v3, s[4:7], s22 offen offset:2048 sc1 lds
    s_add_u32 s22, s22, 3072
    s_add_u32 m0, m0, 3072
    s_nop 0
    buffer_load_dwordx4 v3, s[4:7], s22 offen offset:0 sc1 lds
    buffer_load_dwordx4 v3, s[4:7], s22 offen offset:1024 sc1 lds
    buffer_load_dwordx4 v3, s[4:7], s22 offen offset:2048 sc1 lds
    s_add_u32 s22, s22, 3072
    s_add_u32 m0, m0, 3072
    s_nop 0
    buffer_load_dwordx4 v3, s[4:7], s22 offen offset:0 sc1 lds
    buffer_load_dwordx4 v3, s[4:7], s22 offen offset:1024 sc1 lds
    buffer_load_dwordx4 v3, s[4:7], s22 offen offset:2048 sc1 lds
    v_lshlrev_b32 v16, 16, v88
    v_and_b32 v17, 0xffff0000, v88
    v_lshlrev_b32 v18, 16, v89
    v_and_b32 v19, 0xffff0000, v89
    v_lshlrev_b32 v24, 16, v90
    v_and_b32 v25, 0xffff0000, v90
    v_lshlrev_b32 v26, 16, v91
    v_and_b32 v27, 0xffff0000, v91
    v_lshlrev_b32 v20, 16, v92
    v_and_b32 v21, 0xffff0000, v92
    v_lshlrev_b32 v22, 16, v93
    v_and_b32 v23, 0xffff0000, v93
    v_lshlrev_b32 v28, 16, v94
    v_and_b32 v29, 0xffff0000, v94
    v_lshlrev_b32 v30, 16, v95
    v_and_b32 v31, 0xffff0000, v95
    v_lshlrev_b32 v32, 16, v96
    v_and_b32 v33, 0xffff0000, v96
    v_lshlrev_b32 v34, 16, v97
    v_and_b32 v35, 0xffff0000, v97
    s_add_u32 s19, s16, 4816896
    s_add_u32 s20, s17, 4816896
    s_cmp_lg_u32 s3, 2
    s_cselect_b32 s20, 268435456, s20
    s_and_b32 s26, s3, 1
    s_cmp_eq_u32 s41, 0
    s_cselect_b32 s23, 1.0, 0
    s_cselect_b32 s24, 0, 1.0
    s_lshl_b32 s25, s3, 10
    s_add_u32 s25, s25, 147456
    v_add_u32 v11, s25, v3
    s_lshl_b32 s25, s26, 3
    s_add_u32 s25, s25, 147456
    v_add_u32 v12, s25, v3
    v_add_u32 v124, 151552, v3
    s_lshl_b32 s25, s26, 3
    s_lshr_b32 s27, s3, 1
    s_lshl_b32 s27, s27, 10
    s_add_u32 s25, s25, s27
    v_add_u32 v125, s25, v124
    s_add_u32 s25, s13, s26
    s_lshl_b32 s25, s25, 9
    s_lshl_b32 s27, s40, 7
    s_add_u32 s25, s25, s27
    s_add_u32 s25, s25, 7176192
    s_cmp_ge_u32 s3, 2
    s_cselect_b32 s25, 268435456, s25
    v_mov_b32 v13, 0x40000000
    v_cmp_eq_u32 vcc, 0, v5
    s_nop 1
    v_cndmask_b32 v13, v13, v6, vcc
    s_waitcnt vmcnt(0)
    s_barrier
    ds_read_b128 v[40:43], v9 offset:0
    ds_read_b128 v[44:47], v9 offset:18432
    ds_read_b128 v[48:51], v10 offset:0
    ds_read_b128 v[52:55], v9 offset:1024
    ds_read_b128 v[56:59], v9 offset:19456
    ds_read_b128 v[60:63], v10 offset:1024
    ds_read_b128 v[64:67], v9 offset:2048
    ds_read_b128 v[68:71], v9 offset:20480
    ds_read_b128 v[72:75], v10 offset:2048
    s_waitcnt lgkmcnt(6)
    v_mfma_f32_16x16x32_bf16 v[16:19], a[0:3], v[40:43], v[16:19]
    ds_read_b128 v[76:79], v9 offset:3072
    v_mfma_f32_16x16x32_bf16 v[20:23], a[0:3], v[44:47], v[20:23]
    ds_read_b128 v[80:83], v9 offset:21504
    v_mfma_f32_16x16x32_bf16 v[24:27], a[72:75], v[40:43], v[24:27]
    ds_read_b128 v[84:87], v10 offset:3072
    v_mfma_f32_16x16x32_bf16 v[28:31], a[72:75], v[44:47], v[28:31]
    s_add_u32 m0, s54, 0
    s_add_u32 s55, s55, 20480
    buffer_load_dwordx4 v3, s[4:7], s55 offen offset:0 sc1 lds
    v_mfma_f32_16x16x32_bf16 v[32:35], a[144:147], v[48:51], v[32:35]
    s_waitcnt lgkmcnt(6)
    v_mfma_f32_16x16x32_bf16 v[16:19], a[4:7], v[52:55], v[16:19]
    ds_read_b128 v[40:43], v9 offset:4096
    v_mfma_f32_16x16x32_bf16 v[20:23], a[4:7], v[56:59], v[20:23]
    ds_read_b128 v[44:47], v9 offset:22528
    v_mfma_f32_16x16x32_bf16 v[24:27], a[76:79], v[52:55], v[24:27]
    ds_read_b128 v[48:51], v10 offset:4096
    v_mfma_f32_16x16x32_bf16 v[28:31], a[76:79], v[56:59], v[28:31]
    buffer_load_dwordx4 v3, s[4:7], s55 offen offset:1024 sc1 lds
    v_mfma_f32_16x16x32_bf16 v[32:35], a[148:151], v[60:63], v[32:35]
    s_waitcnt lgkmcnt(6)
    v_mfma_f32_16x16x32_bf16 v[16:19], a[8:11], v[64:67], v[16:19]
    ds_read_b128 v[52:55], v9 offset:5120
    v_mfma_f32_16x16x32_bf16 v[20:23], a[8:11], v[68:71], v[20:23]
    ds_read_b128 v[56:59], v9 offset:23552
    v_mfma_f32_16x16x32_bf16 v[24:27], a[80:83], v[64:67], v[24:27]
    ds_read_b128 v[60:63], v10 offset:5120
    v_mfma_f32_16x16x32_bf16 v[28:31], a[80:83], v[68:71], v[28:31]
    buffer_load_dwordx4 v3, s[4:7], s55 offen offset:2048 sc1 lds
    v_mfma_f32_16x16x32_bf16 v[32:35], a[152:155], v[72:75], v[32:35]
    s_waitcnt lgkmcnt(6)
    v_mfma_f32_16x16x32_bf16 v[16:19], a[12:15], v[76:79], v[16:19]
    ds_read_b128 v[64:67], v9 offset:6144
    v_mfma_f32_16x16x32_bf16 v[20:23], a[12:15], v[80:83], v[20:23]
    ds_read_b128 v[68:71], v9 offset:24576
    v_mfma_f32_16x16x32_bf16 v[24:27], a[84:87], v[76:79], v[24:27]
    ds_read_b128 v[72:75], v10 offset:6144
    v_mfma_f32_16x16x32_bf16 v[28:31], a[84:87], v[80:83], v[28:31]
    buffer_load_dwordx4 v3, s[4:7], s55 offen offset:3072 sc1 lds
    v_mfma_f32_16x16x32_bf16 v[32:35], a[156:159], v[84:87], v[32:35]
    s_waitcnt lgkmcnt(6)
    v_mfma_f32_16x16x32_bf16 v[16:19], a[16:19], v[40:43], v[16:19]
    ds_read_b128 v[76:79], v9 offset:7168
    v_mfma_f32_16x16x32_bf16 v[20:23], a[16:19], v[44:47], v[20:23]
    ds_read_b128 v[80:83], v9 offset:25600
    v_mfma_f32_16x16x32_bf16 v[24:27], a[88:91], v[40:43], v[24:27]
    ds_read_b128 v[84:87], v10 offset:7168
    v_mfma_f32_16x16x32_bf16 v[28:31], a[88:91], v[44:47], v[28:31]
    s_add_u32 m0, m0, 4096
    s_add_u32 s55, s55, 4096
    buffer_load_dwordx4 v3, s[4:7], s55 offen offset:0 sc1 lds
    v_mfma_f32_16x16x32_bf16 v[32:35], a[160:163], v[48:51], v[32:35]
    s_waitcnt lgkmcnt(6)
    v_mfma_f32_16x16x32_bf16 v[16:19], a[20:23], v[52:55], v[16:19]
    ds_read_b128 v[40:43], v9 offset:8192
    v_mfma_f32_16x16x32_bf16 v[20:23], a[20:23], v[56:59], v[20:23]
    ds_read_b128 v[44:47], v9 offset:26624
    v_mfma_f32_16x16x32_bf16 v[24:27], a[92:95], v[52:55], v[24:27]
    ds_read_b128 v[48:51], v10 offset:8192
    v_mfma_f32_16x16x32_bf16 v[28:31], a[92:95], v[56:59], v[28:31]
    buffer_load_dwordx4 v3, s[4:7], s55 offen offset:1024 sc1 lds
    v_mfma_f32_16x16x32_bf16 v[32:35], a[164:167], v[60:63], v[32:35]
    s_waitcnt lgkmcnt(6)
    v_mfma_f32_16x16x32_bf16 v[16:19], a[24:27], v[64:67], v[16:19]
    ds_read_b128 v[52:55], v9 offset:9216
    v_mfma_f32_16x16x32_bf16 v[20:23], a[24:27], v[68:71], v[20:23]
    ds_read_b128 v[56:59], v9 offset:27648
    v_mfma_f32_16x16x32_bf16 v[24:27], a[96:99], v[64:67], v[24:27]
    ds_read_b128 v[60:63], v10 offset:9216
    v_mfma_f32_16x16x32_bf16 v[28:31], a[96:99], v[68:71], v[28:31]
    s_add_u32 m0, s54, 24576
    s_add_u32 s55, s55, 20480
    buffer_load_dwordx4 v3, s[4:7], s55 offen offset:0 sc1 lds
    v_mfma_f32_16x16x32_bf16 v[32:35], a[168:171], v[72:75], v[32:35]
    s_waitcnt lgkmcnt(6)
    v_mfma_f32_16x16x32_bf16 v[16:19], a[28:31], v[76:79], v[16:19]
    ds_read_b128 v[64:67], v9 offset:10240
    v_mfma_f32_16x16x32_bf16 v[20:23], a[28:31], v[80:83], v[20:23]
    ds_read_b128 v[68:71], v9 offset:28672
    v_mfma_f32_16x16x32_bf16 v[24:27], a[100:103], v[76:79], v[24:27]
    ds_read_b128 v[72:75], v10 offset:10240
    v_mfma_f32_16x16x32_bf16 v[28:31], a[100:103], v[80:83], v[28:31]
    buffer_load_dwordx4 v3, s[4:7], s55 offen offset:1024 sc1 lds
    v_mfma_f32_16x16x32_bf16 v[32:35], a[172:175], v[84:87], v[32:35]
    s_waitcnt lgkmcnt(6)
    v_mfma_f32_16x16x32_bf16 v[16:19], a[32:35], v[40:43], v[16:19]
    ds_read_b128 v[76:79], v9 offset:11264
    v_mfma_f32_16x16x32_bf16 v[20:23], a[32:35], v[44:47], v[20:23]
    ds_read_b128 v[80:83], v9 offset:29696
    v_mfma_f32_16x16x32_bf16 v[24:27], a[104:107], v[40:43], v[24:27]
    ds_read_b128 v[84:87], v10 offset:11264
    v_mfma_f32_16x16x32_bf16 v[28:31], a[104:107], v[44:47], v[28:31]
    buffer_load_dwordx4 v3, s[4:7], s55 offen offset:2048 sc1 lds
    v_mfma_f32_16x16x32_bf16 v[32:35], a[176:179], v[48:51], v[32:35]
    s_waitcnt lgkmcnt(6)
    v_mfma_f32_16x16x32_bf16 v[16:19], a[36:39], v[52:55], v[16:19]
    ds_read_b128 v[40:43], v9 offset:12288
    v_mfma_f32_16x16x32_bf16 v[20:23], a[36:39], v[56:59], v[20:23]
    ds_read_b128 v[44:47], v9 offset:30720
    v_mfma_f32_16x16x32_bf16 v[24:27], a[108:111], v[52:55], v[24:27]
    ds_read_b128 v[48:51], v10 offset:12288
    v_mfma_f32_16x16x32_bf16 v[28:31], a[108:111], v[56:59], v[28:31]
    buffer_load_dwordx4 v3, s[4:7], s55 offen offset:3072 sc1 lds
    v_mfma_f32_16x16x32_bf16 v[32:35], a[180:183], v[60:63], v[32:35]
    s_waitcnt lgkmcnt(6)
    v_mfma_f32_16x16x32_bf16 v[16:19], a[40:43], v[64:67], v[16:19]
    ds_read_b128 v[52:55], v9 offset:13312
    v_mfma_f32_16x16x32_bf16 v[20:23], a[40:43], v[68:71], v[20:23]
    ds_read_b128 v[56:59], v9 offset:31744
    v_mfma_f32_16x16x32_bf16 v[24:27], a[112:115], v[64:67], v[24:27]
    ds_read_b128 v[60:63], v10 offset:13312
    v_mfma_f32_16x16x32_bf16 v[28:31], a[112:115], v[68:71], v[28:31]
    s_add_u32 m0, m0, 4096
    s_add_u32 s55, s55, 4096
    buffer_load_dwordx4 v3, s[4:7], s55 offen offset:0 sc1 lds
    v_mfma_f32_16x16x32_bf16 v[32:35], a[184:187], v[72:75], v[32:35]
    s_waitcnt lgkmcnt(6)
    v_mfma_f32_16x16x32_bf16 v[16:19], a[44:47], v[76:79], v[16:19]
    ds_read_b128 v[64:67], v9 offset:14336
    v_mfma_f32_16x16x32_bf16 v[20:23], a[44:47], v[80:83], v[20:23]
    ds_read_b128 v[68:71], v9 offset:32768
    v_mfma_f32_16x16x32_bf16 v[24:27], a[116:119], v[76:79], v[24:27]
    ds_read_b128 v[72:75], v10 offset:14336
    v_mfma_f32_16x16x32_bf16 v[28:31], a[116:119], v[80:83], v[28:31]
    buffer_load_dwordx4 v3, s[4:7], s55 offen offset:1024 sc1 lds
    v_mfma_f32_16x16x32_bf16 v[32:35], a[188:191], v[84:87], v[32:35]
    s_waitcnt lgkmcnt(6)
    v_mfma_f32_16x16x32_bf16 v[16:19], a[48:51], v[40:43], v[16:19]
    ds_read_b128 v[76:79], v9 offset:15360
    v_mfma_f32_16x16x32_bf16 v[20:23], a[48:51], v[44:47], v[20:23]
    ds_read_b128 v[80:83], v9 offset:33792
    v_mfma_f32_16x16x32_bf16 v[24:27], a[120:123], v[40:43], v[24:27]
    ds_read_b128 v[84:87], v10 offset:15360
    v_mfma_f32_16x16x32_bf16 v[28:31], a[120:123], v[44:47], v[28:31]
    s_add_u32 m0, s54, 49152
    s_add_u32 s55, s55, 20480
    buffer_load_dwordx4 v3, s[4:7], s55 offen offset:0 sc1 lds
    v_mfma_f32_16x16x32_bf16 v[32:35], a[192:195], v[48:51], v[32:35]
    s_waitcnt lgkmcnt(6)
    v_mfma_f32_16x16x32_bf16 v[16:19], a[52:55], v[52:55], v[16:19]
    ds_read2_b64 v[40:43], v7 offset0:0 offset1:64
    v_mfma_f32_16x16x32_bf16 v[20:23], a[52:55], v[56:59], v[20:23]
    ds_read2_b64 v[44:47], v8 offset0:0 offset1:64
    v_mfma_f32_16x16x32_bf16 v[24:27], a[124:127], v[52:55], v[24:27]
    ds_read2_b64 v[48:51], v14 offset0:0 offset1:64
    v_mfma_f32_16x16x32_bf16 v[28:31], a[124:127], v[56:59], v[28:31]
    buffer_load_dwordx4 v3, s[4:7], s55 offen offset:1024 sc1 lds
    v_mfma_f32_16x16x32_bf16 v[32:35], a[196:199], v[60:63], v[32:35]
    s_waitcnt lgkmcnt(6)
    v_mfma_f32_16x16x32_bf16 v[16:19], a[56:59], v[64:67], v[16:19]
    ds_read2_b64 v[52:55], v7 offset0:128 offset1:192
    v_mfma_f32_16x16x32_bf16 v[20:23], a[56:59], v[68:71], v[20:23]
    ds_read2_b64 v[56:59], v8 offset0:128 offset1:192
    v_mfma_f32_16x16x32_bf16 v[24:27], a[128:131], v[64:67], v[24:27]
    ds_read2_b64 v[60:63], v14 offset0:128 offset1:192
    v_mfma_f32_16x16x32_bf16 v[28:31], a[128:131], v[68:71], v[28:31]
    buffer_load_dwordx4 v3, s[4:7], s55 offen offset:2048 sc1 lds
    v_mfma_f32_16x16x32_bf16 v[32:35], a[200:203], v[72:75], v[32:35]
    s_waitcnt lgkmcnt(6)
    v_mfma_f32_16x16x32_bf16 v[16:19], a[60:63], v[76:79], v[16:19]
    v_mfma_f32_16x16x32_bf16 v[20:23], a[60:63], v[80:83], v[20:23]
    v_mfma_f32_16x16x32_bf16 v[24:27], a[132:135], v[76:79], v[24:27]
    v_mfma_f32_16x16x32_bf16 v[28:31], a[132:135], v[80:83], v[28:31]
    buffer_load_dwordx4 v3, s[4:7], s55 offen offset:3072 sc1 lds
    v_mfma_f32_16x16x32_bf16 v[32:35], a[204:207], v[84:87], v[32:35]
    s_waitcnt lgkmcnt(3)
    v_mfma_f32_16x16x32_bf16 v[16:19], a[64:67], v[40:43], v[16:19]
    v_mfma_f32_16x16x32_bf16 v[20:23], a[64:67], v[44:47], v[20:23]
    v_mfma_f32_16x16x32_bf16 v[24:27], a[136:139], v[40:43], v[24:27]
    v_mfma_f32_16x16x32_bf16 v[28:31], a[136:139], v[44:47], v[28:31]
    s_add_u32 m0, m0, 4096
    s_add_u32 s55, s55, 4096
    buffer_load_dwordx4 v3, s[4:7], s55 offen offset:0 sc1 lds
    v_mfma_f32_16x16x32_bf16 v[32:35], a[208:211], v[48:51], v[32:35]
    s_waitcnt lgkmcnt(0)
    v_mfma_f32_16x16x32_bf16 v[16:19], a[68:71], v[52:55], v[16:19]
    v_mfma_f32_16x16x32_bf16 v[20:23], a[68:71], v[56:59], v[20:23]
    v_mfma_f32_16x16x32_bf16 v[24:27], a[140:143], v[52:55], v[24:27]
    v_mfma_f32_16x16x32_bf16 v[28:31], a[140:143], v[56:59], v[28:31]
    buffer_load_dwordx4 v3, s[4:7], s55 offen offset:1024 sc1 lds
    v_mfma_f32_16x16x32_bf16 v[32:35], a[212:215], v[60:63], v[32:35]
    s_nop 2
    v_cvt_pk_bf16_f32 v100, v16, v17
    v_cvt_pk_bf16_f32 v101, v18, v19
    v_cvt_pk_bf16_f32 v102, v24, v25
    v_cvt_pk_bf16_f32 v103, v26, v27
    buffer_store_dwordx4 v[100:103], v3, s[4:7], s19 offen sc1
    v_cvt_pk_bf16_f32 v104, v20, v21
    v_cvt_pk_bf16_f32 v105, v22, v23
    v_cvt_pk_bf16_f32 v106, v28, v29
    v_cvt_pk_bf16_f32 v107, v30, v31
    buffer_store_dwordx4 v[104:107], v15, s[4:7], s19 offen sc1
    v_cvt_pk_bf16_f32 v108, v32, v33
    v_cvt_pk_bf16_f32 v109, v34, v35
    ds_write_b64 v125, v[108:109]
    v_add_f32 v112, v16, v17
    v_mul_f32 v113, v16, v16
    v_fmac_f32 v113, v17, v17
    v_add_f32 v112, v112, v18
    v_fmac_f32 v113, v18, v18
    v_add_f32 v112, v112, v19
    v_fmac_f32 v113, v19, v19
    v_add_f32 v112, v112, v24
    v_fmac_f32 v113, v24, v24
    v_add_f32 v112, v112, v25
    v_fmac_f32 v113, v25, v25
    v_add_f32 v112, v112, v26
    v_fmac_f32 v113, v26, v26
    v_add_f32 v112, v112, v27
    v_fmac_f32 v113, v27, v27
    v_add_f32 v114, v20, v21
    v_mul_f32 v115, v20, v20
    v_fmac_f32 v115, v21, v21
    v_add_f32 v114, v114, v22
    v_fmac_f32 v115, v22, v22
    v_add_f32 v114, v114, v23
    v_fmac_f32 v115, v23, v23
    v_add_f32 v114, v114, v28
    v_fmac_f32 v115, v28, v28
    v_add_f32 v114, v114, v29
    v_fmac_f32 v115, v29, v29
    v_add_f32 v114, v114, v30
    v_fmac_f32 v115, v30, v30
    v_add_f32 v114, v114, v31
    v_fmac_f32 v115, v31, v31
    v_add_f32 v116, v32, v33
    v_mul_f32 v117, v32, v32
    v_fmac_f32 v117, v33, v33
    v_add_f32 v116, v116, v34
    v_fmac_f32 v117, v34, v34
    v_add_f32 v116, v116, v35
    v_fmac_f32 v117, v35, v35
    v_fmac_f32 v112, s23, v116
    v_fmac_f32 v113, s23, v117
    v_fmac_f32 v114, s24, v116
    v_fmac_f32 v115, s24, v117
    ds_write_b128 v11, v[112:115]
    s_waitcnt lgkmcnt(0)
    s_barrier
    ds_read_b128 v[128:131], v124
    ds_read_b64 v[132:133], v12 offset:0
    ds_read_b64 v[134:135], v12 offset:1024
    ds_read_b64 v[136:137], v12 offset:2048
    ds_read_b64 v[138:139], v12 offset:3072
    s_waitcnt lgkmcnt(4)
    buffer_store_dwordx4 v[128:131], v3, s[4:7], s20 offen sc1
    s_waitcnt lgkmcnt(0)
    v_add_f32 v132, v132, v134
    v_add_f32 v136, v136, v138
    v_add_f32 v133, v133, v135
    v_add_f32 v137, v137, v139
    v_add_f32 v132, v132, v136
    v_add_f32 v133, v133, v137
    v_mov_b32 v134, v132
    v_mov_b32 v135, v133
    s_nop 0
    v_permlane16_swap_b32 v132, v134
    v_permlane16_swap_b32 v133, v135
    v_add_f32 v132, v132, v134
    v_add_f32 v133, v133, v135
    v_mov_b32 v134, v132
    v_mov_b32 v135, v133
    s_nop 0
    v_permlane32_swap_b32 v132, v134
    v_permlane32_swap_b32 v133, v135
    v_add_f32 v132, v132, v134
    v_add_f32 v133, v133, v135
    buffer_store_dwordx2 v[132:133], v13, s[4:7], s25 offen sc1
    v_cmp_eq_u32 vcc, 0, v1
    s_nop 1
    v_cndmask_b32 v252, 0, 1, vcc
    v_mov_b32 v255, 32
    v_sub_u32 v253, v255, v252
    s_waitcnt vmcnt(0)
    s_barrier
    s_cmp_lg_u32 s3, 0
    s_cbranch_scc1 main_kernel_sa1
    s_mov_b64 exec, 1
    buffer_atomic_add v252, v254, s[4:7], s11 offen
    s_mov_b64 exec, -1
main_kernel_sa1:
    v_add_u32 v4, 0x10000, v3
    v_add_u32 v5, 0x20000, v3
    v_mov_b32 v7, v6
    s_and_b32 s29, s9, 1
    s_mul_i32 s16, s29, 18432
    v_add_u32 v14, s16, v3
    s_sub_u32 s16, 18432, s16
    v_add_u32 v6, s16, v3
    v_lshlrev_b32 v15, 6, v1
    s_lshl_b32 s16, s8, 3
    s_lshl_b32 s17, s3, 1
    s_add_u32 s16, s16, s17
    s_mul_i32 s17, s16, 18432
    s_add_u32 s18, s17, 4816896
    s_add_u32 s21, s16, s29
    s_lshl_b32 s21, s21, 9
    s_add_u32 s21, s21, 7176192
    s_xor_b32 s19, s21, 512
    s_lshl_b32 s22, s8, 4
    s_add_u32 s22, s22, s9
    s_lshl_b32 s22, s22, 2
    s_add_u32 s22, s22, s3
    s_mul_i32 s24, s22, 18432
    s_add_u32 s24, s24, 26116096
    s_xor_b32 s23, s22, 4
    s_mul_i32 s25, s23, 18432
    s_add_u32 s25, s25, 26116096
    s_xor_b32 s23, s22, 8
    s_mul_i32 s34, s23, 18432
    s_add_u32 s34, s34, 26116096
    s_xor_b32 s23, s22, 12
    s_mul_i32 s35, s23, 18432
    s_add_u32 s35, s35, 26116096
    s_lshl_b32 s26, s22, 4
    s_add_u32 s26, s26, 0
    s_andn2_b32 s27, s26, 192
    s_lshr_b32 s28, s9, 2
    s_mul_i32 s28, s28, 2359296
    s_add_u32 s28, s28, s17
    s_add_u32 s28, s28, 7241728
    s_lshl_b32 s36, s46, 10
    s_add_u32 s36, s36, s28
    s_lshl_b32 s23, s42, 10
    s_add_u32 s28, s28, s23
    s_and_b32 s58, s8, 7
    s_lshl_b32 s58, s58, 2
    s_add_u32 s58, s58, s3
    s_lshl_b32 s58, s58, 12
    s_mul_i32 s32, s9, 737280
    s_add_u32 s32, s32, s58
    s_add_u32 s32, s32, 92839936
    s_sub_u32 s32, s32, s59
    s_mul_i32 s33, s9, 129024
    s_add_u32 s33, s33, s58
    s_add_u32 s33, s33, 89980928
    s_cmp_lg_u32 s59, 0
    s_cselect_b32 s33, 268435456, s33
    s_add_u32 s31, s10, 64
    s_cmp_lg_u32 s3, 0
    s_cselect_b32 s31, 268435456, s31
    s_lshl_b32 s12, s8, 4
    s_add_u32 s12, s12, s9
    s_mul_i32 s12, s12, 9
    s_add_u32 s12, s12, s3
    s_lshl_b32 s12, s12, 10
    s_lshl_b32 s50, s3, 11
    s_mul_i32 s51, s9, 129024
    s_add_u32 s51, s51, s50
    s_add_u32 s51, s51, 89980928
    s_cmp_lg_u32 s59, 0
    s_cselect_b32 s51, 268435456, s51
    s_cmp_eq_u32 s3, 3
    s_cselect_b32 s56, 0, 1024
    s_add_u32 s52, s51, s56
    s_add_u32 s53, s50, s56
    s_add_u32 m0, s54, 73728
    s_add_u32 s55, s55, 20480
    buffer_load_dwordx4 v3, s[4:7], s55 offen offset:0 sc1 lds
    buffer_load_dwordx4 v3, s[4:7], s55 offen offset:1024 sc1 lds
    buffer_load_dwordx4 v3, s[4:7], s55 offen offset:2048 sc1 lds
    buffer_load_dwordx4 v3, s[4:7], s55 offen offset:3072 sc1 lds
    s_add_u32 m0, m0, 4096
    s_add_u32 s55, s55, 4096
    buffer_load_dwordx4 v3, s[4:7], s55 offen offset:0 sc1 lds
    buffer_load_dwordx4 v3, s[4:7], s55 offen offset:1024 sc1 lds
    s_cmp_lg_u32 s3, 0
    s_cbranch_scc1 main_kernel_sb1
    s_mov_b64 exec, 1
main_kernel_sp1:
    buffer_load_dword v252, v254, s[4:7], s11 offen sc1
    s_add_u32 s57, s57, 1
    s_waitcnt vmcnt(0)
    v_cmp_gt_u32 vcc, v255, v252
    s_nop 4
    s_cbranch_vccz main_kernel_sq1
    s_cmp_lt_u32 s57, 0x40000
    s_cbranch_scc1 main_kernel_sp1
main_kernel_sq1:
    s_mov_b64 exec, -1
main_kernel_sb1:
    s_waitcnt vmcnt(0) lgkmcnt(0)
    s_barrier
main_kernel_c0:
    buffer_load_dwordx2 v[16:17], v7, s[4:7], s21 offen sc1
    buffer_load_dwordx2 v[18:19], v7, s[4:7], s19 offen sc1
    buffer_load_dwordx4 a[0:3], v14, s[4:7], s18 offen offset:0 sc1
    buffer_load_dwordx4 a[72:75], v6, s[4:7], s18 offen offset:0 sc1
    buffer_load_dwordx4 a[4:7], v14, s[4:7], s18 offen offset:1024 sc1
    buffer_load_dwordx4 a[76:79], v6, s[4:7], s18 offen offset:1024 sc1
    buffer_load_dwordx4 a[8:11], v14, s[4:7], s18 offen offset:2048 sc1
    buffer_load_dwordx4 a[80:83], v6, s[4:7], s18 offen offset:2048 sc1
    buffer_load_dwordx4 a[12:15], v14, s[4:7], s18 offen offset:3072 sc1
    buffer_load_dwordx4 a[84:87], v6, s[4:7], s18 offen offset:3072 sc1
    s_add_u32 s18, s18, 4096
    buffer_load_dwordx4 a[16:19], v14, s[4:7], s18 offen offset:0 sc1
    buffer_load_dwordx4 a[88:91], v6, s[4:7], s18 offen offset:0 sc1
    buffer_load_dwordx4 a[20:23], v14, s[4:7], s18 offen offset:1024 sc1
    buffer_load_dwordx4 a[92:95], v6, s[4:7], s18 offen offset:1024 sc1
    ds_read_b128 v[32:35], v3 offset:0
    ds_read_b128 v[36:39], v3 offset:1024
    ds_read_b128 v[40:43], v3 offset:2048
    ds_read_b128 v[44:47], v3 offset:3072
    ds_read_b128 v[48:51], v3 offset:4096
    ds_read_b128 v[52:55], v3 offset:5120
    ds_read_b128 v[56:59], v3 offset:6144
    ds_read_b128 v[60:63], v3 offset:7168
    ds_read_b128 v[64:67], v3 offset:8192
    ds_read_b128 v[68:71], v3 offset:9216
    ds_read_b128 v[72:75], v3 offset:10240
    s_waitcnt vmcnt(10)
    s_waitcnt lgkmcnt(8)
    v_mfma_f32_16x16x32_bf16 v[84:87], v[32:35], a[0:3], 0
    buffer_load_dwordx4 a[24:27], v14, s[4:7], s18 offen offset:2048 sc1
    v_mov_b32 v7, 0
    v_mfma_f32_16x16x32_bf16 v[88:91], v[32:35], a[72:75], 0
    ds_read_b128 v[76:79], v3 offset:11264
    v_mov_b32 v236, 1
    v_mov_b32 v237, 2
    v_mfma_f32_16x16x32_bf16 v[92:95], v[36:39], a[0:3], 0
    buffer_load_dwordx4 a[96:99], v6, s[4:7], s18 offen offset:2048 sc1
    v_mov_b32 v238, 3
    v_mov_b32 v20, v16
    v_mfma_f32_16x16x32_bf16 v[96:99], v[36:39], a[72:75], 0
    ds_read_b128 v[80:83], v3 offset:12288
    v_mov_b32 v21, v17
    v_mov_b32 v22, v18
    v_mfma_f32_16x16x32_bf16 v[100:103], v[40:43], a[0:3], 0
    buffer_load_dwordx4 a[28:31], v14, s[4:7], s18 offen offset:3072 sc1
    v_mov_b32 v23, v19
    v_mfma_f32_16x16x32_bf16 v[104:107], v[40:43], a[72:75], 0
    s_waitcnt lgkmcnt(7)
    ds_read_b128 v[32:35], v3 offset:13312
    v_permlane16_swap_b32 v16, v20
    v_permlane16_swap_b32 v17, v21
    v_mfma_f32_16x16x32_bf16 v[108:111], v[44:47], a[0:3], 0
    buffer_load_dwordx4 a[100:103], v6, s[4:7], s18 offen offset:3072 sc1
    v_permlane16_swap_b32 v18, v22
    v_permlane16_swap_b32 v19, v23
    v_mfma_f32_16x16x32_bf16 v[112:115], v[44:47], a[72:75], 0
    s_waitcnt vmcnt(12)
    ds_read_b128 v[36:39], v3 offset:14336
    v_add_f32 v16, v16, v20
    v_add_f32 v17, v17, v21
    v_mfma_f32_16x16x32_bf16 v[84:87], v[48:51], a[4:7], v[84:87]
    s_add_u32 s18, s18, 4096
    buffer_load_dwordx4 a[32:35], v14, s[4:7], s18 offen offset:0 sc1
    v_add_f32 v18, v18, v22
    v_mfma_f32_16x16x32_bf16 v[88:91], v[48:51], a[76:79], v[88:91]
    ds_read_b128 v[40:43], v3 offset:15360
    v_add_f32 v19, v19, v23
    v_mov_b32 v20, v16
    v_mfma_f32_16x16x32_bf16 v[92:95], v[52:55], a[4:7], v[92:95]
    buffer_load_dwordx4 a[104:107], v6, s[4:7], s18 offen offset:0 sc1
    v_mov_b32 v21, v17
    v_mov_b32 v22, v18
    v_mfma_f32_16x16x32_bf16 v[96:99], v[52:55], a[76:79], v[96:99]
    s_waitcnt lgkmcnt(7)
    ds_read_b128 v[44:47], v3 offset:16384
    v_mov_b32 v23, v19
    v_permlane32_swap_b32 v16, v20
    v_mfma_f32_16x16x32_bf16 v[100:103], v[56:59], a[4:7], v[100:103]
    buffer_load_dwordx4 a[36:39], v14, s[4:7], s18 offen offset:1024 sc1
    v_permlane32_swap_b32 v17, v21
    v_mfma_f32_16x16x32_bf16 v[104:107], v[56:59], a[76:79], v[104:107]
    ds_read_b128 v[48:51], v3 offset:17408
    v_permlane32_swap_b32 v18, v22
    v_permlane32_swap_b32 v19, v23
    v_mfma_f32_16x16x32_bf16 v[108:111], v[60:63], a[4:7], v[108:111]
    buffer_load_dwordx4 a[108:111], v6, s[4:7], s18 offen offset:1024 sc1
    v_add_f32 v16, v16, v20
    v_add_f32 v17, v17, v21
    v_mfma_f32_16x16x32_bf16 v[112:115], v[60:63], a[76:79], v[112:115]
    s_waitcnt vmcnt(14)
    ds_read_b128 v[52:55], v3 offset:18432
    v_add_f32 v18, v18, v22
    v_add_f32 v19, v19, v23
    v_mfma_f32_16x16x32_bf16 v[84:87], v[64:67], a[8:11], v[84:87]
    buffer_load_dwordx4 a[40:43], v14, s[4:7], s18 offen offset:2048 sc1
    v_mul_f32 v16, 0x3ae38e39, v16
    v_mfma_f32_16x16x32_bf16 v[88:91], v[64:67], a[80:83], v[88:91]
    s_waitcnt lgkmcnt(7)
    ds_read_b128 v[56:59], v3 offset:19456
    v_mul_f32 v17, 0x3ae38e39, v17
    v_fma_f32 v17, -v16, v16, v17
    v_mfma_f32_16x16x32_bf16 v[92:95], v[68:71], a[8:11], v[92:95]
    buffer_load_dwordx4 a[112:115], v6, s[4:7], s18 offen offset:2048 sc1
    v_max_f32 v17, 0, v17
    v_add_f32 v20, 0x3727c5ac, v17
    v_mfma_f32_16x16x32_bf16 v[96:99], v[68:71], a[80:83], v[96:99]
    ds_read_b128 v[60:63], v3 offset:20480
    v_rsq_f32 v24, v20
    s_nop 0
    v_mul_f32 v20, v24, v24
    v_mfma_f32_16x16x32_bf16 v[100:103], v[72:75], a[8:11], v[100:103]
    buffer_load_dwordx4 a[44:47], v14, s[4:7], s18 offen offset:3072 sc1
    v_mul_f32 v20, v20, v17
    v_mfma_f32_16x16x32_bf16 v[104:107], v[72:75], a[80:83], v[104:107]
    ds_read_b128 v[64:67], v3 offset:21504
    v_add_f32 v20, 0x3727c5ac, v20
    v_rsq_f32 v20, v20
    v_mfma_f32_16x16x32_bf16 v[108:111], v[76:79], a[8:11], v[108:111]
    buffer_load_dwordx4 a[116:119], v6, s[4:7], s18 offen offset:3072 sc1
    v_mul_f32 v24, v24, v20
    v_mul_f32 v26, v16, v24
    v_mfma_f32_16x16x32_bf16 v[112:115], v[76:79], a[80:83], v[112:115]
    s_waitcnt vmcnt(16)
    s_waitcnt lgkmcnt(7)
    ds_read_b128 v[68:71], v3 offset:22528
    v_rcp_f32 v12, v24
    v_mul_f32 v8, 0xc0135761, v24
    v_mfma_f32_16x16x32_bf16 v[84:87], v[80:83], a[12:15], v[84:87]
    s_add_u32 s18, s18, 4096
    buffer_load_dwordx4 a[48:51], v14, s[4:7], s18 offen offset:0 sc1
    v_mul_f32 v10, v24, v24
    v_mfma_f32_16x16x32_bf16 v[88:91], v[80:83], a[84:87], v[88:91]
    ds_read_b128 v[72:75], v3 offset:23552
    v_mul_f32 v10, v10, v24
    v_mul_f32 v10, 0xbdd2d3e8, v10
    v_mfma_f32_16x16x32_bf16 v[92:95], v[32:35], a[12:15], v[92:95]
    buffer_load_dwordx4 a[120:123], v6, s[4:7], s18 offen offset:0 sc1
    v_cvt_pk_bf16_f32 v20, v12, v12
    v_and_b32 v20, 0xffff0000, v20
    v_mfma_f32_16x16x32_bf16 v[96:99], v[32:35], a[84:87], v[96:99]
    ds_read_b128 v[76:79], v3 offset:24576
    v_sub_f32 v20, v12, v20
    v_cvt_pk_bf16_f32 v244, v12, v20
    v_mfma_f32_16x16x32_bf16 v[100:103], v[36:39], a[12:15], v[100:103]
    buffer_load_dwordx4 a[52:55], v14, s[4:7], s18 offen offset:1024 sc1
    v_sub_f32 v16, 0, v16
    v_mfma_f32_16x16x32_bf16 v[104:107], v[36:39], a[84:87], v[104:107]
    s_waitcnt lgkmcnt(7)
    ds_read_b128 v[80:83], v3 offset:25600
    v_cvt_pk_bf16_f32 v245, v16, v16
    v_and_b32 v20, 0xffff0000, v245
    v_mfma_f32_16x16x32_bf16 v[108:111], v[40:43], a[12:15], v[108:111]
    buffer_load_dwordx4 a[124:127], v6, s[4:7], s18 offen offset:1024 sc1
    v_sub_f32 v20, v16, v20
    v_cvt_pk_bf16_f32 v246, v20, v7
    v_mfma_f32_16x16x32_bf16 v[112:115], v[40:43], a[84:87], v[112:115]
    s_waitcnt vmcnt(18)
    ds_read_b128 v[32:35], v3 offset:26624
    v_mov_b32 v247, 0
    v_mul_f32 v18, 0x3ae38e39, v18
    v_mfma_f32_16x16x32_bf16 v[84:87], v[44:47], a[16:19], v[84:87]
    buffer_load_dwordx4 a[56:59], v14, s[4:7], s18 offen offset:2048 sc1
    v_mul_f32 v19, 0x3ae38e39, v19
    v_mfma_f32_16x16x32_bf16 v[88:91], v[44:47], a[88:91], v[88:91]
    ds_read_b128 v[36:39], v3 offset:27648
    v_fma_f32 v19, -v18, v18, v19
    v_max_f32 v19, 0, v19
    v_mfma_f32_16x16x32_bf16 v[92:95], v[48:51], a[16:19], v[92:95]
    buffer_load_dwordx4 a[128:131], v6, s[4:7], s18 offen offset:2048 sc1
    v_add_f32 v21, 0x3727c5ac, v19
    v_rsq_f32 v25, v21
    v_mfma_f32_16x16x32_bf16 v[96:99], v[48:51], a[88:91], v[96:99]
    s_waitcnt lgkmcnt(7)
    ds_read_b128 v[40:43], v3 offset:28672
    v_mul_f32 v21, v25, v25
    v_mul_f32 v21, v21, v19
    v_mfma_f32_16x16x32_bf16 v[100:103], v[52:55], a[16:19], v[100:103]
    buffer_load_dwordx4 a[60:63], v14, s[4:7], s18 offen offset:3072 sc1
    v_add_f32 v21, 0x3727c5ac, v21
    v_mfma_f32_16x16x32_bf16 v[104:107], v[52:55], a[88:91], v[104:107]
    ds_read_b128 v[44:47], v3 offset:29696
    v_rsq_f32 v21, v21
    s_nop 0
    v_mul_f32 v25, v25, v21
    v_mfma_f32_16x16x32_bf16 v[108:111], v[56:59], a[16:19], v[108:111]
    buffer_load_dwordx4 a[132:135], v6, s[4:7], s18 offen offset:3072 sc1
    v_mul_f32 v27, v18, v25
    v_rcp_f32 v13, v25
    v_mfma_f32_16x16x32_bf16 v[112:115], v[56:59], a[88:91], v[112:115]
    s_waitcnt vmcnt(20)
    ds_read_b128 v[48:51], v3 offset:30720
    v_mul_f32 v9, 0xc0135761, v25
    v_mul_f32 v11, v25, v25
    v_mfma_f32_16x16x32_bf16 v[84:87], v[60:63], a[20:23], v[84:87]
    s_add_u32 s18, s18, 4096
    buffer_load_dwordx4 a[64:67], v14, s[4:7], s18 offen offset:0 sc1
    v_mul_f32 v11, v11, v25
    v_mfma_f32_16x16x32_bf16 v[88:91], v[60:63], a[92:95], v[88:91]
    s_waitcnt lgkmcnt(7)
    ds_read_b128 v[52:55], v3 offset:31744
    v_mul_f32 v11, 0xbdd2d3e8, v11
    v_cvt_pk_bf16_f32 v21, v13, v13
    v_mfma_f32_16x16x32_bf16 v[92:95], v[64:67], a[20:23], v[92:95]
    buffer_load_dwordx4 a[136:139], v6, s[4:7], s18 offen offset:0 sc1
    v_and_b32 v21, 0xffff0000, v21
    v_sub_f32 v21, v13, v21
    v_mfma_f32_16x16x32_bf16 v[96:99], v[64:67], a[92:95], v[96:99]
    ds_read_b128 v[56:59], v3 offset:32768
    v_cvt_pk_bf16_f32 v248, v13, v21
    v_sub_f32 v18, 0, v18
    v_mfma_f32_16x16x32_bf16 v[100:103], v[68:71], a[20:23], v[100:103]
    buffer_load_dwordx4 a[68:71], v14, s[4:7], s18 offen offset:1024 sc1
    v_cvt_pk_bf16_f32 v249, v18, v18
    v_mfma_f32_16x16x32_bf16 v[104:107], v[68:71], a[92:95], v[104:107]
    ds_read_b128 v[60:63], v3 offset:33792
    v_and_b32 v21, 0xffff0000, v249
    v_sub_f32 v21, v18, v21
    v_mfma_f32_16x16x32_bf16 v[108:111], v[72:75], a[20:23], v[108:111]
    buffer_load_dwordx4 a[140:143], v6, s[4:7], s18 offen offset:1024 sc1
    v_cvt_pk_bf16_f32 v250, v21, v7
    v_mov_b32 v251, 0
    v_mfma_f32_16x16x32_bf16 v[112:115], v[72:75], a[92:95], v[112:115]
    s_waitcnt vmcnt(22)
    s_waitcnt lgkmcnt(7)
    ds_read_b128 v[64:67], v3 offset:34816
    v_mfma_f32_16x16x32_bf16 v[84:87], v[76:79], a[24:27], v[84:87]
    v_mfma_f32_16x16x32_bf16 v[88:91], v[76:79], a[96:99], v[88:91]
    ds_read_b128 v[68:71], v3 offset:35840
    v_mfma_f32_16x16x32_bf16 v[92:95], v[80:83], a[24:27], v[92:95]
    v_mfma_f32_16x16x32_bf16 v[96:99], v[80:83], a[96:99], v[96:99]
    ds_read_b128 v[72:75], v3 offset:36864
    v_mfma_f32_16x16x32_bf16 v[100:103], v[32:35], a[24:27], v[100:103]
    s_add_u32 m0, s54, 98304
    s_add_u32 s55, s55, 20480
    buffer_load_dwordx4 v3, s[4:7], s55 offen offset:0 sc1 lds
    v_mfma_f32_16x16x32_bf16 v[104:107], v[32:35], a[96:99], v[104:107]
    s_waitcnt lgkmcnt(7)
    ds_read_b128 v[76:79], v3 offset:37888
    v_mfma_f32_16x16x32_bf16 v[108:111], v[36:39], a[24:27], v[108:111]
    v_mfma_f32_16x16x32_bf16 v[112:115], v[36:39], a[96:99], v[112:115]
    s_waitcnt vmcnt(21)
    ds_read_b128 v[80:83], v3 offset:38912
    v_mfma_f32_16x16x32_bf16 v[84:87], v[40:43], a[28:31], v[84:87]
    v_mfma_f32_16x16x32_bf16 v[88:91], v[40:43], a[100:103], v[88:91]
    ds_read_b128 v[32:35], v3 offset:39936
    v_mfma_f32_16x16x32_bf16 v[92:95], v[44:47], a[28:31], v[92:95]
    buffer_load_dwordx4 v3, s[4:7], s55 offen offset:1024 sc1 lds
    v_mfma_f32_16x16x32_bf16 v[96:99], v[44:47], a[100:103], v[96:99]
    s_waitcnt lgkmcnt(7)
    ds_read_b128 v[36:39], v3 offset:40960
    v_mfma_f32_16x16x32_bf16 v[100:103], v[48:51], a[28:31], v[100:103]
    v_mfma_f32_16x16x32_bf16 v[104:107], v[48:51], a[100:103], v[104:107]
    ds_read_b128 v[40:43], v3 offset:41984
    v_mfma_f32_16x16x32_bf16 v[108:111], v[52:55], a[28:31], v[108:111]
    v_mfma_f32_16x16x32_bf16 v[112:115], v[52:55], a[100:103], v[112:115]
    s_waitcnt vmcnt(20)
    ds_read_b128 v[44:47], v3 offset:43008
    v_mfma_f32_16x16x32_bf16 v[84:87], v[56:59], a[32:35], v[84:87]
    buffer_load_dwordx4 v3, s[4:7], s55 offen offset:2048 sc1 lds
    v_mfma_f32_16x16x32_bf16 v[88:91], v[56:59], a[104:107], v[88:91]
    s_waitcnt lgkmcnt(7)
    ds_read_b128 v[48:51], v3 offset:44032
    v_mfma_f32_16x16x32_bf16 v[92:95], v[60:63], a[32:35], v[92:95]
    v_mfma_f32_16x16x32_bf16 v[96:99], v[60:63], a[104:107], v[96:99]
    ds_read_b128 v[52:55], v3 offset:45056
    v_mfma_f32_16x16x32_bf16 v[100:103], v[64:67], a[32:35], v[100:103]
    v_mfma_f32_16x16x32_bf16 v[104:107], v[64:67], a[104:107], v[104:107]
    ds_read_b128 v[56:59], v3 offset:46080
    v_mfma_f32_16x16x32_bf16 v[108:111], v[68:71], a[32:35], v[108:111]
    buffer_load_dwordx4 v3, s[4:7], s55 offen offset:3072 sc1 lds
    v_mfma_f32_16x16x32_bf16 v[112:115], v[68:71], a[104:107], v[112:115]
    s_waitcnt vmcnt(20)
    s_waitcnt lgkmcnt(7)
    ds_read_b128 v[60:63], v3 offset:47104
    v_mfma_f32_16x16x32_bf16 v[84:87], v[72:75], a[36:39], v[84:87]
    v_mfma_f32_16x16x32_bf16 v[88:91], v[72:75], a[108:111], v[88:91]
    ds_read_b128 v[64:67], v3 offset:48128
    v_mfma_f32_16x16x32_bf16 v[92:95], v[76:79], a[36:39], v[92:95]
    v_mfma_f32_16x16x32_bf16 v[96:99], v[76:79], a[108:111], v[96:99]
    s_barrier
    ds_read_b128 v[68:71], v3 offset:49152
    v_mfma_f32_16x16x32_bf16 v[100:103], v[80:83], a[36:39], v[100:103]
    s_add_u32 m0, m0, 4096
    s_add_u32 s55, s55, 4096
    buffer_load_dwordx4 v3, s[4:7], s55 offen offset:0 sc1 lds
    v_mfma_f32_16x16x32_bf16 v[104:107], v[80:83], a[108:111], v[104:107]
    s_waitcnt lgkmcnt(7)
    ds_read_b128 v[72:75], v3 offset:50176
    v_mfma_f32_16x16x32_bf16 v[108:111], v[32:35], a[36:39], v[108:111]
    v_mfma_f32_16x16x32_bf16 v[112:115], v[32:35], a[108:111], v[112:115]
    s_waitcnt vmcnt(19)
    ds_read_b128 v[76:79], v3 offset:51200
    v_mfma_f32_16x16x32_bf16 v[84:87], v[36:39], a[40:43], v[84:87]
    v_mfma_f32_16x16x32_bf16 v[88:91], v[36:39], a[112:115], v[88:91]
    ds_read_b128 v[80:83], v3 offset:52224
    v_mfma_f32_16x16x32_bf16 v[92:95], v[40:43], a[40:43], v[92:95]
    buffer_load_dwordx4 v3, s[4:7], s55 offen offset:1024 sc1 lds
    v_mfma_f32_16x16x32_bf16 v[96:99], v[40:43], a[112:115], v[96:99]
    s_waitcnt lgkmcnt(7)
    ds_read_b128 v[32:35], v3 offset:53248
    v_mfma_f32_16x16x32_bf16 v[100:103], v[44:47], a[40:43], v[100:103]
    v_mfma_f32_16x16x32_bf16 v[104:107], v[44:47], a[112:115], v[104:107]
    ds_read_b128 v[36:39], v3 offset:54272
    v_mfma_f32_16x16x32_bf16 v[108:111], v[48:51], a[40:43], v[108:111]
    v_mfma_f32_16x16x32_bf16 v[112:115], v[48:51], a[112:115], v[112:115]
    s_waitcnt vmcnt(18)
    ds_read_b128 v[40:43], v3 offset:55296
    v_mfma_f32_16x16x32_bf16 v[84:87], v[52:55], a[44:47], v[84:87]
    s_add_u32 m0, s54, 122880
    s_add_u32 s55, s55, 20480
    buffer_load_dwordx4 v3, s[4:7], s55 offen offset:0 sc1 lds
    v_mfma_f32_16x16x32_bf16 v[88:91], v[52:55], a[116:119], v[88:91]
    s_waitcnt lgkmcnt(7)
    ds_read_b128 v[44:47], v3 offset:56320
    v_mfma_f32_16x16x32_bf16 v[92:95], v[56:59], a[44:47], v[92:95]
    v_mfma_f32_16x16x32_bf16 v[96:99], v[56:59], a[116:119], v[96:99]
    ds_read_b128 v[48:51], v3 offset:57344
    v_mfma_f32_16x16x32_bf16 v[100:103], v[60:63], a[44:47], v[100:103]
    v_mfma_f32_16x16x32_bf16 v[104:107], v[60:63], a[116:119], v[104:107]
    ds_read_b128 v[52:55], v3 offset:58368
    v_mfma_f32_16x16x32_bf16 v[108:111], v[64:67], a[44:47], v[108:111]
    buffer_load_dwordx4 v3, s[4:7], s55 offen offset:1024 sc1 lds
    v_mfma_f32_16x16x32_bf16 v[112:115], v[64:67], a[116:119], v[112:115]
    s_waitcnt vmcnt(18)
    s_waitcnt lgkmcnt(7)
    ds_read_b128 v[56:59], v3 offset:59392
    v_mfma_f32_16x16x32_bf16 v[84:87], v[68:71], a[48:51], v[84:87]
    v_mfma_f32_16x16x32_bf16 v[88:91], v[68:71], a[120:123], v[88:91]
    ds_read_b128 v[60:63], v3 offset:60416
    v_mfma_f32_16x16x32_bf16 v[92:95], v[72:75], a[48:51], v[92:95]
    v_mfma_f32_16x16x32_bf16 v[96:99], v[72:75], a[120:123], v[96:99]
    ds_read_b128 v[64:67], v3 offset:61440
    v_mfma_f32_16x16x32_bf16 v[100:103], v[76:79], a[48:51], v[100:103]
    buffer_load_dwordx4 v3, s[4:7], s55 offen offset:2048 sc1 lds
    v_mfma_f32_16x16x32_bf16 v[104:107], v[76:79], a[120:123], v[104:107]
    s_waitcnt lgkmcnt(7)
    ds_read_b128 v[68:71], v3 offset:62464
    v_mfma_f32_16x16x32_bf16 v[108:111], v[80:83], a[48:51], v[108:111]
    v_mfma_f32_16x16x32_bf16 v[112:115], v[80:83], a[120:123], v[112:115]
    s_waitcnt vmcnt(17)
    ds_read_b128 v[72:75], v3 offset:63488
    v_mfma_f32_16x16x32_bf16 v[84:87], v[32:35], a[52:55], v[84:87]
    v_mfma_f32_16x16x32_bf16 v[88:91], v[32:35], a[124:127], v[88:91]
    ds_read_b128 v[76:79], v3 offset:64512
    v_mfma_f32_16x16x32_bf16 v[92:95], v[36:39], a[52:55], v[92:95]
    buffer_load_dwordx4 v3, s[4:7], s55 offen offset:3072 sc1 lds
    v_mfma_f32_16x16x32_bf16 v[96:99], v[36:39], a[124:127], v[96:99]
    s_waitcnt lgkmcnt(7)
    ds_read_b128 v[80:83], v4 offset:0
    v_mfma_f32_16x16x32_bf16 v[100:103], v[40:43], a[52:55], v[100:103]
    v_mfma_f32_16x16x32_bf16 v[104:107], v[40:43], a[124:127], v[104:107]
    ds_read_b128 v[32:35], v4 offset:1024
    v_mfma_f32_16x16x32_bf16 v[108:111], v[44:47], a[52:55], v[108:111]
    v_mfma_f32_16x16x32_bf16 v[112:115], v[44:47], a[124:127], v[112:115]
    s_waitcnt vmcnt(16)
    ds_read_b128 v[36:39], v4 offset:2048
    v_mfma_f32_16x16x32_bf16 v[84:87], v[48:51], a[56:59], v[84:87]
    s_add_u32 m0, m0, 4096
    s_add_u32 s55, s55, 4096
    buffer_load_dwordx4 v3, s[4:7], s55 offen offset:0 sc1 lds
    v_mfma_f32_16x16x32_bf16 v[88:91], v[48:51], a[128:131], v[88:91]
    s_waitcnt lgkmcnt(7)
    ds_read_b128 v[40:43], v4 offset:3072
    v_mfma_f32_16x16x32_bf16 v[92:95], v[52:55], a[56:59], v[92:95]
    v_mfma_f32_16x16x32_bf16 v[96:99], v[52:55], a[128:131], v[96:99]
    ds_read_b128 v[44:47], v4 offset:4096
    v_mfma_f32_16x16x32_bf16 v[100:103], v[56:59], a[56:59], v[100:103]
    v_mfma_f32_16x16x32_bf16 v[104:107], v[56:59], a[128:131], v[104:107]
    ds_read_b128 v[48:51], v4 offset:5120
    v_mfma_f32_16x16x32_bf16 v[108:111], v[60:63], a[56:59], v[108:111]
    buffer_load_dwordx4 v3, s[4:7], s55 offen offset:1024 sc1 lds
    v_mfma_f32_16x16x32_bf16 v[112:115], v[60:63], a[128:131], v[112:115]
    s_waitcnt vmcnt(16)
    s_waitcnt lgkmcnt(7)
    ds_read_b128 v[52:55], v4 offset:6144
    v_mfma_f32_16x16x32_bf16 v[84:87], v[64:67], a[60:63], v[84:87]
    v_mfma_f32_16x16x32_bf16 v[88:91], v[64:67], a[132:135], v[88:91]
    ds_read_b128 v[56:59], v4 offset:7168
    v_mfma_f32_16x16x32_bf16 v[92:95], v[68:71], a[60:63], v[92:95]
    v_mfma_f32_16x16x32_bf16 v[96:99], v[68:71], a[132:135], v[96:99]
    s_barrier
    ds_read_b128 v[60:63], v4 offset:8192
    v_mfma_f32_16x16x32_bf16 v[100:103], v[72:75], a[60:63], v[100:103]
    s_add_u32 m0, s54, 0
    s_add_u32 s55, s55, 20480
    buffer_load_dwordx4 v3, s[4:7], s55 offen offset:0 sc1 lds
    v_mfma_f32_16x16x32_bf16 v[104:107], v[72:75], a[132:135], v[104:107]
    s_waitcnt lgkmcnt(7)
    ds_read_b128 v[64:67], v4 offset:9216
    v_mfma_f32_16x16x32_bf16 v[108:111], v[76:79], a[60:63], v[108:111]
    v_mfma_f32_16x16x32_bf16 v[112:115], v[76:79], a[132:135], v[112:115]
    s_waitcnt vmcnt(15)
    ds_read_b128 v[68:71], v4 offset:10240
    v_mfma_f32_16x16x32_bf16 v[84:87], v[80:83], a[64:67], v[84:87]
    v_mfma_f32_16x16x32_bf16 v[88:91], v[80:83], a[136:139], v[88:91]
    ds_read_b128 v[72:75], v4 offset:11264
    v_mfma_f32_16x16x32_bf16 v[92:95], v[32:35], a[64:67], v[92:95]
    buffer_load_dwordx4 v3, s[4:7], s55 offen offset:1024 sc1 lds
    v_mfma_f32_16x16x32_bf16 v[96:99], v[32:35], a[136:139], v[96:99]
    s_waitcnt lgkmcnt(7)
    ds_read_b128 v[76:79], v4 offset:12288
    v_mfma_f32_16x16x32_bf16 v[100:103], v[36:39], a[64:67], v[100:103]
    v_mfma_f32_16x16x32_bf16 v[104:107], v[36:39], a[136:139], v[104:107]
    ds_read_b128 v[80:83], v4 offset:13312
    v_mfma_f32_16x16x32_bf16 v[108:111], v[40:43], a[64:67], v[108:111]
    v_mfma_f32_16x16x32_bf16 v[112:115], v[40:43], a[136:139], v[112:115]
    s_waitcnt vmcnt(14)
    ds_read_b128 v[32:35], v4 offset:14336
    v_mfma_f32_16x16x32_bf16 v[84:87], v[44:47], a[68:71], v[84:87]
    buffer_load_dwordx4 v3, s[4:7], s55 offen offset:2048 sc1 lds
    v_mfma_f32_16x16x32_bf16 v[88:91], v[44:47], a[140:143], v[88:91]
    s_waitcnt lgkmcnt(7)
    ds_read_b128 v[36:39], v4 offset:15360
    v_mfma_f32_16x16x32_bf16 v[92:95], v[48:51], a[68:71], v[92:95]
    v_mfma_f32_16x16x32_bf16 v[96:99], v[48:51], a[140:143], v[96:99]
    ds_read_b128 v[40:43], v4 offset:16384
    v_mfma_f32_16x16x32_bf16 v[100:103], v[52:55], a[68:71], v[100:103]
    v_mfma_f32_16x16x32_bf16 v[104:107], v[52:55], a[140:143], v[104:107]
    ds_read_b128 v[44:47], v4 offset:17408
    v_mfma_f32_16x16x32_bf16 v[108:111], v[56:59], a[68:71], v[108:111]
    buffer_load_dwordx4 v3, s[4:7], s55 offen offset:3072 sc1 lds
    v_mfma_f32_16x16x32_bf16 v[112:115], v[56:59], a[140:143], v[112:115]
    s_waitcnt lgkmcnt(7)
    ds_read_b128 v[48:51], v4 offset:18432
    v_mfma_f32_16x16x32_bf16 v[84:87], v[60:63], v[244:247], v[84:87]
    v_mfma_f32_16x16x32_bf16 v[88:91], v[60:63], v[248:251], v[88:91]
    ds_read_b128 v[52:55], v4 offset:19456
    v_mfma_f32_16x16x32_bf16 v[92:95], v[64:67], v[244:247], v[92:95]
    v_mfma_f32_16x16x32_bf16 v[96:99], v[64:67], v[248:251], v[96:99]
    ds_read_b128 v[56:59], v4 offset:20480
    v_mfma_f32_16x16x32_bf16 v[100:103], v[68:71], v[244:247], v[100:103]
    s_add_u32 m0, m0, 4096
    s_add_u32 s55, s55, 4096
    buffer_load_dwordx4 v3, s[4:7], s55 offen offset:0 sc1 lds
    v_mfma_f32_16x16x32_bf16 v[104:107], v[68:71], v[248:251], v[104:107]
    s_waitcnt lgkmcnt(7)
    ds_read_b128 v[60:63], v4 offset:21504
    v_mfma_f32_16x16x32_bf16 v[108:111], v[72:75], v[244:247], v[108:111]
    v_mul_f32 v16, v84, v84
    v_mul_f32 v17, v85, v85
    v_mfma_f32_16x16x32_bf16 v[112:115], v[72:75], v[248:251], v[112:115]
    ds_read_b128 v[64:67], v4 offset:22528
    v_mul_f32 v18, v86, v86
    v_fma_f32 v16, v16, v10, v8
    v_mfma_f32_16x16x32_bf16 v[116:119], v[76:79], a[0:3], 0
    v_mul_f32 v19, v87, v87
    v_fma_f32 v17, v17, v10, v8
    v_mul_f32 v20, v92, v92
    v_mfma_f32_16x16x32_bf16 v[120:123], v[76:79], a[72:75], 0
    ds_read_b128 v[68:71], v4 offset:23552
    v_fma_f32 v18, v18, v10, v8
    v_mul_f32 v16, v16, v84
    v_mfma_f32_16x16x32_bf16 v[124:127], v[80:83], a[0:3], 0
    buffer_load_dwordx4 v3, s[4:7], s55 offen offset:1024 sc1 lds
    v_mul_f32 v21, v93, v93
    v_mfma_f32_16x16x32_bf16 v[128:131], v[80:83], a[72:75], 0
    s_waitcnt lgkmcnt(7)
    ds_read_b128 v[72:75], v4 offset:24576
    v_fma_f32 v19, v19, v10, v8
    v_mul_f32 v17, v17, v85
    v_mfma_f32_16x16x32_bf16 v[116:119], v[32:35], a[4:7], v[116:119]
    v_mul_f32 v22, v94, v94
    v_fma_f32 v20, v20, v10, v8
    v_mul_f32 v18, v18, v86
    v_mfma_f32_16x16x32_bf16 v[120:123], v[32:35], a[76:79], v[120:123]
    ds_read_b128 v[76:79], v4 offset:25600
    v_mul_f32 v23, v95, v95
    v_mfma_f32_16x16x32_bf16 v[124:127], v[36:39], a[4:7], v[124:127]
    v_exp_f32 v16, v16
    v_fma_f32 v21, v21, v10, v8
    v_mfma_f32_16x16x32_bf16 v[128:131], v[36:39], a[76:79], v[128:131]
    ds_read_b128 v[80:83], v4 offset:26624
    v_mul_f32 v19, v19, v87
    v_mul_f32 v24, v88, v88
    v_mfma_f32_16x16x32_bf16 v[116:119], v[40:43], a[8:11], v[116:119]
    s_add_u32 m0, s54, 24576
    s_add_u32 s55, s55, 20480
    buffer_load_dwordx4 v3, s[4:7], s55 offen offset:0 sc1 lds
    v_exp_f32 v17, v17
    v_mfma_f32_16x16x32_bf16 v[120:123], v[40:43], a[80:83], v[120:123]
    s_waitcnt lgkmcnt(7)
    ds_read_b128 v[32:35], v4 offset:27648
    v_fma_f32 v22, v22, v10, v8
    v_mul_f32 v20, v20, v92
    v_mfma_f32_16x16x32_bf16 v[124:127], v[44:47], a[8:11], v[124:127]
    v_mul_f32 v25, v89, v89
    v_mfma_f32_16x16x32_bf16 v[128:131], v[44:47], a[80:83], v[128:131]
    ds_read_b128 v[36:39], v4 offset:28672
    v_exp_f32 v18, v18
    v_fma_f32 v23, v23, v10, v8
    v_mfma_f32_16x16x32_bf16 v[116:119], v[48:51], a[12:15], v[116:119]
    v_fma_f32 v16, v16, v12, v12
    v_mul_f32 v21, v21, v93
    v_mul_f32 v26, v90, v90
    v_mfma_f32_16x16x32_bf16 v[120:123], v[48:51], a[84:87], v[120:123]
    ds_read_b128 v[40:43], v4 offset:29696
    v_exp_f32 v19, v19
    v_mfma_f32_16x16x32_bf16 v[124:127], v[52:55], a[12:15], v[124:127]
    buffer_load_dwordx4 v3, s[4:7], s55 offen offset:1024 sc1 lds
    v_fma_f32 v24, v24, v11, v9
    v_mfma_f32_16x16x32_bf16 v[128:131], v[52:55], a[84:87], v[128:131]
    s_waitcnt lgkmcnt(7)
    ds_read_b128 v[44:47], v4 offset:30720
    v_fma_f32 v17, v17, v12, v12
    v_mul_f32 v22, v22, v94
    v_mfma_f32_16x16x32_bf16 v[116:119], v[56:59], a[16:19], v[116:119]
    v_mul_f32 v27, v91, v91
    v_exp_f32 v20, v20
    v_mfma_f32_16x16x32_bf16 v[120:123], v[56:59], a[88:91], v[120:123]
    ds_read_b128 v[48:51], v4 offset:31744
    v_fma_f32 v25, v25, v11, v9
    v_fma_f32 v18, v18, v12, v12
    v_mfma_f32_16x16x32_bf16 v[124:127], v[60:63], a[16:19], v[124:127]
    v_mul_f32 v23, v23, v95
    v_mul_f32 v28, v96, v96
    v_mfma_f32_16x16x32_bf16 v[128:131], v[60:63], a[88:91], v[128:131]
    s_waitcnt vmcnt(14)
    s_barrier
    ds_read_b128 v[52:55], v4 offset:32768
    v_rcp_f32 v16, v16
    v_mfma_f32_16x16x32_bf16 v[116:119], v[64:67], a[20:23], v[116:119]
    buffer_load_dwordx4 v3, s[4:7], s55 offen offset:2048 sc1 lds
    v_exp_f32 v21, v21
    v_mfma_f32_16x16x32_bf16 v[120:123], v[64:67], a[92:95], v[120:123]
    s_waitcnt lgkmcnt(7)
    ds_read_b128 v[56:59], v4 offset:33792
    v_fma_f32 v26, v26, v11, v9
    v_fma_f32 v19, v19, v12, v12
    v_mfma_f32_16x16x32_bf16 v[124:127], v[68:71], a[20:23], v[124:127]
    v_mul_f32 v24, v24, v88
    v_mul_f32 v29, v97, v97
    v_mfma_f32_16x16x32_bf16 v[128:131], v[68:71], a[92:95], v[128:131]
    ds_read_b128 v[60:63], v4 offset:34816
    v_rcp_f32 v17, v17
    v_mfma_f32_16x16x32_bf16 v[116:119], v[72:75], a[24:27], v[116:119]
    v_exp_f32 v22, v22
    v_fma_f32 v27, v27, v11, v9
    v_mfma_f32_16x16x32_bf16 v[120:123], v[72:75], a[96:99], v[120:123]
    ds_read_b128 v[64:67], v4 offset:35840
    v_fma_f32 v20, v20, v12, v12
    v_mul_f32 v25, v25, v89
    v_mfma_f32_16x16x32_bf16 v[124:127], v[76:79], a[24:27], v[124:127]
    buffer_load_dwordx4 v3, s[4:7], s55 offen offset:3072 sc1 lds
    v_mul_f32 v30, v98, v98
    v_mfma_f32_16x16x32_bf16 v[128:131], v[76:79], a[96:99], v[128:131]
    s_waitcnt lgkmcnt(7)
    ds_read_b128 v[68:71], v4 offset:36864
    v_rcp_f32 v18, v18
    v_mfma_f32_16x16x32_bf16 v[116:119], v[80:83], a[28:31], v[116:119]
    v_exp_f32 v23, v23
    v_fma_f32 v28, v28, v11, v9
    v_mfma_f32_16x16x32_bf16 v[120:123], v[80:83], a[100:103], v[120:123]
    ds_read_b128 v[72:75], v4 offset:37888
    v_mul_f32 v84, v84, v16
    v_fma_f32 v21, v21, v12, v12
    v_mfma_f32_16x16x32_bf16 v[124:127], v[32:35], a[28:31], v[124:127]
    v_mul_f32 v26, v26, v90
    v_mul_f32 v31, v99, v99
    v_mfma_f32_16x16x32_bf16 v[128:131], v[32:35], a[100:103], v[128:131]
    ds_read_b128 v[76:79], v4 offset:38912
    v_rcp_f32 v19, v19
    v_mfma_f32_16x16x32_bf16 v[116:119], v[36:39], a[32:35], v[116:119]
    s_add_u32 m0, m0, 4096
    s_add_u32 s55, s55, 4096
    buffer_load_dwordx4 v3, s[4:7], s55 offen offset:0 sc1 lds
    v_exp_f32 v24, v24
    v_mfma_f32_16x16x32_bf16 v[120:123], v[36:39], a[104:107], v[120:123]
    s_waitcnt lgkmcnt(7)
    ds_read_b128 v[80:83], v4 offset:39936
    v_fma_f32 v29, v29, v11, v9
    v_mul_f32 v85, v85, v17
    v_mfma_f32_16x16x32_bf16 v[124:127], v[40:43], a[32:35], v[124:127]
    v_fma_f32 v22, v22, v12, v12
    v_mul_f32 v27, v27, v91
    v_mfma_f32_16x16x32_bf16 v[128:131], v[40:43], a[104:107], v[128:131]
    ds_read_b128 v[32:35], v4 offset:40960
    v_mul_f32 v16, v100, v100
    v_mfma_f32_16x16x32_bf16 v[116:119], v[44:47], a[36:39], v[116:119]
    v_rcp_f32 v20, v20
    v_exp_f32 v25, v25
    v_mfma_f32_16x16x32_bf16 v[120:123], v[44:47], a[108:111], v[120:123]
    ds_read_b128 v[36:39], v4 offset:41984
    v_fma_f32 v30, v30, v11, v9
    v_mul_f32 v86, v86, v18
    v_mfma_f32_16x16x32_bf16 v[124:127], v[48:51], a[36:39], v[124:127]
    buffer_load_dwordx4 v3, s[4:7], s55 offen offset:1024 sc1 lds
    v_fma_f32 v23, v23, v12, v12
    v_mfma_f32_16x16x32_bf16 v[128:131], v[48:51], a[108:111], v[128:131]
    s_waitcnt lgkmcnt(7)
    ds_read_b128 v[40:43], v4 offset:43008
    v_mul_f32 v28, v28, v96
    v_mul_f32 v17, v101, v101
    v_mfma_f32_16x16x32_bf16 v[116:119], v[52:55], a[40:43], v[116:119]
    v_cvt_pk_bf16_f32 v164, v84, v85
    v_rcp_f32 v21, v21
    v_mfma_f32_16x16x32_bf16 v[120:123], v[52:55], a[112:115], v[120:123]
    ds_read_b128 v[44:47], v4 offset:44032
    v_exp_f32 v26, v26
    v_mfma_f32_16x16x32_bf16 v[124:127], v[56:59], a[40:43], v[124:127]
    v_fma_f32 v31, v31, v11, v9
    v_mul_f32 v87, v87, v19
    v_mfma_f32_16x16x32_bf16 v[128:131], v[56:59], a[112:115], v[128:131]
    ds_read_b128 v[48:51], v4 offset:45056
    v_fma_f32 v24, v24, v13, v13
    v_mul_f32 v29, v29, v97
    v_mfma_f32_16x16x32_bf16 v[116:119], v[60:63], a[44:47], v[116:119]
    s_add_u32 m0, s54, 49152
    s_add_u32 s55, s55, 20480
    buffer_load_dwordx4 v3, s[4:7], s55 offen offset:0 sc1 lds
    v_mul_f32 v18, v102, v102
    v_mfma_f32_16x16x32_bf16 v[120:123], v[60:63], a[116:119], v[120:123]
    s_waitcnt lgkmcnt(7)
    ds_read_b128 v[52:55], v4 offset:46080
    v_rcp_f32 v22, v22
    v_mfma_f32_16x16x32_bf16 v[124:127], v[64:67], a[44:47], v[124:127]
    v_exp_f32 v27, v27
    v_fma_f32 v16, v16, v10, v8
    v_mfma_f32_16x16x32_bf16 v[128:131], v[64:67], a[116:119], v[128:131]
    ds_read_b128 v[56:59], v4 offset:47104
    v_mul_f32 v92, v92, v20
    v_fma_f32 v25, v25, v13, v13
    v_mfma_f32_16x16x32_bf16 v[116:119], v[68:71], a[48:51], v[116:119]
    v_mul_f32 v30, v30, v98
    v_mul_f32 v19, v103, v103
    v_cvt_pk_bf16_f32 v165, v86, v87
    v_mfma_f32_16x16x32_bf16 v[120:123], v[68:71], a[120:123], v[120:123]
    ds_read_b128 v[60:63], v4 offset:48128
    v_rcp_f32 v23, v23
    v_mfma_f32_16x16x32_bf16 v[124:127], v[72:75], a[48:51], v[124:127]
    buffer_load_dwordx4 v3, s[4:7], s55 offen offset:1024 sc1 lds
    v_mfma_f32_16x16x32_bf16 v[128:131], v[72:75], a[120:123], v[128:131]
    s_waitcnt lgkmcnt(7)
    ds_read_b128 v[64:67], v4 offset:49152
    v_exp_f32 v28, v28
    v_fma_f32 v17, v17, v10, v8
    v_mfma_f32_16x16x32_bf16 v[116:119], v[76:79], a[52:55], v[116:119]
    v_mul_f32 v93, v93, v21
    v_fma_f32 v26, v26, v13, v13
    v_mul_f32 v31, v31, v99
    v_mfma_f32_16x16x32_bf16 v[120:123], v[76:79], a[124:127], v[120:123]
    ds_read_b128 v[68:71], v4 offset:50176
    v_mul_f32 v20, v108, v108
    v_mfma_f32_16x16x32_bf16 v[124:127], v[80:83], a[52:55], v[124:127]
    v_rcp_f32 v24, v24
    v_mfma_f32_16x16x32_bf16 v[128:131], v[80:83], a[124:127], v[128:131]
    ds_read_b128 v[72:75], v4 offset:51200
    v_exp_f32 v29, v29
    v_fma_f32 v18, v18, v10, v8
    v_mfma_f32_16x16x32_bf16 v[116:119], v[32:35], a[56:59], v[116:119]
    buffer_load_dwordx4 v3, s[4:7], s55 offen offset:2048 sc1 lds
    v_mul_f32 v94, v94, v22
    v_fma_f32 v27, v27, v13, v13
    v_mfma_f32_16x16x32_bf16 v[120:123], v[32:35], a[128:131], v[120:123]
    s_waitcnt lgkmcnt(7)
    ds_read_b128 v[76:79], v4 offset:52224
    v_mul_f32 v16, v16, v100
    v_mul_f32 v21, v109, v109
    v_mfma_f32_16x16x32_bf16 v[124:127], v[36:39], a[56:59], v[124:127]
    v_cvt_pk_bf16_f32 v166, v92, v93
    v_mfma_f32_16x16x32_bf16 v[128:131], v[36:39], a[128:131], v[128:131]
    ds_read_b128 v[80:83], v4 offset:53248
    v_rcp_f32 v25, v25
    v_mfma_f32_16x16x32_bf16 v[116:119], v[40:43], a[60:63], v[116:119]
    v_exp_f32 v30, v30
    v_fma_f32 v19, v19, v10, v8
    v_mul_f32 v95, v95, v23
    v_mfma_f32_16x16x32_bf16 v[120:123], v[40:43], a[132:135], v[120:123]
    ds_read_b128 v[32:35], v4 offset:54272
    v_fma_f32 v28, v28, v13, v13
    v_mul_f32 v17, v17, v101
    v_mfma_f32_16x16x32_bf16 v[124:127], v[44:47], a[60:63], v[124:127]
    buffer_load_dwordx4 v3, s[4:7], s55 offen offset:3072 sc1 lds
    v_mul_f32 v22, v110, v110
    v_mfma_f32_16x16x32_bf16 v[128:131], v[44:47], a[132:135], v[128:131]
    s_waitcnt lgkmcnt(7)
    ds_read_b128 v[36:39], v4 offset:55296
    v_rcp_f32 v26, v26
    v_mfma_f32_16x16x32_bf16 v[116:119], v[48:51], a[64:67], v[116:119]
    v_exp_f32 v31, v31
    v_fma_f32 v20, v20, v10, v8
    v_mfma_f32_16x16x32_bf16 v[120:123], v[48:51], a[136:139], v[120:123]
    ds_read_b128 v[40:43], v4 offset:56320
    v_mul_f32 v88, v88, v24
    v_fma_f32 v29, v29, v13, v13
    v_mfma_f32_16x16x32_bf16 v[124:127], v[52:55], a[64:67], v[124:127]
    v_mul_f32 v18, v18, v102
    v_mul_f32 v23, v111, v111
    v_mfma_f32_16x16x32_bf16 v[128:131], v[52:55], a[136:139], v[128:131]
    s_waitcnt vmcnt(16)
    s_barrier
    ds_read_b128 v[44:47], v4 offset:57344
    v_cvt_pk_bf16_f32 v167, v94, v95
    v_mfma_f32_16x16x32_bf16 v[116:119], v[56:59], a[68:71], v[116:119]
    buffer_store_dwordx4 v[164:167], v3, s[4:7], s24 offen offset:0 sc1
    v_rcp_f32 v27, v27
    v_mfma_f32_16x16x32_bf16 v[120:123], v[56:59], a[140:143], v[120:123]
    s_waitcnt lgkmcnt(7)
    ds_read_b128 v[48:51], v4 offset:58368
    v_exp_f32 v16, v16
    v_fma_f32 v21, v21, v10, v8
    v_mfma_f32_16x16x32_bf16 v[124:127], v[60:63], a[68:71], v[124:127]
    s_add_u32 m0, m0, 4096
    s_add_u32 s55, s55, 4096
    buffer_load_dwordx4 v3, s[4:7], s55 offen offset:0 sc1 lds
    v_mul_f32 v89, v89, v25
    v_mfma_f32_16x16x32_bf16 v[128:131], v[60:63], a[140:143], v[128:131]
    ds_read_b128 v[52:55], v4 offset:59392
    v_fma_f32 v30, v30, v13, v13
    v_mul_f32 v19, v19, v103
    v_mfma_f32_16x16x32_bf16 v[116:119], v[64:67], v[244:247], v[116:119]
    v_mul_f32 v24, v104, v104
    v_rcp_f32 v28, v28
    v_mfma_f32_16x16x32_bf16 v[120:123], v[64:67], v[248:251], v[120:123]
    ds_read_b128 v[56:59], v4 offset:60416
    v_exp_f32 v17, v17
    v_mfma_f32_16x16x32_bf16 v[124:127], v[68:71], v[244:247], v[124:127]
    v_fma_f32 v22, v22, v10, v8
    v_mul_f32 v90, v90, v26
    v_mfma_f32_16x16x32_bf16 v[128:131], v[68:71], v[248:251], v[128:131]
    s_waitcnt lgkmcnt(7)
    ds_read_b128 v[60:63], v4 offset:61440
    v_fma_f32 v31, v31, v13, v13
    v_mul_f32 v20, v20, v108
    v_mfma_f32_16x16x32_bf16 v[132:135], v[72:75], a[0:3], 0
    buffer_load_dwordx4 v3, s[4:7], s55 offen offset:1024 sc1 lds
    v_mul_f32 v25, v105, v105
    v_cvt_pk_bf16_f32 v168, v88, v89
    v_mfma_f32_16x16x32_bf16 v[136:139], v[72:75], a[72:75], 0
    ds_read_b128 v[64:67], v4 offset:62464
    v_rcp_f32 v29, v29
    v_mfma_f32_16x16x32_bf16 v[140:143], v[76:79], a[0:3], 0
    v_exp_f32 v18, v18
    v_mfma_f32_16x16x32_bf16 v[144:147], v[76:79], a[72:75], 0
    ds_read_b128 v[68:71], v4 offset:63488
    v_fma_f32 v23, v23, v10, v8
    v_mul_f32 v91, v91, v27
    v_mfma_f32_16x16x32_bf16 v[132:135], v[80:83], a[4:7], v[132:135]
    v_fma_f32 v16, v16, v12, v12
    v_mul_f32 v21, v21, v109
    v_mul_f32 v26, v106, v106
    v_mfma_f32_16x16x32_bf16 v[136:139], v[80:83], a[76:79], v[136:139]
    s_waitcnt lgkmcnt(7)
    ds_read_b128 v[72:75], v4 offset:64512
    v_rcp_f32 v30, v30
    v_mfma_f32_16x16x32_bf16 v[140:143], v[32:35], a[4:7], v[140:143]
    s_add_u32 m0, s54, 73728
    s_add_u32 s55, s55, 20480
    buffer_load_dwordx4 v3, s[4:7], s55 offen offset:0 sc1 lds
    v_mfma_f32_16x16x32_bf16 v[144:147], v[32:35], a[76:79], v[144:147]
    ds_read_b128 v[76:79], v5 offset:0
    v_exp_f32 v19, v19
    v_fma_f32 v24, v24, v11, v9
    v_mfma_f32_16x16x32_bf16 v[132:135], v[36:39], a[8:11], v[132:135]
    v_mul_f32 v96, v96, v28
    v_fma_f32 v17, v17, v12, v12
    v_mul_f32 v22, v22, v110
    v_mfma_f32_16x16x32_bf16 v[136:139], v[36:39], a[80:83], v[136:139]
    ds_read_b128 v[80:83], v5 offset:1024
    v_mul_f32 v27, v107, v107
    v_cvt_pk_bf16_f32 v169, v90, v91
    v_mfma_f32_16x16x32_bf16 v[140:143], v[40:43], a[8:11], v[140:143]
    v_rcp_f32 v31, v31
    v_mfma_f32_16x16x32_bf16 v[144:147], v[40:43], a[80:83], v[144:147]
    s_waitcnt lgkmcnt(7)
    ds_read_b128 v[32:35], v5 offset:2048
    v_exp_f32 v20, v20
    v_mfma_f32_16x16x32_bf16 v[132:135], v[44:47], a[12:15], v[132:135]
    buffer_load_dwordx4 v3, s[4:7], s55 offen offset:1024 sc1 lds
    v_fma_f32 v25, v25, v11, v9
    v_mul_f32 v97, v97, v29
    v_mfma_f32_16x16x32_bf16 v[136:139], v[44:47], a[84:87], v[136:139]
    ds_read_b128 v[36:39], v5 offset:3072
    v_fma_f32 v18, v18, v12, v12
    v_mul_f32 v23, v23, v111
    v_mfma_f32_16x16x32_bf16 v[140:143], v[48:51], a[12:15], v[140:143]
    v_mul_f32 v28, v112, v112
    v_mfma_f32_16x16x32_bf16 v[144:147], v[48:51], a[84:87], v[144:147]
    ds_read_b128 v[40:43], v5 offset:4096
    v_rcp_f32 v16, v16
    v_mfma_f32_16x16x32_bf16 v[132:135], v[52:55], a[16:19], v[132:135]
    v_exp_f32 v21, v21
    v_fma_f32 v26, v26, v11, v9
    v_mul_f32 v98, v98, v30
    v_mfma_f32_16x16x32_bf16 v[136:139], v[52:55], a[88:91], v[136:139]
    s_waitcnt lgkmcnt(7)
    ds_read_b128 v[44:47], v5 offset:5120
    v_fma_f32 v19, v19, v12, v12
    v_mul_f32 v24, v24, v104
    v_mfma_f32_16x16x32_bf16 v[140:143], v[56:59], a[16:19], v[140:143]
    buffer_load_dwordx4 v3, s[4:7], s55 offen offset:2048 sc1 lds
    v_mul_f32 v29, v113, v113
    v_mfma_f32_16x16x32_bf16 v[144:147], v[56:59], a[88:91], v[144:147]
    ds_read_b128 v[48:51], v5 offset:6144
    v_cvt_pk_bf16_f32 v170, v96, v97
    v_mfma_f32_16x16x32_bf16 v[132:135], v[60:63], a[20:23], v[132:135]
    v_rcp_f32 v17, v17
    v_exp_f32 v22, v22
    v_mfma_f32_16x16x32_bf16 v[136:139], v[60:63], a[92:95], v[136:139]
    ds_read_b128 v[52:55], v5 offset:7168
    v_fma_f32 v27, v27, v11, v9
    v_mul_f32 v99, v99, v31
    v_mfma_f32_16x16x32_bf16 v[140:143], v[64:67], a[20:23], v[140:143]
    v_fma_f32 v20, v20, v12, v12
    v_mul_f32 v25, v25, v105
    v_mfma_f32_16x16x32_bf16 v[144:147], v[64:67], a[92:95], v[144:147]
    s_waitcnt lgkmcnt(7)
    ds_read_b128 v[56:59], v5 offset:8192
    v_mul_f32 v30, v114, v114
    v_mfma_f32_16x16x32_bf16 v[132:135], v[68:71], a[24:27], v[132:135]
    buffer_load_dwordx4 v3, s[4:7], s55 offen offset:3072 sc1 lds
    v_rcp_f32 v18, v18
    v_mfma_f32_16x16x32_bf16 v[136:139], v[68:71], a[96:99], v[136:139]
    ds_read_b128 v[60:63], v5 offset:9216
    v_exp_f32 v23, v23
    v_fma_f32 v28, v28, v11, v9
    v_mfma_f32_16x16x32_bf16 v[140:143], v[72:75], a[24:27], v[140:143]
    v_mul_f32 v100, v100, v16
    v_fma_f32 v21, v21, v12, v12
    v_mfma_f32_16x16x32_bf16 v[144:147], v[72:75], a[96:99], v[144:147]
    ds_read_b128 v[64:67], v5 offset:10240
    v_mul_f32 v26, v26, v106
    v_mul_f32 v31, v115, v115
    v_mfma_f32_16x16x32_bf16 v[132:135], v[76:79], a[28:31], v[132:135]
    v_cvt_pk_bf16_f32 v171, v98, v99
    v_rcp_f32 v19, v19
    v_mfma_f32_16x16x32_bf16 v[136:139], v[76:79], a[100:103], v[136:139]
    s_waitcnt lgkmcnt(7)
    ds_read_b128 v[68:71], v5 offset:11264
    v_exp_f32 v24, v24
    v_mfma_f32_16x16x32_bf16 v[140:143], v[80:83], a[28:31], v[140:143]
    buffer_store_dwordx4 v[168:171], v3, s[4:7], s24 offen offset:1024 sc1
    v_fma_f32 v29, v29, v11, v9
    v_mfma_f32_16x16x32_bf16 v[144:147], v[80:83], a[100:103], v[144:147]
    ds_read_b128 v[72:75], v5 offset:12288
    v_mul_f32 v101, v101, v17
    v_fma_f32 v22, v22, v12, v12
    v_mfma_f32_16x16x32_bf16 v[132:135], v[32:35], a[32:35], v[132:135]
    s_add_u32 m0, m0, 4096
    s_add_u32 s55, s55, 4096
    buffer_load_dwordx4 v3, s[4:7], s55 offen offset:0 sc1 lds
    v_mul_f32 v27, v27, v107
    v_mul_f32 v16, v116, v116
    v_mfma_f32_16x16x32_bf16 v[136:139], v[32:35], a[104:107], v[136:139]
    ds_read_b128 v[76:79], v5 offset:13312
    v_rcp_f32 v20, v20
    v_mfma_f32_16x16x32_bf16 v[140:143], v[36:39], a[32:35], v[140:143]
    v_exp_f32 v25, v25
    v_mfma_f32_16x16x32_bf16 v[144:147], v[36:39], a[104:107], v[144:147]
    s_waitcnt lgkmcnt(7)
    ds_read_b128 v[80:83], v5 offset:14336
    v_fma_f32 v30, v30, v11, v9
    v_mul_f32 v102, v102, v18
    v_mfma_f32_16x16x32_bf16 v[132:135], v[40:43], a[36:39], v[132:135]
    v_fma_f32 v23, v23, v12, v12
    v_mul_f32 v28, v28, v112
    v_mul_f32 v17, v117, v117
    v_mfma_f32_16x16x32_bf16 v[136:139], v[40:43], a[108:111], v[136:139]
    ds_read_b128 v[32:35], v5 offset:15360
    v_cvt_pk_bf16_f32 v172, v100, v101
    v_mfma_f32_16x16x32_bf16 v[140:143], v[44:47], a[36:39], v[140:143]
    buffer_load_dwordx4 v3, s[4:7], s55 offen offset:1024 sc1 lds
    v_rcp_f32 v21, v21
    v_mfma_f32_16x16x32_bf16 v[144:147], v[44:47], a[108:111], v[144:147]
    s_waitcnt vmcnt(20)
    s_barrier
    ds_read_b128 v[36:39], v3 offset:0
    v_exp_f32 v26, v26
    v_mfma_f32_16x16x32_bf16 v[132:135], v[48:51], a[40:43], v[132:135]
    v_fma_f32 v31, v31, v11, v9
    v_mul_f32 v103, v103, v19
    v_fma_f32 v24, v24, v13, v13
    v_mfma_f32_16x16x32_bf16 v[136:139], v[48:51], a[112:115], v[136:139]
    s_waitcnt lgkmcnt(7)
    ds_read_b128 v[40:43], v3 offset:1024
    v_mul_f32 v29, v29, v113
    v_mul_f32 v18, v118, v118
    v_mfma_f32_16x16x32_bf16 v[140:143], v[52:55], a[40:43], v[140:143]
    v_rcp_f32 v22, v22
    v_mfma_f32_16x16x32_bf16 v[144:147], v[52:55], a[112:115], v[144:147]
    ds_read_b128 v[44:47], v3 offset:2048
    v_exp_f32 v27, v27
    v_mfma_f32_16x16x32_bf16 v[132:135], v[56:59], a[44:47], v[132:135]
    s_add_u32 m0, s54, 98304
    s_add_u32 s55, s55, 20480
    buffer_load_dwordx4 v3, s[4:7], s55 offen offset:0 sc1 lds
    v_fma_f32 v16, v16, v10, v8
    v_mul_f32 v108, v108, v20
    v_mfma_f32_16x16x32_bf16 v[136:139], v[56:59], a[116:119], v[136:139]
    ds_read_b128 v[48:51], v3 offset:3072
    v_fma_f32 v25, v25, v13, v13
    v_mul_f32 v30, v30, v114
    v_mfma_f32_16x16x32_bf16 v[140:143], v[60:63], a[44:47], v[140:143]
    v_mul_f32 v19, v119, v119
    v_cvt_pk_bf16_f32 v173, v102, v103
    v_mfma_f32_16x16x32_bf16 v[144:147], v[60:63], a[116:119], v[144:147]
    s_waitcnt lgkmcnt(7)
    ds_read_b128 v[52:55], v3 offset:4096
    v_rcp_f32 v23, v23
    v_mfma_f32_16x16x32_bf16 v[132:135], v[64:67], a[48:51], v[132:135]
    v_exp_f32 v28, v28
    v_fma_f32 v17, v17, v10, v8
    v_mfma_f32_16x16x32_bf16 v[136:139], v[64:67], a[120:123], v[136:139]
    ds_read_b128 v[56:59], v3 offset:5120
    v_mul_f32 v109, v109, v21
    v_fma_f32 v26, v26, v13, v13
    v_mfma_f32_16x16x32_bf16 v[140:143], v[68:71], a[48:51], v[140:143]
    buffer_load_dwordx4 v3, s[4:7], s55 offen offset:1024 sc1 lds
    v_mul_f32 v31, v31, v115
    v_mfma_f32_16x16x32_bf16 v[144:147], v[68:71], a[120:123], v[144:147]
    ds_read_b128 v[60:63], v3 offset:6144
    v_mul_f32 v20, v124, v124
    v_mfma_f32_16x16x32_bf16 v[132:135], v[72:75], a[52:55], v[132:135]
    v_rcp_f32 v24, v24
    v_exp_f32 v29, v29
    v_mfma_f32_16x16x32_bf16 v[136:139], v[72:75], a[124:127], v[136:139]
    s_waitcnt lgkmcnt(7)
    ds_read_b128 v[64:67], v3 offset:7168
    v_fma_f32 v18, v18, v10, v8
    v_mul_f32 v110, v110, v22
    v_mfma_f32_16x16x32_bf16 v[140:143], v[76:79], a[52:55], v[140:143]
    v_fma_f32 v27, v27, v13, v13
    v_mul_f32 v16, v16, v116
    v_mfma_f32_16x16x32_bf16 v[144:147], v[76:79], a[124:127], v[144:147]
    ds_read_b128 v[68:71], v3 offset:8192
    v_mul_f32 v21, v125, v125
    v_cvt_pk_bf16_f32 v174, v108, v109
    v_mfma_f32_16x16x32_bf16 v[132:135], v[80:83], a[56:59], v[132:135]
    buffer_load_dwordx4 v3, s[4:7], s55 offen offset:2048 sc1 lds
    v_rcp_f32 v25, v25
    v_mfma_f32_16x16x32_bf16 v[136:139], v[80:83], a[128:131], v[136:139]
    ds_read_b128 v[72:75], v3 offset:9216
    v_exp_f32 v30, v30
    v_mfma_f32_16x16x32_bf16 v[140:143], v[32:35], a[56:59], v[140:143]
    v_fma_f32 v19, v19, v10, v8
    v_mul_f32 v111, v111, v23
    v_mfma_f32_16x16x32_bf16 v[144:147], v[32:35], a[128:131], v[144:147]
    s_waitcnt lgkmcnt(7)
    ds_read_b128 v[76:79], v3 offset:10240
    v_fma_f32 v28, v28, v13, v13
    v_mul_f32 v17, v17, v117
    v_mfma_f32_16x16x32_bf16 v[132:135], v[36:39], a[60:63], v[132:135]
    v_mul_f32 v22, v126, v126
    v_rcp_f32 v26, v26
    v_mfma_f32_16x16x32_bf16 v[136:139], v[36:39], a[132:135], v[136:139]
    ds_read_b128 v[80:83], v3 offset:11264
    v_exp_f32 v31, v31
    v_mfma_f32_16x16x32_bf16 v[140:143], v[40:43], a[60:63], v[140:143]
    buffer_load_dwordx4 v3, s[4:7], s55 offen offset:3072 sc1 lds
    v_fma_f32 v20, v20, v10, v8
    v_mfma_f32_16x16x32_bf16 v[144:147], v[40:43], a[132:135], v[144:147]
    ds_read_b128 v[32:35], v3 offset:12288
    v_mul_f32 v104, v104, v24
    v_fma_f32 v29, v29, v13, v13
    v_mfma_f32_16x16x32_bf16 v[132:135], v[44:47], a[64:67], v[132:135]
    v_mul_f32 v18, v18, v118
    v_mul_f32 v23, v127, v127
    v_cvt_pk_bf16_f32 v175, v110, v111
    v_mfma_f32_16x16x32_bf16 v[136:139], v[44:47], a[136:139], v[136:139]
    s_waitcnt lgkmcnt(7)
    ds_read_b128 v[36:39], v3 offset:13312
    v_rcp_f32 v27, v27
    v_mfma_f32_16x16x32_bf16 v[140:143], v[48:51], a[64:67], v[140:143]
    buffer_store_dwordx4 v[172:175], v3, s[4:7], s24 offen offset:2048 sc1
    v_mfma_f32_16x16x32_bf16 v[144:147], v[48:51], a[136:139], v[144:147]
    ds_read_b128 v[40:43], v3 offset:14336
    v_exp_f32 v16, v16
    v_fma_f32 v21, v21, v10, v8
    v_mfma_f32_16x16x32_bf16 v[132:135], v[52:55], a[68:71], v[132:135]
    s_add_u32 m0, m0, 4096
    s_add_u32 s55, s55, 4096
    buffer_load_dwordx4 v3, s[4:7], s55 offen offset:0 sc1 lds
    v_mul_f32 v105, v105, v25
    v_fma_f32 v30, v30, v13, v13
    v_mfma_f32_16x16x32_bf16 v[136:139], v[52:55], a[140:143], v[136:139]
    ds_read_b128 v[44:47], v3 offset:15360
    v_mul_f32 v19, v19, v119
    v_mul_f32 v24, v120, v120
    v_mfma_f32_16x16x32_bf16 v[140:143], v[56:59], a[68:71], v[140:143]
    v_rcp_f32 v28, v28
    v_mfma_f32_16x16x32_bf16 v[144:147], v[56:59], a[140:143], v[144:147]
    s_waitcnt lgkmcnt(7)
    ds_read_b128 v[48:51], v3 offset:16384
    v_exp_f32 v17, v17
    v_mfma_f32_16x16x32_bf16 v[132:135], v[60:63], v[244:247], v[132:135]
    v_fma_f32 v22, v22, v10, v8
    v_mul_f32 v106, v106, v26
    v_fma_f32 v31, v31, v13, v13
    v_mfma_f32_16x16x32_bf16 v[136:139], v[60:63], v[248:251], v[136:139]
    ds_read_b128 v[52:55], v3 offset:17408
    v_mul_f32 v20, v20, v124
    v_mul_f32 v25, v121, v121
    v_mfma_f32_16x16x32_bf16 v[140:143], v[64:67], v[244:247], v[140:143]
    buffer_load_dwordx4 v3, s[4:7], s55 offen offset:1024 sc1 lds
    v_cvt_pk_bf16_f32 v176, v104, v105
    v_mfma_f32_16x16x32_bf16 v[144:147], v[64:67], v[248:251], v[144:147]
    ds_read_b128 v[56:59], v3 offset:18432
    v_rcp_f32 v29, v29
    v_mfma_f32_16x16x32_bf16 v[148:151], v[68:71], a[0:3], 0
    v_exp_f32 v18, v18
    v_fma_f32 v23, v23, v10, v8
    v_mfma_f32_16x16x32_bf16 v[152:155], v[68:71], a[72:75], 0
    s_waitcnt lgkmcnt(7)
    ds_read_b128 v[60:63], v3 offset:19456
    v_mul_f32 v107, v107, v27
    v_fma_f32 v16, v16, v12, v12
    v_mfma_f32_16x16x32_bf16 v[156:159], v[72:75], a[0:3], 0
    v_mul_f32 v21, v21, v125
    v_mul_f32 v26, v122, v122
    v_mfma_f32_16x16x32_bf16 v[160:163], v[72:75], a[72:75], 0
    ds_read_b128 v[64:67], v3 offset:20480
    v_rcp_f32 v30, v30
    v_mfma_f32_16x16x32_bf16 v[148:151], v[76:79], a[4:7], v[148:151]
    v_exp_f32 v19, v19
    v_fma_f32 v24, v24, v11, v9
    v_mfma_f32_16x16x32_bf16 v[152:155], v[76:79], a[76:79], v[152:155]
    ds_read_b128 v[68:71], v3 offset:21504
    v_mul_f32 v112, v112, v28
    v_fma_f32 v17, v17, v12, v12
    v_mfma_f32_16x16x32_bf16 v[156:159], v[80:83], a[4:7], v[156:159]
    v_mul_f32 v22, v22, v126
    v_mul_f32 v27, v123, v123
    v_mfma_f32_16x16x32_bf16 v[160:163], v[80:83], a[76:79], v[160:163]
    s_waitcnt lgkmcnt(7)
    ds_read_b128 v[72:75], v3 offset:22528
    v_cvt_pk_bf16_f32 v177, v106, v107
    v_mfma_f32_16x16x32_bf16 v[148:151], v[32:35], a[8:11], v[148:151]
    v_rcp_f32 v31, v31
    v_exp_f32 v20, v20
    v_mfma_f32_16x16x32_bf16 v[152:155], v[32:35], a[80:83], v[152:155]
    ds_read_b128 v[76:79], v3 offset:23552
    v_fma_f32 v25, v25, v11, v9
    v_mul_f32 v113, v113, v29
    v_mfma_f32_16x16x32_bf16 v[156:159], v[36:39], a[8:11], v[156:159]
    v_fma_f32 v18, v18, v12, v12
    v_mul_f32 v23, v23, v127
    v_mfma_f32_16x16x32_bf16 v[160:163], v[36:39], a[80:83], v[160:163]
    s_waitcnt vmcnt(21)
    s_barrier
    ds_read_b128 v[80:83], v3 offset:24576
    v_mul_f32 v28, v128, v128
    v_mfma_f32_16x16x32_bf16 v[148:151], v[40:43], a[12:15], v[148:151]
    s_add_u32 m0, s54, 122880
    s_add_u32 s55, s55, 20480
    buffer_load_dwordx4 v3, s[4:7], s55 offen offset:0 sc1 lds
    v_rcp_f32 v16, v16
    v_mfma_f32_16x16x32_bf16 v[152:155], v[40:43], a[84:87], v[152:155]
    s_waitcnt lgkmcnt(7)
    ds_read_b128 v[32:35], v3 offset:25600
    v_exp_f32 v21, v21
    v_fma_f32 v26, v26, v11, v9
    v_mfma_f32_16x16x32_bf16 v[156:159], v[44:47], a[12:15], v[156:159]
    v_mul_f32 v114, v114, v30
    v_fma_f32 v19, v19, v12, v12
    v_mfma_f32_16x16x32_bf16 v[160:163], v[44:47], a[84:87], v[160:163]
    ds_read_b128 v[36:39], v3 offset:26624
    v_mul_f32 v24, v24, v120
    v_mul_f32 v29, v129, v129
    v_mfma_f32_16x16x32_bf16 v[148:151], v[48:51], a[16:19], v[148:151]
    v_cvt_pk_bf16_f32 v178, v112, v113
    v_rcp_f32 v17, v17
    v_mfma_f32_16x16x32_bf16 v[152:155], v[48:51], a[88:91], v[152:155]
    ds_read_b128 v[40:43], v3 offset:27648
    v_exp_f32 v22, v22
    v_mfma_f32_16x16x32_bf16 v[156:159], v[52:55], a[16:19], v[156:159]
    buffer_load_dwordx4 v3, s[4:7], s55 offen offset:1024 sc1 lds
    v_fma_f32 v27, v27, v11, v9
    v_mfma_f32_16x16x32_bf16 v[160:163], v[52:55], a[88:91], v[160:163]
    s_waitcnt lgkmcnt(7)
    ds_read_b128 v[44:47], v3 offset:28672
    v_mul_f32 v115, v115, v31
    v_fma_f32 v20, v20, v12, v12
    v_mfma_f32_16x16x32_bf16 v[148:151], v[56:59], a[20:23], v[148:151]
    v_mul_f32 v25, v25, v121
    v_mul_f32 v30, v130, v130
    v_mfma_f32_16x16x32_bf16 v[152:155], v[56:59], a[92:95], v[152:155]
    ds_read_b128 v[48:51], v3 offset:29696
    v_rcp_f32 v18, v18
    v_mfma_f32_16x16x32_bf16 v[156:159], v[60:63], a[20:23], v[156:159]
    v_exp_f32 v23, v23
    v_fma_f32 v28, v28, v11, v9
    v_mfma_f32_16x16x32_bf16 v[160:163], v[60:63], a[92:95], v[160:163]
    ds_read_b128 v[52:55], v3 offset:30720
    v_mul_f32 v116, v116, v16
    v_fma_f32 v21, v21, v12, v12
    v_mfma_f32_16x16x32_bf16 v[148:151], v[64:67], a[24:27], v[148:151]
    buffer_load_dwordx4 v3, s[4:7], s55 offen offset:2048 sc1 lds
    v_mul_f32 v26, v26, v122
    v_mul_f32 v31, v131, v131
    v_mfma_f32_16x16x32_bf16 v[152:155], v[64:67], a[96:99], v[152:155]
    s_waitcnt lgkmcnt(7)
    ds_read_b128 v[56:59], v3 offset:31744
    v_cvt_pk_bf16_f32 v179, v114, v115
    v_mfma_f32_16x16x32_bf16 v[156:159], v[68:71], a[24:27], v[156:159]
    buffer_store_dwordx4 v[176:179], v3, s[4:7], s24 offen offset:3072 sc1
    v_rcp_f32 v19, v19
    v_mfma_f32_16x16x32_bf16 v[160:163], v[68:71], a[96:99], v[160:163]
    ds_read_b128 v[60:63], v3 offset:32768
    v_exp_f32 v24, v24
    v_mfma_f32_16x16x32_bf16 v[148:151], v[72:75], a[28:31], v[148:151]
    v_fma_f32 v29, v29, v11, v9
    v_mul_f32 v117, v117, v17
    v_fma_f32 v22, v22, v12, v12
    v_mfma_f32_16x16x32_bf16 v[152:155], v[72:75], a[100:103], v[152:155]
    ds_read_b128 v[64:67], v3 offset:33792
    v_mul_f32 v27, v27, v123
    v_mul_f32 v16, v132, v132
    v_mfma_f32_16x16x32_bf16 v[156:159], v[76:79], a[28:31], v[156:159]
    buffer_load_dwordx4 v3, s[4:7], s55 offen offset:3072 sc1 lds
    v_mfma_f32_16x16x32_bf16 v[160:163], v[76:79], a[100:103], v[160:163]
    s_waitcnt lgkmcnt(7)
    ds_read_b128 v[68:71], v3 offset:34816
    v_rcp_f32 v20, v20
    v_mfma_f32_16x16x32_bf16 v[148:151], v[80:83], a[32:35], v[148:151]
    v_exp_f32 v25, v25
    v_fma_f32 v30, v30, v11, v9
    v_mul_f32 v118, v118, v18
    v_mfma_f32_16x16x32_bf16 v[152:155], v[80:83], a[104:107], v[152:155]
    ds_read_b128 v[72:75], v3 offset:35840
    v_fma_f32 v23, v23, v12, v12
    v_mul_f32 v28, v28, v128
    v_mfma_f32_16x16x32_bf16 v[156:159], v[32:35], a[32:35], v[156:159]
    v_mul_f32 v17, v133, v133
    v_cvt_pk_bf16_f32 v180, v116, v117
    v_mfma_f32_16x16x32_bf16 v[160:163], v[32:35], a[104:107], v[160:163]
    ds_read_b128 v[76:79], v3 offset:36864
    v_rcp_f32 v21, v21
    v_mfma_f32_16x16x32_bf16 v[148:151], v[36:39], a[36:39], v[148:151]
    s_add_u32 m0, m0, 4096
    s_add_u32 s55, s55, 4096
    buffer_load_dwordx4 v3, s[4:7], s55 offen offset:0 sc1 lds
    v_exp_f32 v26, v26
    v_mfma_f32_16x16x32_bf16 v[152:155], v[36:39], a[108:111], v[152:155]
    s_waitcnt lgkmcnt(7)
    ds_read_b128 v[80:83], v3 offset:37888
    v_fma_f32 v31, v31, v11, v9
    v_mul_f32 v119, v119, v19
    v_mfma_f32_16x16x32_bf16 v[156:159], v[40:43], a[36:39], v[156:159]
    v_fma_f32 v24, v24, v13, v13
    v_mul_f32 v29, v29, v129
    v_mfma_f32_16x16x32_bf16 v[160:163], v[40:43], a[108:111], v[160:163]
    ds_read_b128 v[32:35], v3 offset:38912
    v_mul_f32 v18, v134, v134
    v_mfma_f32_16x16x32_bf16 v[148:151], v[44:47], a[40:43], v[148:151]
    v_rcp_f32 v22, v22
    v_exp_f32 v27, v27
    v_mfma_f32_16x16x32_bf16 v[152:155], v[44:47], a[112:115], v[152:155]
    ds_read_b128 v[36:39], v3 offset:39936
    v_fma_f32 v16, v16, v10, v8
    v_mul_f32 v124, v124, v20
    v_mfma_f32_16x16x32_bf16 v[156:159], v[48:51], a[40:43], v[156:159]
    buffer_load_dwordx4 v3, s[4:7], s55 offen offset:1024 sc1 lds
    v_fma_f32 v25, v25, v13, v13
    v_mfma_f32_16x16x32_bf16 v[160:163], v[48:51], a[112:115], v[160:163]
    s_waitcnt lgkmcnt(7)
    ds_read_b128 v[40:43], v3 offset:40960
    v_mul_f32 v30, v30, v130
    v_mul_f32 v19, v135, v135
    v_mfma_f32_16x16x32_bf16 v[148:151], v[52:55], a[44:47], v[148:151]
    v_cvt_pk_bf16_f32 v181, v118, v119
    v_rcp_f32 v23, v23
    v_mfma_f32_16x16x32_bf16 v[152:155], v[52:55], a[116:119], v[152:155]
    ds_read_b128 v[44:47], v3 offset:41984
    v_exp_f32 v28, v28
    v_mfma_f32_16x16x32_bf16 v[156:159], v[56:59], a[44:47], v[156:159]
    v_fma_f32 v17, v17, v10, v8
    v_mul_f32 v125, v125, v21
    v_mfma_f32_16x16x32_bf16 v[160:163], v[56:59], a[116:119], v[160:163]
    ds_read_b128 v[48:51], v3 offset:43008
    v_fma_f32 v26, v26, v13, v13
    v_mul_f32 v31, v31, v131
    v_mfma_f32_16x16x32_bf16 v[148:151], v[60:63], a[48:51], v[148:151]
    v_mul_f32 v20, v140, v140
    v_rcp_f32 v24, v24
    v_mfma_f32_16x16x32_bf16 v[152:155], v[60:63], a[120:123], v[152:155]
    s_waitcnt lgkmcnt(7)
    ds_read_b128 v[52:55], v3 offset:44032
    v_exp_f32 v29, v29
    v_mfma_f32_16x16x32_bf16 v[156:159], v[64:67], a[48:51], v[156:159]
    v_fma_f32 v18, v18, v10, v8
    v_mul_f32 v126, v126, v22
    v_mfma_f32_16x16x32_bf16 v[160:163], v[64:67], a[120:123], v[160:163]
    ds_read_b128 v[56:59], v3 offset:45056
    v_fma_f32 v27, v27, v13, v13
    v_mul_f32 v16, v16, v132
    v_mfma_f32_16x16x32_bf16 v[148:151], v[68:71], a[52:55], v[148:151]
    v_mul_f32 v21, v141, v141
    v_cvt_pk_bf16_f32 v182, v124, v125
    v_mfma_f32_16x16x32_bf16 v[152:155], v[68:71], a[124:127], v[152:155]
    ds_read_b128 v[60:63], v3 offset:46080
    v_rcp_f32 v25, v25
    v_mfma_f32_16x16x32_bf16 v[156:159], v[72:75], a[52:55], v[156:159]
    v_exp_f32 v30, v30
    v_fma_f32 v19, v19, v10, v8
    v_mfma_f32_16x16x32_bf16 v[160:163], v[72:75], a[124:127], v[160:163]
    s_waitcnt lgkmcnt(7)
    ds_read_b128 v[64:67], v3 offset:47104
    v_mul_f32 v127, v127, v23
    v_fma_f32 v28, v28, v13, v13
    v_mfma_f32_16x16x32_bf16 v[148:151], v[76:79], a[56:59], v[148:151]
    v_mul_f32 v17, v17, v133
    v_mul_f32 v22, v142, v142
    v_mfma_f32_16x16x32_bf16 v[152:155], v[76:79], a[128:131], v[152:155]
    ds_read_b128 v[68:71], v3 offset:48128
    v_rcp_f32 v26, v26
    v_mfma_f32_16x16x32_bf16 v[156:159], v[80:83], a[56:59], v[156:159]
    v_exp_f32 v31, v31
    v_fma_f32 v20, v20, v10, v8
    v_mfma_f32_16x16x32_bf16 v[160:163], v[80:83], a[128:131], v[160:163]
    s_waitcnt vmcnt(21)
    s_barrier
    ds_read_b128 v[72:75], v3 offset:49152
    v_mul_f32 v120, v120, v24
    v_fma_f32 v29, v29, v13, v13
    v_mfma_f32_16x16x32_bf16 v[148:151], v[32:35], a[60:63], v[148:151]
    s_add_u32 m0, s54, 0
    s_add_u32 s55, s55, 20480
    buffer_load_dwordx4 v3, s[4:7], s55 offen offset:0 sc1 lds
    v_mul_f32 v18, v18, v134
    v_mul_f32 v23, v143, v143
    v_mfma_f32_16x16x32_bf16 v[152:155], v[32:35], a[132:135], v[152:155]
    s_waitcnt lgkmcnt(7)
    ds_read_b128 v[76:79], v3 offset:50176
    v_cvt_pk_bf16_f32 v183, v126, v127
    v_mfma_f32_16x16x32_bf16 v[156:159], v[36:39], a[60:63], v[156:159]
    s_add_u32 s24, s24, 4096
    buffer_store_dwordx4 v[180:183], v3, s[4:7], s24 offen offset:0 sc1
    v_rcp_f32 v27, v27
    v_mfma_f32_16x16x32_bf16 v[160:163], v[36:39], a[132:135], v[160:163]
    ds_read_b128 v[80:83], v3 offset:51200
    v_exp_f32 v16, v16
    v_mfma_f32_16x16x32_bf16 v[148:151], v[40:43], a[64:67], v[148:151]
    v_fma_f32 v21, v21, v10, v8
    v_mul_f32 v121, v121, v25
    v_fma_f32 v30, v30, v13, v13
    v_mfma_f32_16x16x32_bf16 v[152:155], v[40:43], a[136:139], v[152:155]
    ds_read_b128 v[32:35], v3 offset:52224
    v_mul_f32 v19, v19, v135
    v_mul_f32 v24, v136, v136
    v_mfma_f32_16x16x32_bf16 v[156:159], v[44:47], a[64:67], v[156:159]
    buffer_load_dwordx4 v3, s[4:7], s55 offen offset:1024 sc1 lds
    v_mfma_f32_16x16x32_bf16 v[160:163], v[44:47], a[136:139], v[160:163]
    s_waitcnt lgkmcnt(7)
    ds_read_b128 v[36:39], v3 offset:53248
    v_rcp_f32 v28, v28
    v_mfma_f32_16x16x32_bf16 v[148:151], v[48:51], a[68:71], v[148:151]
    v_exp_f32 v17, v17
    v_fma_f32 v22, v22, v10, v8
    v_mul_f32 v122, v122, v26
    v_mfma_f32_16x16x32_bf16 v[152:155], v[48:51], a[140:143], v[152:155]
    ds_read_b128 v[40:43], v3 offset:54272
    v_fma_f32 v31, v31, v13, v13
    v_mul_f32 v20, v20, v140
    v_mfma_f32_16x16x32_bf16 v[156:159], v[52:55], a[68:71], v[156:159]
    v_mul_f32 v25, v137, v137
    v_cvt_pk_bf16_f32 v184, v120, v121
    v_mfma_f32_16x16x32_bf16 v[160:163], v[52:55], a[140:143], v[160:163]
    ds_read_b128 v[44:47], v3 offset:55296
    v_rcp_f32 v29, v29
    v_mfma_f32_16x16x32_bf16 v[148:151], v[56:59], v[244:247], v[148:151]
    buffer_load_dwordx4 v3, s[4:7], s55 offen offset:2048 sc1 lds
    v_exp_f32 v18, v18
    v_mfma_f32_16x16x32_bf16 v[152:155], v[56:59], v[248:251], v[152:155]
    s_waitcnt lgkmcnt(7)
    ds_read_b128 v[48:51], v3 offset:56320
    v_fma_f32 v23, v23, v10, v8
    v_mul_f32 v123, v123, v27
    v_mfma_f32_16x16x32_bf16 v[156:159], v[60:63], v[244:247], v[156:159]
    v_fma_f32 v16, v16, v12, v12
    v_mul_f32 v21, v21, v141
    v_mfma_f32_16x16x32_bf16 v[160:163], v[60:63], v[248:251], v[160:163]
    ds_read_b128 v[52:55], v3 offset:57344
    v_mul_f32 v26, v138, v138
    v_mfma_f32_16x16x32_bf16 v[84:87], v[64:67], a[0:3], 0
    v_rcp_f32 v30, v30
    v_exp_f32 v19, v19
    v_mfma_f32_16x16x32_bf16 v[88:91], v[64:67], a[72:75], 0
    ds_read_b128 v[56:59], v3 offset:58368
    v_fma_f32 v24, v24, v11, v9
    v_mul_f32 v128, v128, v28
    v_mfma_f32_16x16x32_bf16 v[92:95], v[68:71], a[0:3], 0
    buffer_load_dwordx4 v3, s[4:7], s55 offen offset:3072 sc1 lds
    v_fma_f32 v17, v17, v12, v12
    v_mfma_f32_16x16x32_bf16 v[96:99], v[68:71], a[72:75], 0
    s_waitcnt lgkmcnt(7)
    ds_read_b128 v[60:63], v3 offset:59392
    v_mul_f32 v22, v22, v142
    v_mul_f32 v27, v139, v139
    v_mfma_f32_16x16x32_bf16 v[84:87], v[72:75], a[4:7], v[84:87]
    v_cvt_pk_bf16_f32 v185, v122, v123
    v_rcp_f32 v31, v31
    v_mfma_f32_16x16x32_bf16 v[88:91], v[72:75], a[76:79], v[88:91]
    ds_read_b128 v[64:67], v3 offset:60416
    v_exp_f32 v20, v20
    v_mfma_f32_16x16x32_bf16 v[92:95], v[76:79], a[4:7], v[92:95]
    v_fma_f32 v25, v25, v11, v9
    v_mul_f32 v129, v129, v29
    v_mfma_f32_16x16x32_bf16 v[96:99], v[76:79], a[76:79], v[96:99]
    ds_read_b128 v[68:71], v3 offset:61440
    v_fma_f32 v18, v18, v12, v12
    v_mul_f32 v23, v23, v143
    v_mfma_f32_16x16x32_bf16 v[84:87], v[80:83], a[8:11], v[84:87]
    s_add_u32 m0, m0, 4096
    s_add_u32 s55, s55, 4096
    buffer_load_dwordx4 v3, s[4:7], s55 offen offset:0 sc1 lds
    v_mul_f32 v28, v144, v144
    v_mfma_f32_16x16x32_bf16 v[88:91], v[80:83], a[80:83], v[88:91]
    s_waitcnt lgkmcnt(7)
    ds_read_b128 v[72:75], v3 offset:62464
    v_rcp_f32 v16, v16
    v_mfma_f32_16x16x32_bf16 v[92:95], v[32:35], a[8:11], v[92:95]
    v_exp_f32 v21, v21
    v_fma_f32 v26, v26, v11, v9
    v_mfma_f32_16x16x32_bf16 v[96:99], v[32:35], a[80:83], v[96:99]
    ds_read_b128 v[76:79], v3 offset:63488
    v_mul_f32 v130, v130, v30
    v_fma_f32 v19, v19, v12, v12
    v_mfma_f32_16x16x32_bf16 v[84:87], v[36:39], a[12:15], v[84:87]
    v_mul_f32 v24, v24, v136
    v_mul_f32 v29, v145, v145
    v_cvt_pk_bf16_f32 v186, v128, v129
    v_mfma_f32_16x16x32_bf16 v[88:91], v[36:39], a[84:87], v[88:91]
    ds_read_b128 v[80:83], v3 offset:64512
    v_rcp_f32 v17, v17
    v_mfma_f32_16x16x32_bf16 v[92:95], v[40:43], a[12:15], v[92:95]
    buffer_load_dwordx4 v3, s[4:7], s55 offen offset:1024 sc1 lds
    v_mfma_f32_16x16x32_bf16 v[96:99], v[40:43], a[84:87], v[96:99]
    s_waitcnt lgkmcnt(7)
    ds_read_b128 v[32:35], v4 offset:0
    v_exp_f32 v22, v22
    v_fma_f32 v27, v27, v11, v9
    v_mfma_f32_16x16x32_bf16 v[84:87], v[44:47], a[16:19], v[84:87]
    v_mul_f32 v131, v131, v31
    v_fma_f32 v20, v20, v12, v12
    v_mul_f32 v25, v25, v137
    v_mfma_f32_16x16x32_bf16 v[88:91], v[44:47], a[88:91], v[88:91]
    ds_read_b128 v[36:39], v4 offset:1024
    v_mul_f32 v30, v146, v146
    v_mfma_f32_16x16x32_bf16 v[92:95], v[48:51], a[16:19], v[92:95]
    v_rcp_f32 v18, v18
    v_mfma_f32_16x16x32_bf16 v[96:99], v[48:51], a[88:91], v[96:99]
    ds_read_b128 v[40:43], v4 offset:2048
    v_exp_f32 v23, v23
    v_fma_f32 v28, v28, v11, v9
    v_mfma_f32_16x16x32_bf16 v[84:87], v[52:55], a[20:23], v[84:87]
    v_mul_f32 v132, v132, v16
    v_fma_f32 v21, v21, v12, v12
    v_mul_f32 v26, v26, v138
    v_mfma_f32_16x16x32_bf16 v[88:91], v[52:55], a[92:95], v[88:91]
    s_waitcnt lgkmcnt(7)
    ds_read_b128 v[44:47], v4 offset:3072
    v_mul_f32 v31, v147, v147
    v_cvt_pk_bf16_f32 v187, v130, v131
    v_mfma_f32_16x16x32_bf16 v[92:95], v[56:59], a[20:23], v[92:95]
    buffer_store_dwordx4 v[184:187], v3, s[4:7], s24 offen offset:1024 sc1
    v_mfma_f32_16x16x32_bf16 v[96:99], v[56:59], a[92:95], v[96:99]
    ds_read_b128 v[48:51], v4 offset:4096
    v_rcp_f32 v19, v19
    v_mfma_f32_16x16x32_bf16 v[84:87], v[60:63], a[24:27], v[84:87]
    v_exp_f32 v24, v24
    v_fma_f32 v29, v29, v11, v9
    v_mul_f32 v133, v133, v17
    v_mfma_f32_16x16x32_bf16 v[88:91], v[60:63], a[96:99], v[88:91]
    ds_read_b128 v[52:55], v4 offset:5120
    v_fma_f32 v22, v22, v12, v12
    v_mul_f32 v27, v27, v139
    v_mfma_f32_16x16x32_bf16 v[92:95], v[64:67], a[24:27], v[92:95]
    v_mul_f32 v16, v148, v148
    v_mfma_f32_16x16x32_bf16 v[96:99], v[64:67], a[96:99], v[96:99]
    s_waitcnt lgkmcnt(7)
    ds_read_b128 v[56:59], v4 offset:6144
    v_rcp_f32 v20, v20
    v_mfma_f32_16x16x32_bf16 v[84:87], v[68:71], a[28:31], v[84:87]
    v_exp_f32 v25, v25
    v_fma_f32 v30, v30, v11, v9
    v_mul_f32 v134, v134, v18
    v_mfma_f32_16x16x32_bf16 v[88:91], v[68:71], a[100:103], v[88:91]
    ds_read_b128 v[60:63], v4 offset:7168
    v_fma_f32 v23, v23, v12, v12
    v_mul_f32 v28, v28, v144
    v_mfma_f32_16x16x32_bf16 v[92:95], v[72:75], a[28:31], v[92:95]
    v_mul_f32 v17, v149, v149
    v_cvt_pk_bf16_f32 v188, v132, v133
    v_mfma_f32_16x16x32_bf16 v[96:99], v[72:75], a[100:103], v[96:99]
    s_waitcnt vmcnt(22)
    s_barrier
    ds_read_b128 v[64:67], v4 offset:8192
    v_rcp_f32 v21, v21
    v_mfma_f32_16x16x32_bf16 v[84:87], v[76:79], a[32:35], v[84:87]
    s_add_u32 m0, s54, 24576
    s_add_u32 s55, s55, 20480
    buffer_load_dwordx4 v3, s[4:7], s55 offen offset:0 sc1 lds
    v_exp_f32 v26, v26
    v_mfma_f32_16x16x32_bf16 v[88:91], v[76:79], a[104:107], v[88:91]
    s_waitcnt lgkmcnt(7)
    ds_read_b128 v[68:71], v4 offset:9216
    v_fma_f32 v31, v31, v11, v9
    v_mul_f32 v135, v135, v19
    v_mfma_f32_16x16x32_bf16 v[92:95], v[80:83], a[32:35], v[92:95]
    v_fma_f32 v24, v24, v13, v13
    v_mul_f32 v29, v29, v145
    v_mfma_f32_16x16x32_bf16 v[96:99], v[80:83], a[104:107], v[96:99]
    ds_read_b128 v[72:75], v4 offset:10240
    v_mul_f32 v18, v150, v150
    v_mfma_f32_16x16x32_bf16 v[84:87], v[32:35], a[36:39], v[84:87]
    v_rcp_f32 v22, v22
    v_exp_f32 v27, v27
    v_mfma_f32_16x16x32_bf16 v[88:91], v[32:35], a[108:111], v[88:91]
    ds_read_b128 v[76:79], v4 offset:11264
    v_fma_f32 v16, v16, v10, v8
    v_mul_f32 v140, v140, v20
    v_mfma_f32_16x16x32_bf16 v[92:95], v[36:39], a[36:39], v[92:95]
    buffer_load_dwordx4 v3, s[4:7], s55 offen offset:1024 sc1 lds
    v_fma_f32 v25, v25, v13, v13
    v_mfma_f32_16x16x32_bf16 v[96:99], v[36:39], a[108:111], v[96:99]
    s_waitcnt lgkmcnt(7)
    ds_read_b128 v[80:83], v4 offset:12288
    v_mul_f32 v30, v30, v146
    v_mul_f32 v19, v151, v151
    v_mfma_f32_16x16x32_bf16 v[84:87], v[40:43], a[40:43], v[84:87]
    v_cvt_pk_bf16_f32 v189, v134, v135
    v_rcp_f32 v23, v23
    v_mfma_f32_16x16x32_bf16 v[88:91], v[40:43], a[112:115], v[88:91]
    ds_read_b128 v[32:35], v4 offset:13312
    v_exp_f32 v28, v28
    v_mfma_f32_16x16x32_bf16 v[92:95], v[44:47], a[40:43], v[92:95]
    v_fma_f32 v17, v17, v10, v8
    v_mul_f32 v141, v141, v21
    v_mfma_f32_16x16x32_bf16 v[96:99], v[44:47], a[112:115], v[96:99]
    ds_read_b128 v[36:39], v4 offset:14336
    v_fma_f32 v26, v26, v13, v13
    v_mul_f32 v31, v31, v147
    v_mfma_f32_16x16x32_bf16 v[84:87], v[48:51], a[44:47], v[84:87]
    buffer_load_dwordx4 v3, s[4:7], s55 offen offset:2048 sc1 lds
    v_mul_f32 v20, v156, v156
    v_mfma_f32_16x16x32_bf16 v[88:91], v[48:51], a[116:119], v[88:91]
    s_waitcnt lgkmcnt(7)
    ds_read_b128 v[40:43], v4 offset:15360
    v_rcp_f32 v24, v24
    v_mfma_f32_16x16x32_bf16 v[92:95], v[52:55], a[44:47], v[92:95]
    v_exp_f32 v29, v29
    v_fma_f32 v18, v18, v10, v8
    v_mfma_f32_16x16x32_bf16 v[96:99], v[52:55], a[116:119], v[96:99]
    ds_read_b128 v[44:47], v4 offset:16384
    v_mul_f32 v142, v142, v22
    v_fma_f32 v27, v27, v13, v13
    v_mfma_f32_16x16x32_bf16 v[84:87], v[56:59], a[48:51], v[84:87]
    v_mul_f32 v16, v16, v148
    v_mul_f32 v21, v157, v157
    v_cvt_pk_bf16_f32 v190, v140, v141
    v_mfma_f32_16x16x32_bf16 v[88:91], v[56:59], a[120:123], v[88:91]
    ds_read_b128 v[48:51], v4 offset:17408
    v_rcp_f32 v25, v25
    v_mfma_f32_16x16x32_bf16 v[92:95], v[60:63], a[48:51], v[92:95]
    buffer_load_dwordx4 v3, s[4:7], s55 offen offset:3072 sc1 lds
    v_mfma_f32_16x16x32_bf16 v[96:99], v[60:63], a[120:123], v[96:99]
    s_waitcnt lgkmcnt(7)
    ds_read_b128 v[52:55], v4 offset:18432
    v_exp_f32 v30, v30
    v_fma_f32 v19, v19, v10, v8
    v_mfma_f32_16x16x32_bf16 v[84:87], v[64:67], a[52:55], v[84:87]
    v_mul_f32 v143, v143, v23
    v_fma_f32 v28, v28, v13, v13
    v_mul_f32 v17, v17, v149
    v_mfma_f32_16x16x32_bf16 v[88:91], v[64:67], a[124:127], v[88:91]
    ds_read_b128 v[56:59], v4 offset:19456
    v_mul_f32 v22, v158, v158
    v_mfma_f32_16x16x32_bf16 v[92:95], v[68:71], a[52:55], v[92:95]
    v_rcp_f32 v26, v26
    v_mfma_f32_16x16x32_bf16 v[96:99], v[68:71], a[124:127], v[96:99]
    ds_read_b128 v[60:63], v4 offset:20480
    v_exp_f32 v31, v31
    v_fma_f32 v20, v20, v10, v8
    v_mfma_f32_16x16x32_bf16 v[84:87], v[72:75], a[56:59], v[84:87]
    s_add_u32 m0, m0, 4096
    s_add_u32 s55, s55, 4096
    buffer_load_dwordx4 v3, s[4:7], s55 offen offset:0 sc1 lds
    v_mul_f32 v136, v136, v24
    v_fma_f32 v29, v29, v13, v13
    v_mfma_f32_16x16x32_bf16 v[88:91], v[72:75], a[128:131], v[88:91]
    s_waitcnt lgkmcnt(7)
    ds_read_b128 v[64:67], v4 offset:21504
    v_mul_f32 v18, v18, v150
    v_mul_f32 v23, v159, v159
    v_mfma_f32_16x16x32_bf16 v[92:95], v[76:79], a[56:59], v[92:95]
    v_cvt_pk_bf16_f32 v191, v142, v143
    v_mfma_f32_16x16x32_bf16 v[96:99], v[76:79], a[128:131], v[96:99]
    ds_read_b128 v[68:71], v4 offset:22528
    v_rcp_f32 v27, v27
    v_mfma_f32_16x16x32_bf16 v[84:87], v[80:83], a[60:63], v[84:87]
    s_mov_b32 s101, main_kernel_c0+16384-main_kernel_pc
    s_load_dword s100, s[98:99], s101
    s_load_dword s100, s[98:99], s101 offset:64
    v_exp_f32 v16, v16
    v_fma_f32 v21, v21, v10, v8
    v_mul_f32 v137, v137, v25
    v_mfma_f32_16x16x32_bf16 v[88:91], v[80:83], a[132:135], v[88:91]
    ds_read_b128 v[72:75], v4 offset:23552
    v_fma_f32 v30, v30, v13, v13
    v_mul_f32 v19, v19, v151
    v_mfma_f32_16x16x32_bf16 v[92:95], v[32:35], a[60:63], v[92:95]
    buffer_store_dwordx4 v[188:191], v3, s[4:7], s24 offen offset:2048 sc1
    v_mul_f32 v24, v152, v152
    v_mfma_f32_16x16x32_bf16 v[96:99], v[32:35], a[132:135], v[96:99]
    s_waitcnt lgkmcnt(7)
    ds_read_b128 v[76:79], v4 offset:24576
    v_rcp_f32 v28, v28
    v_mfma_f32_16x16x32_bf16 v[84:87], v[36:39], a[64:67], v[84:87]
    buffer_load_dwordx4 v3, s[4:7], s55 offen offset:1024 sc1 lds
    v_exp_f32 v17, v17
    v_mfma_f32_16x16x32_bf16 v[88:91], v[36:39], a[136:139], v[88:91]
    ds_read_b128 v[80:83], v4 offset:25600
    v_fma_f32 v22, v22, v10, v8
    v_mul_f32 v138, v138, v26
    v_mfma_f32_16x16x32_bf16 v[92:95], v[40:43], a[64:67], v[92:95]
    v_fma_f32 v31, v31, v13, v13
    v_mul_f32 v20, v20, v156
    v_mfma_f32_16x16x32_bf16 v[96:99], v[40:43], a[136:139], v[96:99]
    ds_read_b128 v[32:35], v4 offset:26624
    v_mul_f32 v25, v153, v153
    v_cvt_pk_bf16_f32 v192, v136, v137
    v_mfma_f32_16x16x32_bf16 v[84:87], v[44:47], a[68:71], v[84:87]
    v_rcp_f32 v29, v29
    v_mfma_f32_16x16x32_bf16 v[88:91], v[44:47], a[140:143], v[88:91]
    s_waitcnt lgkmcnt(7)
    ds_read_b128 v[36:39], v4 offset:27648
    v_exp_f32 v18, v18
    v_fma_f32 v23, v23, v10, v8
    v_mfma_f32_16x16x32_bf16 v[92:95], v[48:51], a[68:71], v[92:95]
    v_mul_f32 v139, v139, v27
    v_fma_f32 v16, v16, v12, v12
    v_mfma_f32_16x16x32_bf16 v[96:99], v[48:51], a[140:143], v[96:99]
    ds_read_b128 v[40:43], v4 offset:28672
    v_mul_f32 v21, v21, v157
    v_mul_f32 v26, v154, v154
    v_mfma_f32_16x16x32_bf16 v[84:87], v[52:55], v[244:247], v[84:87]
    v_rcp_f32 v30, v30
    v_mfma_f32_16x16x32_bf16 v[88:91], v[52:55], v[248:251], v[88:91]
    ds_read_b128 v[44:47], v4 offset:29696
    v_exp_f32 v19, v19
    v_fma_f32 v24, v24, v11, v9
    v_mfma_f32_16x16x32_bf16 v[92:95], v[56:59], v[244:247], v[92:95]
    v_mul_f32 v144, v144, v28
    v_fma_f32 v17, v17, v12, v12
    v_mfma_f32_16x16x32_bf16 v[96:99], v[56:59], v[248:251], v[96:99]
    s_waitcnt lgkmcnt(7)
    ds_read_b128 v[48:51], v4 offset:30720
    v_mul_f32 v22, v22, v158
    v_mul_f32 v27, v155, v155
    v_mfma_f32_16x16x32_bf16 v[100:103], v[60:63], a[0:3], 0
    v_cvt_pk_bf16_f32 v193, v138, v139
    v_rcp_f32 v31, v31
    v_mfma_f32_16x16x32_bf16 v[104:107], v[60:63], a[72:75], 0
    ds_read_b128 v[52:55], v4 offset:31744
    v_exp_f32 v20, v20
    v_mfma_f32_16x16x32_bf16 v[108:111], v[64:67], a[0:3], 0
    v_fma_f32 v25, v25, v11, v9
    v_mul_f32 v145, v145, v29
    v_mfma_f32_16x16x32_bf16 v[112:115], v[64:67], a[72:75], 0
    s_waitcnt vmcnt(22)
    s_barrier
    ds_read_b128 v[56:59], v4 offset:32768
    v_fma_f32 v18, v18, v12, v12
    v_mul_f32 v23, v23, v159
    v_mfma_f32_16x16x32_bf16 v[100:103], v[68:71], a[4:7], v[100:103]
    s_add_u32 m0, s54, 49152
    s_add_u32 s55, s55, 20480
    buffer_load_dwordx4 v3, s[4:7], s55 offen offset:0 sc1 lds
    v_mul_f32 v28, v160, v160
    v_mfma_f32_16x16x32_bf16 v[104:107], v[68:71], a[76:79], v[104:107]
    s_waitcnt lgkmcnt(7)
    ds_read_b128 v[60:63], v4 offset:33792
    v_rcp_f32 v16, v16
    v_mfma_f32_16x16x32_bf16 v[108:111], v[72:75], a[4:7], v[108:111]
    v_exp_f32 v21, v21
    v_fma_f32 v26, v26, v11, v9
    v_mfma_f32_16x16x32_bf16 v[112:115], v[72:75], a[76:79], v[112:115]
    ds_read_b128 v[64:67], v4 offset:34816
    v_mul_f32 v146, v146, v30
    v_fma_f32 v19, v19, v12, v12
    v_mfma_f32_16x16x32_bf16 v[100:103], v[76:79], a[8:11], v[100:103]
    v_mul_f32 v24, v24, v152
    v_mul_f32 v29, v161, v161
    v_cvt_pk_bf16_f32 v194, v144, v145
    v_mfma_f32_16x16x32_bf16 v[104:107], v[76:79], a[80:83], v[104:107]
    ds_read_b128 v[68:71], v4 offset:35840
    v_rcp_f32 v17, v17
    v_mfma_f32_16x16x32_bf16 v[108:111], v[80:83], a[8:11], v[108:111]
    buffer_load_dwordx4 v3, s[4:7], s55 offen offset:1024 sc1 lds
    v_mfma_f32_16x16x32_bf16 v[112:115], v[80:83], a[80:83], v[112:115]
    s_waitcnt lgkmcnt(7)
    ds_read_b128 v[72:75], v4 offset:36864
    v_exp_f32 v22, v22
    v_fma_f32 v27, v27, v11, v9
    v_mfma_f32_16x16x32_bf16 v[100:103], v[32:35], a[12:15], v[100:103]
    v_mul_f32 v147, v147, v31
    v_fma_f32 v20, v20, v12, v12
    v_mul_f32 v25, v25, v153
    v_mfma_f32_16x16x32_bf16 v[104:107], v[32:35], a[84:87], v[104:107]
    ds_read_b128 v[76:79], v4 offset:37888
    v_mul_f32 v30, v162, v162
    v_mfma_f32_16x16x32_bf16 v[108:111], v[36:39], a[12:15], v[108:111]
    v_rcp_f32 v18, v18
    v_mfma_f32_16x16x32_bf16 v[112:115], v[36:39], a[84:87], v[112:115]
    ds_read_b128 v[80:83], v4 offset:38912
    v_exp_f32 v23, v23
    v_fma_f32 v28, v28, v11, v9
    v_mfma_f32_16x16x32_bf16 v[100:103], v[40:43], a[16:19], v[100:103]
    s_waitcnt vmcnt(9)
    s_mov_b64 exec, 1
    buffer_store_dword v236, v7, s[4:7], s26 offen sc1
    s_mov_b64 exec, -1
    v_mul_f32 v148, v148, v16
    v_mfma_f32_16x16x32_bf16 v[104:107], v[40:43], a[88:91], v[104:107]
    s_waitcnt lgkmcnt(7)
    ds_read_b128 v[32:35], v4 offset:39936
    v_fma_f32 v21, v21, v12, v12
    v_mul_f32 v26, v26, v154
    v_mfma_f32_16x16x32_bf16 v[108:111], v[44:47], a[16:19], v[108:111]
    buffer_load_dwordx4 v3, s[4:7], s55 offen offset:2048 sc1 lds
    v_mul_f32 v31, v163, v163
    v_mfma_f32_16x16x32_bf16 v[112:115], v[44:47], a[88:91], v[112:115]
    ds_read_b128 v[36:39], v4 offset:40960
    v_cvt_pk_bf16_f32 v195, v146, v147
    v_mfma_f32_16x16x32_bf16 v[100:103], v[48:51], a[20:23], v[100:103]
    buffer_store_dwordx4 v[192:195], v3, s[4:7], s24 offen offset:3072 sc1
    v_rcp_f32 v19, v19
    v_mfma_f32_16x16x32_bf16 v[104:107], v[48:51], a[92:95], v[104:107]
    ds_read_b128 v[40:43], v4 offset:41984
    v_exp_f32 v24, v24
    v_fma_f32 v29, v29, v11, v9
    v_mfma_f32_16x16x32_bf16 v[108:111], v[52:55], a[20:23], v[108:111]
    v_mul_f32 v149, v149, v17
    v_fma_f32 v22, v22, v12, v12
    v_mfma_f32_16x16x32_bf16 v[112:115], v[52:55], a[92:95], v[112:115]
    s_waitcnt lgkmcnt(7)
    ds_read_b128 v[44:47], v4 offset:43008
    v_mul_f32 v27, v27, v155
    v_mul_f32 v16, v84, v84
    v_mfma_f32_16x16x32_bf16 v[100:103], v[56:59], a[24:27], v[100:103]
    buffer_load_dwordx4 v3, s[4:7], s55 offen offset:3072 sc1 lds
    v_rcp_f32 v20, v20
    v_mfma_f32_16x16x32_bf16 v[104:107], v[56:59], a[96:99], v[104:107]
    ds_read_b128 v[48:51], v4 offset:44032
    v_exp_f32 v25, v25
    v_mfma_f32_16x16x32_bf16 v[108:111], v[60:63], a[24:27], v[108:111]
    v_fma_f32 v30, v30, v11, v9
    v_mul_f32 v150, v150, v18
    v_mfma_f32_16x16x32_bf16 v[112:115], v[60:63], a[96:99], v[112:115]
    ds_read_b128 v[52:55], v4 offset:45056
    v_fma_f32 v23, v23, v12, v12
    v_mul_f32 v28, v28, v160
    v_mfma_f32_16x16x32_bf16 v[100:103], v[64:67], a[28:31], v[100:103]
    v_mul_f32 v17, v85, v85
    v_cvt_pk_bf16_f32 v196, v148, v149
    v_mfma_f32_16x16x32_bf16 v[104:107], v[64:67], a[100:103], v[104:107]
    s_waitcnt lgkmcnt(7)
    ds_read_b128 v[56:59], v4 offset:46080
    v_rcp_f32 v21, v21
    v_mfma_f32_16x16x32_bf16 v[108:111], v[68:71], a[28:31], v[108:111]
    s_add_u32 m0, m0, 4096
    s_add_u32 s55, s55, 4096
    buffer_load_dwordx4 v3, s[4:7], s55 offen offset:0 sc1 lds
    v_exp_f32 v26, v26
    v_mfma_f32_16x16x32_bf16 v[112:115], v[68:71], a[100:103], v[112:115]
    ds_read_b128 v[60:63], v4 offset:47104
    v_fma_f32 v31, v31, v11, v9
    v_mul_f32 v151, v151, v19
    v_mfma_f32_16x16x32_bf16 v[100:103], v[72:75], a[32:35], v[100:103]
    v_fma_f32 v24, v24, v13, v13
    v_mul_f32 v29, v29, v161
    v_mul_f32 v18, v86, v86
    v_mfma_f32_16x16x32_bf16 v[104:107], v[72:75], a[104:107], v[104:107]
    ds_read_b128 v[64:67], v4 offset:48128
    v_rcp_f32 v22, v22
    v_mfma_f32_16x16x32_bf16 v[108:111], v[76:79], a[32:35], v[108:111]
    v_exp_f32 v27, v27
    v_mfma_f32_16x16x32_bf16 v[112:115], v[76:79], a[104:107], v[112:115]
    s_waitcnt lgkmcnt(7)
    ds_read_b128 v[68:71], v4 offset:49152
    v_fma_f32 v16, v16, v10, v8
    v_mul_f32 v156, v156, v20
    v_mfma_f32_16x16x32_bf16 v[100:103], v[80:83], a[36:39], v[100:103]
    buffer_load_dwordx4 v3, s[4:7], s55 offen offset:1024 sc1 lds
    v_fma_f32 v25, v25, v13, v13
    v_mul_f32 v30, v30, v162
    v_mfma_f32_16x16x32_bf16 v[104:107], v[80:83], a[108:111], v[104:107]
    ds_read_b128 v[72:75], v4 offset:50176
    v_mul_f32 v19, v87, v87
    v_cvt_pk_bf16_f32 v197, v150, v151
    v_mfma_f32_16x16x32_bf16 v[108:111], v[32:35], a[36:39], v[108:111]
    v_rcp_f32 v23, v23
    v_mfma_f32_16x16x32_bf16 v[112:115], v[32:35], a[108:111], v[112:115]
    ds_read_b128 v[76:79], v4 offset:51200
    v_exp_f32 v28, v28
    v_mfma_f32_16x16x32_bf16 v[100:103], v[36:39], a[40:43], v[100:103]
    v_fma_f32 v17, v17, v10, v8
    v_mul_f32 v157, v157, v21
    v_fma_f32 v26, v26, v13, v13
    v_mfma_f32_16x16x32_bf16 v[104:107], v[36:39], a[112:115], v[104:107]
    s_waitcnt lgkmcnt(7)
    ds_read_b128 v[80:83], v4 offset:52224
    v_mul_f32 v31, v31, v163
    v_mul_f32 v20, v92, v92
    v_mfma_f32_16x16x32_bf16 v[108:111], v[40:43], a[40:43], v[108:111]
    v_rcp_f32 v24, v24
    v_mfma_f32_16x16x32_bf16 v[112:115], v[40:43], a[112:115], v[112:115]
    ds_read_b128 v[32:35], v4 offset:53248
    v_exp_f32 v29, v29
    v_mfma_f32_16x16x32_bf16 v[100:103], v[44:47], a[44:47], v[100:103]
    v_fma_f32 v18, v18, v10, v8
    v_mul_f32 v158, v158, v22
    v_fma_f32 v27, v27, v13, v13
    v_mfma_f32_16x16x32_bf16 v[104:107], v[44:47], a[116:119], v[104:107]
    ds_read_b128 v[36:39], v4 offset:54272
    v_mul_f32 v16, v16, v84
    v_mul_f32 v21, v93, v93
    v_mfma_f32_16x16x32_bf16 v[108:111], v[48:51], a[44:47], v[108:111]
    v_cvt_pk_bf16_f32 v198, v156, v157
    v_mfma_f32_16x16x32_bf16 v[112:115], v[48:51], a[116:119], v[112:115]
    s_waitcnt lgkmcnt(7)
    ds_read_b128 v[40:43], v4 offset:55296
    v_rcp_f32 v25, v25
    v_mfma_f32_16x16x32_bf16 v[100:103], v[52:55], a[48:51], v[100:103]
    v_exp_f32 v30, v30
    v_fma_f32 v19, v19, v10, v8
    v_mul_f32 v159, v159, v23
    v_mfma_f32_16x16x32_bf16 v[104:107], v[52:55], a[120:123], v[104:107]
    ds_read_b128 v[44:47], v4 offset:56320
    v_fma_f32 v28, v28, v13, v13
    v_mul_f32 v17, v17, v85
    v_mfma_f32_16x16x32_bf16 v[108:111], v[56:59], a[48:51], v[108:111]
    v_mul_f32 v22, v94, v94
    v_mfma_f32_16x16x32_bf16 v[112:115], v[56:59], a[120:123], v[112:115]
    s_barrier
    ds_read_b128 v[48:51], v4 offset:57344
    v_rcp_f32 v26, v26
    v_mfma_f32_16x16x32_bf16 v[100:103], v[60:63], a[52:55], v[100:103]
    s_add_u32 m0, s54, 73728
    s_add_u32 s55, s55, 20480
    buffer_load_dwordx4 v3, s[4:7], s55 offen offset:0 sc1 lds
    v_exp_f32 v31, v31
    v_fma_f32 v20, v20, v10, v8
    v_mfma_f32_16x16x32_bf16 v[104:107], v[60:63], a[124:127], v[104:107]
    s_waitcnt lgkmcnt(7)
    ds_read_b128 v[52:55], v4 offset:58368
    v_mul_f32 v152, v152, v24
    v_fma_f32 v29, v29, v13, v13
    v_mfma_f32_16x16x32_bf16 v[108:111], v[64:67], a[52:55], v[108:111]
    v_mul_f32 v18, v18, v86
    v_mul_f32 v23, v95, v95
    v_mfma_f32_16x16x32_bf16 v[112:115], v[64:67], a[124:127], v[112:115]
    ds_read_b128 v[56:59], v4 offset:59392
    v_cvt_pk_bf16_f32 v199, v158, v159
    v_mfma_f32_16x16x32_bf16 v[100:103], v[68:71], a[56:59], v[100:103]
    s_add_u32 s24, s24, 4096
    buffer_store_dwordx4 v[196:199], v3, s[4:7], s24 offen offset:0 sc1
    v_rcp_f32 v27, v27
    v_mfma_f32_16x16x32_bf16 v[104:107], v[68:71], a[128:131], v[104:107]
    ds_read_b128 v[60:63], v4 offset:60416
    v_exp_f32 v16, v16
    v_fma_f32 v21, v21, v10, v8
    v_mfma_f32_16x16x32_bf16 v[108:111], v[72:75], a[56:59], v[108:111]
    buffer_load_dwordx4 v3, s[4:7], s55 offen offset:1024 sc1 lds
    v_mul_f32 v153, v153, v25
    v_mfma_f32_16x16x32_bf16 v[112:115], v[72:75], a[128:131], v[112:115]
    s_waitcnt lgkmcnt(7)
    ds_read_b128 v[64:67], v4 offset:61440
    v_fma_f32 v30, v30, v13, v13
    v_mul_f32 v19, v19, v87
    v_mfma_f32_16x16x32_bf16 v[100:103], v[76:79], a[60:63], v[100:103]
    v_mul_f32 v24, v88, v88
    v_rcp_f32 v28, v28
    v_mfma_f32_16x16x32_bf16 v[104:107], v[76:79], a[132:135], v[104:107]
    ds_read_b128 v[68:71], v4 offset:62464
    v_exp_f32 v17, v17
    v_mfma_f32_16x16x32_bf16 v[108:111], v[80:83], a[60:63], v[108:111]
    v_fma_f32 v22, v22, v10, v8
    v_mul_f32 v154, v154, v26
    v_mfma_f32_16x16x32_bf16 v[112:115], v[80:83], a[132:135], v[112:115]
    ds_read_b128 v[72:75], v4 offset:63488
    v_fma_f32 v31, v31, v13, v13
    v_mul_f32 v20, v20, v92
    v_mfma_f32_16x16x32_bf16 v[100:103], v[32:35], a[64:67], v[100:103]
    buffer_load_dwordx4 v3, s[4:7], s55 offen offset:2048 sc1 lds
    v_mul_f32 v25, v89, v89
    v_cvt_pk_bf16_f32 v200, v152, v153
    v_mfma_f32_16x16x32_bf16 v[104:107], v[32:35], a[136:139], v[104:107]
    s_waitcnt lgkmcnt(7)
    ds_read_b128 v[76:79], v4 offset:64512
    v_rcp_f32 v29, v29
    v_mfma_f32_16x16x32_bf16 v[108:111], v[36:39], a[64:67], v[108:111]
    v_exp_f32 v18, v18
    v_mfma_f32_16x16x32_bf16 v[112:115], v[36:39], a[136:139], v[112:115]
    ds_read_b128 v[80:83], v5 offset:0
    v_fma_f32 v23, v23, v10, v8
    v_mul_f32 v155, v155, v27
    v_mfma_f32_16x16x32_bf16 v[100:103], v[40:43], a[68:71], v[100:103]
    v_fma_f32 v16, v16, v12, v12
    v_mul_f32 v21, v21, v93
    v_mul_f32 v26, v90, v90
    v_mfma_f32_16x16x32_bf16 v[104:107], v[40:43], a[140:143], v[104:107]
    ds_read_b128 v[32:35], v5 offset:1024
    v_rcp_f32 v30, v30
    v_mfma_f32_16x16x32_bf16 v[108:111], v[44:47], a[68:71], v[108:111]
    buffer_load_dwordx4 v3, s[4:7], s55 offen offset:3072 sc1 lds
    v_mfma_f32_16x16x32_bf16 v[112:115], v[44:47], a[140:143], v[112:115]
    s_waitcnt lgkmcnt(7)
    ds_read_b128 v[36:39], v5 offset:2048
    v_exp_f32 v19, v19
    v_fma_f32 v24, v24, v11, v9
    v_mfma_f32_16x16x32_bf16 v[100:103], v[48:51], v[244:247], v[100:103]
    v_mul_f32 v160, v160, v28
    v_fma_f32 v17, v17, v12, v12
    v_mul_f32 v22, v22, v94
    v_mfma_f32_16x16x32_bf16 v[104:107], v[48:51], v[248:251], v[104:107]
    ds_read_b128 v[40:43], v5 offset:3072
    v_mul_f32 v27, v91, v91
    v_cvt_pk_bf16_f32 v201, v154, v155
    v_mfma_f32_16x16x32_bf16 v[108:111], v[52:55], v[244:247], v[108:111]
    v_rcp_f32 v31, v31
    v_mfma_f32_16x16x32_bf16 v[112:115], v[52:55], v[248:251], v[112:115]
    ds_read_b128 v[44:47], v5 offset:4096
    v_exp_f32 v20, v20
    v_mfma_f32_16x16x32_bf16 v[116:119], v[56:59], a[0:3], 0
    s_mov_b64 exec, 15
    buffer_load_dword v2, v15, s[4:7], s27 offen sc1
    s_mov_b64 exec, -1
    v_fma_f32 v25, v25, v11, v9
    v_mfma_f32_16x16x32_bf16 v[120:123], v[56:59], a[72:75], 0
    s_waitcnt lgkmcnt(7)
    ds_read_b128 v[48:51], v5 offset:5120
    v_mul_f32 v161, v161, v29
    v_fma_f32 v18, v18, v12, v12
    v_mfma_f32_16x16x32_bf16 v[124:127], v[60:63], a[0:3], 0
    s_add_u32 m0, m0, 4096
    s_add_u32 s55, s55, 4096
    buffer_load_dwordx4 v3, s[4:7], s55 offen offset:0 sc1 lds
    v_mul_f32 v23, v23, v95
    v_mfma_f32_16x16x32_bf16 v[128:131], v[60:63], a[72:75], 0
    ds_read_b128 v[52:55], v5 offset:6144
    v_mul_f32 v28, v96, v96
    v_mfma_f32_16x16x32_bf16 v[116:119], v[64:67], a[4:7], v[116:119]
    v_rcp_f32 v16, v16
    v_exp_f32 v21, v21
    v_mfma_f32_16x16x32_bf16 v[120:123], v[64:67], a[76:79], v[120:123]
    ds_read_b128 v[56:59], v5 offset:7168
    v_fma_f32 v26, v26, v11, v9
    v_mul_f32 v162, v162, v30
    v_mfma_f32_16x16x32_bf16 v[124:127], v[68:71], a[4:7], v[124:127]
    v_fma_f32 v19, v19, v12, v12
    v_mul_f32 v24, v24, v88
    v_mfma_f32_16x16x32_bf16 v[128:131], v[68:71], a[76:79], v[128:131]
    s_waitcnt lgkmcnt(7)
    ds_read_b128 v[60:63], v5 offset:8192
    v_mul_f32 v29, v97, v97
    v_cvt_pk_bf16_f32 v202, v160, v161
    v_mfma_f32_16x16x32_bf16 v[116:119], v[72:75], a[8:11], v[116:119]
    buffer_load_dwordx4 v3, s[4:7], s55 offen offset:1024 sc1 lds
    v_rcp_f32 v17, v17
    v_mfma_f32_16x16x32_bf16 v[120:123], v[72:75], a[80:83], v[120:123]
    ds_read_b128 v[64:67], v5 offset:9216
    v_exp_f32 v22, v22
    v_mfma_f32_16x16x32_bf16 v[124:127], v[76:79], a[8:11], v[124:127]
    v_fma_f32 v27, v27, v11, v9
    v_mul_f32 v163, v163, v31
    v_mfma_f32_16x16x32_bf16 v[128:131], v[76:79], a[80:83], v[128:131]
    ds_read_b128 v[68:71], v5 offset:10240
    v_fma_f32 v20, v20, v12, v12
    v_mul_f32 v25, v25, v89
    v_mfma_f32_16x16x32_bf16 v[116:119], v[80:83], a[12:15], v[116:119]
    v_mul_f32 v30, v98, v98
    v_rcp_f32 v18, v18
    v_mfma_f32_16x16x32_bf16 v[120:123], v[80:83], a[84:87], v[120:123]
    s_waitcnt lgkmcnt(7)
    ds_read_b128 v[72:75], v5 offset:11264
    v_exp_f32 v23, v23
    v_mfma_f32_16x16x32_bf16 v[124:127], v[32:35], a[12:15], v[124:127]
    v_fma_f32 v28, v28, v11, v9
    v_mul_f32 v84, v84, v16
    v_mfma_f32_16x16x32_bf16 v[128:131], v[32:35], a[84:87], v[128:131]
    ds_read_b128 v[76:79], v5 offset:12288
    v_fma_f32 v21, v21, v12, v12
    v_mul_f32 v26, v26, v90
    v_mfma_f32_16x16x32_bf16 v[116:119], v[36:39], a[16:19], v[116:119]
    v_mul_f32 v31, v99, v99
    v_cvt_pk_bf16_f32 v203, v162, v163
    v_mfma_f32_16x16x32_bf16 v[120:123], v[36:39], a[88:91], v[120:123]
    ds_read_b128 v[80:83], v5 offset:13312
    v_rcp_f32 v19, v19
    v_mfma_f32_16x16x32_bf16 v[124:127], v[40:43], a[16:19], v[124:127]
    buffer_store_dwordx4 v[200:203], v3, s[4:7], s24 offen offset:1024 sc1
    v_exp_f32 v24, v24
    v_mfma_f32_16x16x32_bf16 v[128:131], v[40:43], a[88:91], v[128:131]
    s_waitcnt lgkmcnt(7)
    ds_read_b128 v[32:35], v5 offset:14336
    v_fma_f32 v29, v29, v11, v9
    v_mul_f32 v85, v85, v17
    v_mfma_f32_16x16x32_bf16 v[116:119], v[44:47], a[20:23], v[116:119]
    v_fma_f32 v22, v22, v12, v12
    v_mul_f32 v27, v27, v91
    v_mul_f32 v16, v100, v100
    v_mfma_f32_16x16x32_bf16 v[120:123], v[44:47], a[92:95], v[120:123]
    ds_read_b128 v[36:39], v5 offset:15360
    v_rcp_f32 v20, v20
    v_mfma_f32_16x16x32_bf16 v[124:127], v[48:51], a[20:23], v[124:127]
    v_exp_f32 v25, v25
    v_mfma_f32_16x16x32_bf16 v[128:131], v[48:51], a[92:95], v[128:131]
    s_barrier
    ds_read_b128 v[40:43], v3 offset:0
    v_fma_f32 v30, v30, v11, v9
    v_mul_f32 v86, v86, v18
    v_mfma_f32_16x16x32_bf16 v[116:119], v[52:55], a[24:27], v[116:119]
    s_add_u32 m0, s54, 98304
    s_add_u32 s55, s55, 20480
    buffer_load_dwordx4 v3, s[4:7], s55 offen offset:0 sc1 lds
    v_fma_f32 v23, v23, v12, v12
    v_mul_f32 v28, v28, v96
    v_mfma_f32_16x16x32_bf16 v[120:123], v[52:55], a[96:99], v[120:123]
    s_waitcnt lgkmcnt(7)
    ds_read_b128 v[44:47], v3 offset:1024
    v_mul_f32 v17, v101, v101
    v_cvt_pk_bf16_f32 v204, v84, v85
    v_mfma_f32_16x16x32_bf16 v[124:127], v[56:59], a[24:27], v[124:127]
    v_rcp_f32 v21, v21
    v_mfma_f32_16x16x32_bf16 v[128:131], v[56:59], a[96:99], v[128:131]
    ds_read_b128 v[48:51], v3 offset:2048
    v_exp_f32 v26, v26
    v_mfma_f32_16x16x32_bf16 v[116:119], v[60:63], a[28:31], v[116:119]
    v_fma_f32 v31, v31, v11, v9
    v_mul_f32 v87, v87, v19
    v_fma_f32 v24, v24, v13, v13
    v_mfma_f32_16x16x32_bf16 v[120:123], v[60:63], a[100:103], v[120:123]
    ds_read_b128 v[52:55], v3 offset:3072
    v_mul_f32 v29, v29, v97
    v_mul_f32 v18, v102, v102
    v_mfma_f32_16x16x32_bf16 v[124:127], v[64:67], a[28:31], v[124:127]
    buffer_load_dwordx4 v3, s[4:7], s55 offen offset:1024 sc1 lds
    v_mfma_f32_16x16x32_bf16 v[128:131], v[64:67], a[100:103], v[128:131]
    s_waitcnt lgkmcnt(7)
    ds_read_b128 v[56:59], v3 offset:4096
    v_rcp_f32 v22, v22
    v_mfma_f32_16x16x32_bf16 v[116:119], v[68:71], a[32:35], v[116:119]
    v_exp_f32 v27, v27
    v_fma_f32 v16, v16, v10, v8
    v_mul_f32 v92, v92, v20
    v_mfma_f32_16x16x32_bf16 v[120:123], v[68:71], a[104:107], v[120:123]
    ds_read_b128 v[60:63], v3 offset:5120
    v_fma_f32 v25, v25, v13, v13
    v_mul_f32 v30, v30, v98
    v_mfma_f32_16x16x32_bf16 v[124:127], v[72:75], a[32:35], v[124:127]
    v_mul_f32 v19, v103, v103
    v_cvt_pk_bf16_f32 v205, v86, v87
    v_mfma_f32_16x16x32_bf16 v[128:131], v[72:75], a[104:107], v[128:131]
    ds_read_b128 v[64:67], v3 offset:6144
    v_rcp_f32 v23, v23
    v_mfma_f32_16x16x32_bf16 v[116:119], v[76:79], a[36:39], v[116:119]
    buffer_load_dwordx4 v3, s[4:7], s55 offen offset:2048 sc1 lds
    v_exp_f32 v28, v28
    v_mfma_f32_16x16x32_bf16 v[120:123], v[76:79], a[108:111], v[120:123]
    s_waitcnt lgkmcnt(7)
    ds_read_b128 v[68:71], v3 offset:7168
    v_fma_f32 v17, v17, v10, v8
    v_mul_f32 v93, v93, v21
    v_mfma_f32_16x16x32_bf16 v[124:127], v[80:83], a[36:39], v[124:127]
    v_fma_f32 v26, v26, v13, v13
    v_mul_f32 v31, v31, v99
    v_mfma_f32_16x16x32_bf16 v[128:131], v[80:83], a[108:111], v[128:131]
    ds_read_b128 v[72:75], v3 offset:8192
    v_mul_f32 v20, v108, v108
    v_mfma_f32_16x16x32_bf16 v[116:119], v[32:35], a[40:43], v[116:119]
    v_rcp_f32 v24, v24
    v_exp_f32 v29, v29
    v_mfma_f32_16x16x32_bf16 v[120:123], v[32:35], a[112:115], v[120:123]
    ds_read_b128 v[76:79], v3 offset:9216
    v_fma_f32 v18, v18, v10, v8
    v_mul_f32 v94, v94, v22
    v_mfma_f32_16x16x32_bf16 v[124:127], v[36:39], a[40:43], v[124:127]
    buffer_load_dwordx4 v3, s[4:7], s55 offen offset:3072 sc1 lds
    v_fma_f32 v27, v27, v13, v13
    v_mfma_f32_16x16x32_bf16 v[128:131], v[36:39], a[112:115], v[128:131]
    s_waitcnt lgkmcnt(7)
    ds_read_b128 v[80:83], v3 offset:10240
    v_mul_f32 v16, v16, v100
    v_mul_f32 v21, v109, v109
    v_mfma_f32_16x16x32_bf16 v[116:119], v[40:43], a[44:47], v[116:119]
    v_cvt_pk_bf16_f32 v206, v92, v93
    v_rcp_f32 v25, v25
    v_mfma_f32_16x16x32_bf16 v[120:123], v[40:43], a[116:119], v[120:123]
    ds_read_b128 v[32:35], v3 offset:11264
    v_exp_f32 v30, v30
    v_mfma_f32_16x16x32_bf16 v[124:127], v[44:47], a[44:47], v[124:127]
    v_fma_f32 v19, v19, v10, v8
    v_mul_f32 v95, v95, v23
    v_mfma_f32_16x16x32_bf16 v[128:131], v[44:47], a[116:119], v[128:131]
    ds_read_b128 v[36:39], v3 offset:12288
    v_fma_f32 v28, v28, v13, v13
    v_mul_f32 v17, v17, v101
    v_mfma_f32_16x16x32_bf16 v[116:119], v[48:51], a[48:51], v[116:119]
    s_add_u32 m0, m0, 4096
    s_add_u32 s55, s55, 4096
    buffer_load_dwordx4 v3, s[4:7], s55 offen offset:0 sc1 lds
    v_mul_f32 v22, v110, v110
    v_mfma_f32_16x16x32_bf16 v[120:123], v[48:51], a[120:123], v[120:123]
    s_waitcnt lgkmcnt(7)
    ds_read_b128 v[40:43], v3 offset:13312
    v_rcp_f32 v26, v26
    v_mfma_f32_16x16x32_bf16 v[124:127], v[52:55], a[48:51], v[124:127]
    v_exp_f32 v31, v31
    v_fma_f32 v20, v20, v10, v8
    v_mfma_f32_16x16x32_bf16 v[128:131], v[52:55], a[120:123], v[128:131]
    ds_read_b128 v[44:47], v3 offset:14336
    v_mul_f32 v88, v88, v24
    v_fma_f32 v29, v29, v13, v13
    v_mfma_f32_16x16x32_bf16 v[116:119], v[56:59], a[52:55], v[116:119]
    v_mul_f32 v18, v18, v102
    v_mul_f32 v23, v111, v111
    v_cvt_pk_bf16_f32 v207, v94, v95
    v_mfma_f32_16x16x32_bf16 v[120:123], v[56:59], a[124:127], v[120:123]
    ds_read_b128 v[48:51], v3 offset:15360
    v_rcp_f32 v27, v27
    v_mfma_f32_16x16x32_bf16 v[124:127], v[60:63], a[52:55], v[124:127]
    buffer_store_dwordx4 v[204:207], v3, s[4:7], s24 offen offset:2048 sc1
    v_mfma_f32_16x16x32_bf16 v[128:131], v[60:63], a[124:127], v[128:131]
    s_waitcnt lgkmcnt(7)
    ds_read_b128 v[52:55], v3 offset:16384
    v_exp_f32 v16, v16
    v_fma_f32 v21, v21, v10, v8
    v_mfma_f32_16x16x32_bf16 v[116:119], v[64:67], a[56:59], v[116:119]
    buffer_load_dwordx4 v3, s[4:7], s55 offen offset:1024 sc1 lds
    v_mul_f32 v89, v89, v25
    v_fma_f32 v30, v30, v13, v13
    v_mfma_f32_16x16x32_bf16 v[120:123], v[64:67], a[128:131], v[120:123]
    ds_read_b128 v[56:59], v3 offset:17408
    v_mul_f32 v19, v19, v103
    v_mul_f32 v24, v104, v104
    v_mfma_f32_16x16x32_bf16 v[124:127], v[68:71], a[56:59], v[124:127]
    v_rcp_f32 v28, v28
    v_mfma_f32_16x16x32_bf16 v[128:131], v[68:71], a[128:131], v[128:131]
    ds_read_b128 v[60:63], v3 offset:18432
    v_exp_f32 v17, v17
    v_mfma_f32_16x16x32_bf16 v[116:119], v[72:75], a[60:63], v[116:119]
    v_fma_f32 v22, v22, v10, v8
    v_mul_f32 v90, v90, v26
    v_fma_f32 v31, v31, v13, v13
    v_mfma_f32_16x16x32_bf16 v[120:123], v[72:75], a[132:135], v[120:123]
    s_waitcnt lgkmcnt(7)
    ds_read_b128 v[64:67], v3 offset:19456
    v_mul_f32 v20, v20, v108
    v_mul_f32 v25, v105, v105
    v_mfma_f32_16x16x32_bf16 v[124:127], v[76:79], a[60:63], v[124:127]
    v_cvt_pk_bf16_f32 v208, v88, v89
    v_mfma_f32_16x16x32_bf16 v[128:131], v[76:79], a[132:135], v[128:131]
    ds_read_b128 v[68:71], v3 offset:20480
    v_rcp_f32 v29, v29
    v_mfma_f32_16x16x32_bf16 v[116:119], v[80:83], a[64:67], v[116:119]
    v_exp_f32 v18, v18
    v_fma_f32 v23, v23, v10, v8
    v_mul_f32 v91, v91, v27
    v_mfma_f32_16x16x32_bf16 v[120:123], v[80:83], a[136:139], v[120:123]
    ds_read_b128 v[72:75], v3 offset:21504
    v_fma_f32 v16, v16, v12, v12
    v_mul_f32 v21, v21, v109
    v_mfma_f32_16x16x32_bf16 v[124:127], v[32:35], a[64:67], v[124:127]
    v_mul_f32 v26, v106, v106
    v_mfma_f32_16x16x32_bf16 v[128:131], v[32:35], a[136:139], v[128:131]
    s_waitcnt lgkmcnt(7)
    ds_read_b128 v[76:79], v3 offset:22528
    v_rcp_f32 v30, v30
    v_mfma_f32_16x16x32_bf16 v[116:119], v[36:39], a[68:71], v[116:119]
    v_exp_f32 v19, v19
    v_fma_f32 v24, v24, v11, v9
    v_mul_f32 v96, v96, v28
    v_mfma_f32_16x16x32_bf16 v[120:123], v[36:39], a[140:143], v[120:123]
    ds_read_b128 v[80:83], v3 offset:23552
    v_fma_f32 v17, v17, v12, v12
    v_mul_f32 v22, v22, v110
    v_mfma_f32_16x16x32_bf16 v[124:127], v[40:43], a[68:71], v[124:127]
    s_waitcnt vmcnt(10)
    v_cmp_ge_u32 vcc, 0, v2
    s_nop 0
    s_and_b32 s30, vcc_lo, 15
    s_cbranch_scc1 main_kernel_w0
main_kernel_r0:
    v_mfma_f32_16x16x32_bf16 v[128:131], v[40:43], a[140:143], v[128:131]
    s_barrier
    ds_read_b128 v[32:35], v3 offset:24576
    v_mul_f32 v27, v107, v107
    v_mfma_f32_16x16x32_bf16 v[116:119], v[44:47], v[244:247], v[116:119]
    s_add_u32 m0, s54, 122880
    s_add_u32 s55, s55, 20480
    buffer_load_dwordx4 v3, s[4:7], s55 offen offset:0 sc1 lds
    v_cvt_pk_bf16_f32 v209, v90, v91
    v_mfma_f32_16x16x32_bf16 v[120:123], v[44:47], v[248:251], v[120:123]
    s_waitcnt lgkmcnt(7)
    ds_read_b128 v[36:39], v3 offset:25600
    v_rcp_f32 v31, v31
    v_mfma_f32_16x16x32_bf16 v[124:127], v[48:51], v[244:247], v[124:127]
    s_add_u32 s58, s25, 1024
    buffer_load_dwordx4 a[144:147], v3, s[4:7], s58 offen sc1
    v_mfma_f32_16x16x32_bf16 v[128:131], v[48:51], v[248:251], v[128:131]
    ds_read_b128 v[40:43], v3 offset:26624
    v_exp_f32 v20, v20
    v_fma_f32 v25, v25, v11, v9
    v_mfma_f32_16x16x32_bf16 v[132:135], v[52:55], a[0:3], 0
    v_mul_f32 v97, v97, v29
    v_fma_f32 v18, v18, v12, v12
    v_mul_f32 v23, v23, v111
    v_mfma_f32_16x16x32_bf16 v[136:139], v[52:55], a[72:75], 0
    ds_read_b128 v[44:47], v3 offset:27648
    v_mul_f32 v28, v112, v112
    v_mfma_f32_16x16x32_bf16 v[140:143], v[56:59], a[0:3], 0
    buffer_load_dwordx4 v3, s[4:7], s55 offen offset:1024 sc1 lds
    v_rcp_f32 v16, v16
    v_mfma_f32_16x16x32_bf16 v[144:147], v[56:59], a[72:75], 0
    s_waitcnt lgkmcnt(7)
    ds_read_b128 v[48:51], v3 offset:28672
    v_exp_f32 v21, v21
    v_mfma_f32_16x16x32_bf16 v[132:135], v[60:63], a[4:7], v[132:135]
    v_fma_f32 v26, v26, v11, v9
    v_mul_f32 v98, v98, v30
    v_fma_f32 v19, v19, v12, v12
    v_mfma_f32_16x16x32_bf16 v[136:139], v[60:63], a[76:79], v[136:139]
    ds_read_b128 v[52:55], v3 offset:29696
    v_mul_f32 v24, v24, v104
    v_mul_f32 v29, v113, v113
    v_mfma_f32_16x16x32_bf16 v[140:143], v[64:67], a[4:7], v[140:143]
    v_cvt_pk_bf16_f32 v210, v96, v97
    v_mfma_f32_16x16x32_bf16 v[144:147], v[64:67], a[76:79], v[144:147]
    ds_read_b128 v[56:59], v3 offset:30720
    v_rcp_f32 v17, v17
    v_mfma_f32_16x16x32_bf16 v[132:135], v[68:71], a[8:11], v[132:135]
    buffer_load_dwordx4 v3, s[4:7], s55 offen offset:2048 sc1 lds
    v_exp_f32 v22, v22
    v_fma_f32 v27, v27, v11, v9
    v_mfma_f32_16x16x32_bf16 v[136:139], v[68:71], a[80:83], v[136:139]
    s_waitcnt lgkmcnt(7)
    ds_read_b128 v[60:63], v3 offset:31744
    v_mul_f32 v99, v99, v31
    v_fma_f32 v20, v20, v12, v12
    v_mfma_f32_16x16x32_bf16 v[140:143], v[72:75], a[8:11], v[140:143]
    s_add_u32 s58, s25, 0
    buffer_load_dwordx4 a[148:151], v3, s[4:7], s58 offen sc1
    v_mul_f32 v25, v25, v105
    v_mfma_f32_16x16x32_bf16 v[144:147], v[72:75], a[80:83], v[144:147]
    ds_read_b128 v[64:67], v3 offset:32768
    v_mul_f32 v30, v114, v114
    v_mfma_f32_16x16x32_bf16 v[132:135], v[76:79], a[12:15], v[132:135]
    v_rcp_f32 v18, v18
    v_exp_f32 v23, v23
    v_mfma_f32_16x16x32_bf16 v[136:139], v[76:79], a[84:87], v[136:139]
    ds_read_b128 v[68:71], v3 offset:33792
    v_fma_f32 v28, v28, v11, v9
    v_mul_f32 v100, v100, v16
    v_mfma_f32_16x16x32_bf16 v[140:143], v[80:83], a[12:15], v[140:143]
    buffer_load_dwordx4 v3, s[4:7], s55 offen offset:3072 sc1 lds
    v_fma_f32 v21, v21, v12, v12
    v_mfma_f32_16x16x32_bf16 v[144:147], v[80:83], a[84:87], v[144:147]
    s_waitcnt lgkmcnt(7)
    ds_read_b128 v[72:75], v3 offset:34816
    v_mul_f32 v26, v26, v106
    v_mul_f32 v31, v115, v115
    v_mfma_f32_16x16x32_bf16 v[132:135], v[32:35], a[16:19], v[132:135]
    v_cvt_pk_bf16_f32 v211, v98, v99
    v_rcp_f32 v19, v19
    v_mfma_f32_16x16x32_bf16 v[136:139], v[32:35], a[88:91], v[136:139]
    ds_read_b128 v[76:79], v3 offset:35840
    v_exp_f32 v24, v24
    v_mfma_f32_16x16x32_bf16 v[140:143], v[36:39], a[16:19], v[140:143]
    buffer_store_dwordx4 v[208:211], v3, s[4:7], s24 offen offset:3072 sc1
    v_fma_f32 v29, v29, v11, v9
    v_mfma_f32_16x16x32_bf16 v[144:147], v[36:39], a[88:91], v[144:147]
    ds_read_b128 v[80:83], v3 offset:36864
    v_mul_f32 v101, v101, v17
    v_fma_f32 v22, v22, v12, v12
    v_mfma_f32_16x16x32_bf16 v[132:135], v[40:43], a[20:23], v[132:135]
    s_add_u32 m0, m0, 4096
    s_add_u32 s55, s55, 4096
    buffer_load_dwordx4 v3, s[4:7], s55 offen offset:0 sc1 lds
    v_mul_f32 v27, v27, v107
    v_mul_f32 v16, v116, v116
    v_mfma_f32_16x16x32_bf16 v[136:139], v[40:43], a[92:95], v[136:139]
    s_waitcnt lgkmcnt(7)
    ds_read_b128 v[32:35], v3 offset:37888
    v_rcp_f32 v20, v20
    v_mfma_f32_16x16x32_bf16 v[140:143], v[44:47], a[20:23], v[140:143]
    s_add_u32 s58, s25, 3072
    buffer_load_dwordx4 a[152:155], v3, s[4:7], s58 offen sc1
    v_mfma_f32_16x16x32_bf16 v[144:147], v[44:47], a[92:95], v[144:147]
    ds_read_b128 v[36:39], v3 offset:38912
    v_exp_f32 v25, v25
    v_fma_f32 v30, v30, v11, v9
    v_mfma_f32_16x16x32_bf16 v[132:135], v[48:51], a[24:27], v[132:135]
    v_mul_f32 v102, v102, v18
    v_fma_f32 v23, v23, v12, v12
    v_mul_f32 v28, v28, v112
    v_mfma_f32_16x16x32_bf16 v[136:139], v[48:51], a[96:99], v[136:139]
    ds_read_b128 v[40:43], v3 offset:39936
    v_mul_f32 v17, v117, v117
    v_cvt_pk_bf16_f32 v212, v100, v101
    v_mfma_f32_16x16x32_bf16 v[140:143], v[52:55], a[24:27], v[140:143]
    buffer_load_dwordx4 v3, s[4:7], s55 offen offset:1024 sc1 lds
    v_mfma_f32_16x16x32_bf16 v[144:147], v[52:55], a[96:99], v[144:147]
    s_waitcnt lgkmcnt(7)
    ds_read_b128 v[44:47], v3 offset:40960
    v_rcp_f32 v21, v21
    v_mfma_f32_16x16x32_bf16 v[132:135], v[56:59], a[28:31], v[132:135]
    v_exp_f32 v26, v26
    v_fma_f32 v31, v31, v11, v9
    v_mul_f32 v103, v103, v19
    v_mfma_f32_16x16x32_bf16 v[136:139], v[56:59], a[100:103], v[136:139]
    ds_read_b128 v[48:51], v3 offset:41984
    v_fma_f32 v24, v24, v13, v13
    v_mul_f32 v29, v29, v113
    v_mfma_f32_16x16x32_bf16 v[140:143], v[60:63], a[28:31], v[140:143]
    v_mul_f32 v18, v118, v118
    v_mfma_f32_16x16x32_bf16 v[144:147], v[60:63], a[100:103], v[144:147]
    ds_read_b128 v[52:55], v3 offset:43008
    v_rcp_f32 v22, v22
    v_mfma_f32_16x16x32_bf16 v[132:135], v[64:67], a[32:35], v[132:135]
    v_exp_f32 v27, v27
    v_fma_f32 v16, v16, v10, v8
    v_mul_f32 v108, v108, v20
    v_mfma_f32_16x16x32_bf16 v[136:139], v[64:67], a[104:107], v[136:139]
    s_waitcnt lgkmcnt(7)
    ds_read_b128 v[56:59], v3 offset:44032
    v_fma_f32 v25, v25, v13, v13
    v_mul_f32 v30, v30, v114
    v_mfma_f32_16x16x32_bf16 v[140:143], v[68:71], a[32:35], v[140:143]
    s_add_u32 s58, s25, 2048
    buffer_load_dwordx4 a[156:159], v3, s[4:7], s58 offen sc1
    v_mul_f32 v19, v119, v119
    v_mfma_f32_16x16x32_bf16 v[144:147], v[68:71], a[104:107], v[144:147]
    ds_read_b128 v[60:63], v3 offset:45056
    v_cvt_pk_bf16_f32 v213, v102, v103
    v_mfma_f32_16x16x32_bf16 v[132:135], v[72:75], a[36:39], v[132:135]
    v_rcp_f32 v23, v23
    v_exp_f32 v28, v28
    v_mfma_f32_16x16x32_bf16 v[136:139], v[72:75], a[108:111], v[136:139]
    ds_read_b128 v[64:67], v3 offset:46080
    v_fma_f32 v17, v17, v10, v8
    v_mul_f32 v109, v109, v21
    v_mfma_f32_16x16x32_bf16 v[140:143], v[76:79], a[36:39], v[140:143]
    v_fma_f32 v26, v26, v13, v13
    v_mul_f32 v31, v31, v115
    v_mfma_f32_16x16x32_bf16 v[144:147], v[76:79], a[108:111], v[144:147]
    s_waitcnt lgkmcnt(7)
    ds_read_b128 v[68:71], v3 offset:47104
    v_mul_f32 v20, v124, v124
    v_mfma_f32_16x16x32_bf16 v[132:135], v[80:83], a[40:43], v[132:135]
    v_rcp_f32 v24, v24
    v_exp_f32 v29, v29
    v_mfma_f32_16x16x32_bf16 v[136:139], v[80:83], a[112:115], v[136:139]
    ds_read_b128 v[72:75], v3 offset:48128
    v_fma_f32 v18, v18, v10, v8
    v_mul_f32 v110, v110, v22
    v_mfma_f32_16x16x32_bf16 v[140:143], v[32:35], a[40:43], v[140:143]
    v_fma_f32 v27, v27, v13, v13
    v_mul_f32 v16, v16, v116
    v_mfma_f32_16x16x32_bf16 v[144:147], v[32:35], a[112:115], v[144:147]
    s_barrier
    ds_read_b128 v[76:79], v3 offset:49152
    v_mul_f32 v21, v125, v125
    v_cvt_pk_bf16_f32 v214, v108, v109
    v_mfma_f32_16x16x32_bf16 v[132:135], v[36:39], a[44:47], v[132:135]
    s_add_u32 m0, s54, 0
    s_add_u32 s55, s55, 20480
    buffer_load_dwordx4 v3, s[4:7], s55 offen offset:0 sc1 lds
    v_rcp_f32 v25, v25
    v_mfma_f32_16x16x32_bf16 v[136:139], v[36:39], a[116:119], v[136:139]
    s_waitcnt lgkmcnt(7)
    ds_read_b128 v[80:83], v3 offset:50176
    v_exp_f32 v30, v30
    v_mfma_f32_16x16x32_bf16 v[140:143], v[40:43], a[44:47], v[140:143]
    s_add_u32 s58, s25, 5120
    buffer_load_dwordx4 a[160:163], v3, s[4:7], s58 offen sc1
    v_fma_f32 v19, v19, v10, v8
    v_mfma_f32_16x16x32_bf16 v[144:147], v[40:43], a[116:119], v[144:147]
    ds_read_b128 v[32:35], v3 offset:51200
    v_mul_f32 v111, v111, v23
    v_fma_f32 v28, v28, v13, v13
    v_mfma_f32_16x16x32_bf16 v[132:135], v[44:47], a[48:51], v[132:135]
    v_mul_f32 v17, v17, v117
    v_mul_f32 v22, v126, v126
    v_mfma_f32_16x16x32_bf16 v[136:139], v[44:47], a[120:123], v[136:139]
    ds_read_b128 v[36:39], v3 offset:52224
    v_rcp_f32 v26, v26
    v_mfma_f32_16x16x32_bf16 v[140:143], v[48:51], a[48:51], v[140:143]
    buffer_load_dwordx4 v3, s[4:7], s55 offen offset:1024 sc1 lds
    v_exp_f32 v31, v31
    v_mfma_f32_16x16x32_bf16 v[144:147], v[48:51], a[120:123], v[144:147]
    s_waitcnt lgkmcnt(7)
    ds_read_b128 v[40:43], v3 offset:53248
    v_fma_f32 v20, v20, v10, v8
    v_mul_f32 v104, v104, v24
    v_mfma_f32_16x16x32_bf16 v[132:135], v[52:55], a[52:55], v[132:135]
    v_fma_f32 v29, v29, v13, v13
    v_mul_f32 v18, v18, v118
    v_mul_f32 v23, v127, v127
    v_mfma_f32_16x16x32_bf16 v[136:139], v[52:55], a[124:127], v[136:139]
    ds_read_b128 v[44:47], v3 offset:54272
    v_cvt_pk_bf16_f32 v215, v110, v111
    v_mfma_f32_16x16x32_bf16 v[140:143], v[56:59], a[52:55], v[140:143]
    s_add_u32 s24, s24, 4096
    buffer_store_dwordx4 v[212:215], v3, s[4:7], s24 offen offset:0 sc1
    v_rcp_f32 v27, v27
    v_mfma_f32_16x16x32_bf16 v[144:147], v[56:59], a[124:127], v[144:147]
    ds_read_b128 v[48:51], v3 offset:55296
    v_exp_f32 v16, v16
    v_mfma_f32_16x16x32_bf16 v[132:135], v[60:63], a[56:59], v[132:135]
    buffer_load_dwordx4 v3, s[4:7], s55 offen offset:2048 sc1 lds
    v_fma_f32 v21, v21, v10, v8
    v_mul_f32 v105, v105, v25
    v_mfma_f32_16x16x32_bf16 v[136:139], v[60:63], a[128:131], v[136:139]
    s_waitcnt lgkmcnt(7)
    ds_read_b128 v[52:55], v3 offset:56320
    v_fma_f32 v30, v30, v13, v13
    v_mul_f32 v19, v19, v119
    v_mfma_f32_16x16x32_bf16 v[140:143], v[64:67], a[56:59], v[140:143]
    s_add_u32 s58, s25, 4096
    buffer_load_dwordx4 a[164:167], v3, s[4:7], s58 offen sc1
    v_mul_f32 v24, v120, v120
    v_mfma_f32_16x16x32_bf16 v[144:147], v[64:67], a[128:131], v[144:147]
    ds_read_b128 v[56:59], v3 offset:57344
    v_rcp_f32 v28, v28
    v_mfma_f32_16x16x32_bf16 v[132:135], v[68:71], a[60:63], v[132:135]
    v_exp_f32 v17, v17
    v_fma_f32 v22, v22, v10, v8
    v_mfma_f32_16x16x32_bf16 v[136:139], v[68:71], a[132:135], v[136:139]
    ds_read_b128 v[60:63], v3 offset:58368
    v_mul_f32 v106, v106, v26
    v_fma_f32 v31, v31, v13, v13
    v_mfma_f32_16x16x32_bf16 v[140:143], v[72:75], a[60:63], v[140:143]
    buffer_load_dwordx4 v3, s[4:7], s55 offen offset:3072 sc1 lds
    v_mul_f32 v20, v20, v124
    v_mfma_f32_16x16x32_bf16 v[144:147], v[72:75], a[132:135], v[144:147]
    s_waitcnt lgkmcnt(7)
    ds_read_b128 v[64:67], v3 offset:59392
    v_mul_f32 v25, v121, v121
    v_cvt_pk_bf16_f32 v216, v104, v105
    v_mfma_f32_16x16x32_bf16 v[132:135], v[76:79], a[64:67], v[132:135]
    v_rcp_f32 v29, v29
    v_mfma_f32_16x16x32_bf16 v[136:139], v[76:79], a[136:139], v[136:139]
    ds_read_b128 v[68:71], v3 offset:60416
    v_exp_f32 v18, v18
    v_fma_f32 v23, v23, v10, v8
    v_mfma_f32_16x16x32_bf16 v[140:143], v[80:83], a[64:67], v[140:143]
    v_mul_f32 v107, v107, v27
    v_fma_f32 v16, v16, v12, v12
    v_mfma_f32_16x16x32_bf16 v[144:147], v[80:83], a[136:139], v[144:147]
    ds_read_b128 v[72:75], v3 offset:61440
    v_mul_f32 v21, v21, v125
    v_mul_f32 v26, v122, v122
    v_mfma_f32_16x16x32_bf16 v[132:135], v[32:35], a[68:71], v[132:135]
    s_add_u32 m0, m0, 4096
    s_add_u32 s55, s55, 4096
    buffer_load_dwordx4 v3, s[4:7], s55 offen offset:0 sc1 lds
    v_rcp_f32 v30, v30
    v_mfma_f32_16x16x32_bf16 v[136:139], v[32:35], a[140:143], v[136:139]
    s_waitcnt lgkmcnt(7)
    ds_read_b128 v[76:79], v3 offset:62464
    v_exp_f32 v19, v19
    v_mfma_f32_16x16x32_bf16 v[140:143], v[36:39], a[68:71], v[140:143]
    s_add_u32 s58, s34, 0
    buffer_load_dwordx4 a[168:171], v3, s[4:7], s58 offen sc1
    v_fma_f32 v24, v24, v11, v9
    v_mfma_f32_16x16x32_bf16 v[144:147], v[36:39], a[140:143], v[144:147]
    ds_read_b128 v[80:83], v3 offset:63488
    v_mul_f32 v112, v112, v28
    v_fma_f32 v17, v17, v12, v12
    v_mfma_f32_16x16x32_bf16 v[132:135], v[40:43], v[244:247], v[132:135]
    v_mul_f32 v22, v22, v126
    v_mul_f32 v27, v123, v123
    v_cvt_pk_bf16_f32 v217, v106, v107
    v_mfma_f32_16x16x32_bf16 v[136:139], v[40:43], v[248:251], v[136:139]
    ds_read_b128 v[32:35], v3 offset:64512
    v_rcp_f32 v31, v31
    v_mfma_f32_16x16x32_bf16 v[140:143], v[44:47], v[244:247], v[140:143]
    buffer_load_dwordx4 v3, s[4:7], s55 offen offset:1024 sc1 lds
    v_mfma_f32_16x16x32_bf16 v[144:147], v[44:47], v[248:251], v[144:147]
    s_waitcnt lgkmcnt(7)
    ds_read_b128 v[36:39], v4 offset:0
    v_exp_f32 v20, v20
    v_fma_f32 v25, v25, v11, v9
    v_mfma_f32_16x16x32_bf16 a[0:3], v[48:51], v[164:167], 0
    v_mul_f32 v113, v113, v29
    v_fma_f32 v18, v18, v12, v12
    v_mul_f32 v23, v23, v127
    v_mfma_f32_16x16x32_bf16 a[4:7], v[48:51], v[168:171], 0
    ds_read_b128 v[40:43], v4 offset:1024
    v_mul_f32 v28, v128, v128
    v_mfma_f32_16x16x32_bf16 a[8:11], v[52:55], v[164:167], 0
    v_rcp_f32 v16, v16
    v_mfma_f32_16x16x32_bf16 a[12:15], v[52:55], v[168:171], 0
    ds_read_b128 v[44:47], v4 offset:2048
    v_exp_f32 v21, v21
    v_fma_f32 v26, v26, v11, v9
    v_mfma_f32_16x16x32_bf16 a[16:19], v[56:59], v[164:167], 0
    v_mul_f32 v114, v114, v30
    v_fma_f32 v19, v19, v12, v12
    v_mul_f32 v24, v24, v120
    v_mfma_f32_16x16x32_bf16 a[20:23], v[56:59], v[168:171], 0
    s_waitcnt lgkmcnt(7)
    ds_read_b128 v[48:51], v4 offset:3072
    v_mul_f32 v29, v129, v129
    v_cvt_pk_bf16_f32 v218, v112, v113
    v_mfma_f32_16x16x32_bf16 a[24:27], v[60:63], v[164:167], 0
    s_add_u32 s58, s34, 1024
    buffer_load_dwordx4 a[172:175], v3, s[4:7], s58 offen sc1
    v_mfma_f32_16x16x32_bf16 a[28:31], v[60:63], v[168:171], 0
    ds_read_b128 v[52:55], v4 offset:4096
    v_rcp_f32 v17, v17
    v_mfma_f32_16x16x32_bf16 a[32:35], v[64:67], v[164:167], 0
    v_exp_f32 v22, v22
    v_fma_f32 v27, v27, v11, v9
    v_mul_f32 v115, v115, v31
    v_mfma_f32_16x16x32_bf16 a[36:39], v[64:67], v[168:171], 0
    ds_read_b128 v[56:59], v4 offset:5120
    v_fma_f32 v20, v20, v12, v12
    v_mul_f32 v25, v25, v121
    v_mfma_f32_16x16x32_bf16 a[40:43], v[68:71], v[164:167], 0
    v_mul_f32 v30, v130, v130
    v_mfma_f32_16x16x32_bf16 a[44:47], v[68:71], v[168:171], 0
    s_waitcnt lgkmcnt(7)
    ds_read_b128 v[60:63], v4 offset:6144
    v_rcp_f32 v18, v18
    v_mfma_f32_16x16x32_bf16 a[48:51], v[72:75], v[164:167], 0
    s_waitcnt vmcnt(15)
    s_mov_b64 exec, 1
    buffer_store_dword v237, v7, s[4:7], s26 offen sc1
    s_mov_b64 exec, -1
    v_exp_f32 v23, v23
    v_mfma_f32_16x16x32_bf16 a[52:55], v[72:75], v[168:171], 0
    ds_read_b128 v[64:67], v4 offset:7168
    v_fma_f32 v28, v28, v11, v9
    v_mul_f32 v116, v116, v16
    v_mfma_f32_16x16x32_bf16 a[56:59], v[76:79], v[164:167], 0
    v_fma_f32 v21, v21, v12, v12
    v_mul_f32 v26, v26, v122
    v_mfma_f32_16x16x32_bf16 a[60:63], v[76:79], v[168:171], 0
    s_barrier
    ds_read_b128 v[68:71], v4 offset:8192
    v_mul_f32 v31, v131, v131
    v_cvt_pk_bf16_f32 v219, v114, v115
    v_mfma_f32_16x16x32_bf16 a[64:67], v[80:83], v[164:167], 0
    s_waitcnt lgkmcnt(7)
    ds_read_b128 v[72:75], v4 offset:9216
    buffer_store_dwordx4 v[216:219], v3, s[4:7], s24 offen offset:1024 sc1
    v_mfma_f32_16x16x32_bf16 a[68:71], v[32:35], v[164:167], 0
    ds_read_b128 v[76:79], v4 offset:10240
    s_add_u32 m0, s54, 24576
    s_add_u32 s55, s55, 20480
    buffer_load_dwordx4 v3, s[4:7], s55 offen offset:0 sc1 lds
    v_rcp_f32 v19, v19
    v_mfma_f32_16x16x32_bf16 a[0:3], v[36:39], v[172:175], a[0:3]
    s_add_u32 s58, s34, 2048
    buffer_load_dwordx4 a[176:179], v3, s[4:7], s58 offen sc1
    v_mfma_f32_16x16x32_bf16 a[4:7], v[36:39], v[176:179], a[4:7]
    ds_read_b128 v[80:83], v4 offset:11264
    v_exp_f32 v24, v24
    v_fma_f32 v29, v29, v11, v9
    v_mfma_f32_16x16x32_bf16 a[8:11], v[40:43], v[172:175], a[8:11]
    v_mul_f32 v117, v117, v17
    v_fma_f32 v22, v22, v12, v12
    v_mul_f32 v27, v27, v123
    v_mfma_f32_16x16x32_bf16 a[12:15], v[40:43], v[176:179], a[12:15]
    s_waitcnt lgkmcnt(7)
    ds_read_b128 v[32:35], v4 offset:12288
    v_mul_f32 v16, v132, v132
    v_mfma_f32_16x16x32_bf16 a[16:19], v[44:47], v[172:175], a[16:19]
    buffer_load_dwordx4 v3, s[4:7], s55 offen offset:1024 sc1 lds
    v_rcp_f32 v20, v20
    v_mfma_f32_16x16x32_bf16 a[20:23], v[44:47], v[176:179], a[20:23]
    ds_read_b128 v[36:39], v4 offset:13312
    v_exp_f32 v25, v25
    v_mfma_f32_16x16x32_bf16 a[24:27], v[48:51], v[172:175], a[24:27]
    v_fma_f32 v30, v30, v11, v9
    v_mul_f32 v118, v118, v18
    v_fma_f32 v23, v23, v12, v12
    v_mfma_f32_16x16x32_bf16 a[28:31], v[48:51], v[176:179], a[28:31]
    ds_read_b128 v[40:43], v4 offset:14336
    v_mul_f32 v28, v28, v128
    v_mul_f32 v17, v133, v133
    v_mfma_f32_16x16x32_bf16 a[32:35], v[52:55], v[172:175], a[32:35]
    v_cvt_pk_bf16_f32 v220, v116, v117
    v_mfma_f32_16x16x32_bf16 a[36:39], v[52:55], v[176:179], a[36:39]
    s_waitcnt lgkmcnt(7)
    ds_read_b128 v[44:47], v4 offset:15360
    v_rcp_f32 v21, v21
    v_mfma_f32_16x16x32_bf16 a[40:43], v[56:59], v[172:175], a[40:43]
    buffer_load_dwordx4 v3, s[4:7], s55 offen offset:2048 sc1 lds
    v_exp_f32 v26, v26
    v_fma_f32 v31, v31, v11, v9
    v_mfma_f32_16x16x32_bf16 a[44:47], v[56:59], v[176:179], a[44:47]
    ds_read_b128 v[48:51], v4 offset:16384
    v_mul_f32 v119, v119, v19
    v_fma_f32 v24, v24, v13, v13
    v_mfma_f32_16x16x32_bf16 a[48:51], v[60:63], v[172:175], a[48:51]
    s_add_u32 s58, s34, 3072
    buffer_load_dwordx4 a[180:183], v3, s[4:7], s58 offen sc1
    v_mul_f32 v29, v29, v129
    v_mfma_f32_16x16x32_bf16 a[52:55], v[60:63], v[176:179], a[52:55]
    ds_read_b128 v[52:55], v4 offset:17408
    v_mul_f32 v18, v134, v134
    v_mfma_f32_16x16x32_bf16 a[56:59], v[64:67], v[172:175], a[56:59]
    v_rcp_f32 v22, v22
    v_exp_f32 v27, v27
    v_mfma_f32_16x16x32_bf16 a[60:63], v[64:67], v[176:179], a[60:63]
    s_waitcnt lgkmcnt(7)
    ds_read_b128 v[56:59], v4 offset:18432
    v_fma_f32 v16, v16, v10, v8
    v_mul_f32 v124, v124, v20
    v_mfma_f32_16x16x32_bf16 a[64:67], v[68:71], v[172:175], a[64:67]
    ds_read_b128 v[60:63], v4 offset:19456
    buffer_load_dwordx4 v3, s[4:7], s55 offen offset:3072 sc1 lds
    v_mfma_f32_16x16x32_bf16 a[68:71], v[72:75], v[172:175], a[68:71]
    ds_read_b128 v[64:67], v4 offset:20480
    v_fma_f32 v25, v25, v13, v13
    v_mul_f32 v30, v30, v130
    v_mfma_f32_16x16x32_bf16 a[0:3], v[76:79], v[180:183], a[0:3]
    v_mul_f32 v19, v135, v135
    v_cvt_pk_bf16_f32 v221, v118, v119
    v_mfma_f32_16x16x32_bf16 a[4:7], v[76:79], v[184:187], a[4:7]
    s_waitcnt lgkmcnt(7)
    ds_read_b128 v[68:71], v4 offset:21504
    v_rcp_f32 v23, v23
    v_mfma_f32_16x16x32_bf16 a[8:11], v[80:83], v[180:183], a[8:11]
    s_add_u32 m0, m0, 4096
    s_add_u32 s55, s55, 4096
    buffer_load_dwordx4 v3, s[4:7], s55 offen offset:0 sc1 lds
    v_exp_f32 v28, v28
    v_mfma_f32_16x16x32_bf16 a[12:15], v[80:83], v[184:187], a[12:15]
    ds_read_b128 v[72:75], v4 offset:22528
    v_fma_f32 v17, v17, v10, v8
    v_mul_f32 v125, v125, v21
    v_mfma_f32_16x16x32_bf16 a[16:19], v[32:35], v[180:183], a[16:19]
    s_add_u32 s58, s34, 4096
    buffer_load_dwordx4 a[184:187], v3, s[4:7], s58 offen sc1
    v_fma_f32 v26, v26, v13, v13
    v_mul_f32 v31, v31, v131
    v_mfma_f32_16x16x32_bf16 a[20:23], v[32:35], v[184:187], a[20:23]
    ds_read_b128 v[76:79], v4 offset:23552
    v_mul_f32 v20, v140, v140
    v_mfma_f32_16x16x32_bf16 a[24:27], v[36:39], v[180:183], a[24:27]
    v_rcp_f32 v24, v24
    v_mfma_f32_16x16x32_bf16 a[28:31], v[36:39], v[184:187], a[28:31]
    s_waitcnt lgkmcnt(7)
    ds_read_b128 v[80:83], v4 offset:24576
    v_exp_f32 v29, v29
    v_fma_f32 v18, v18, v10, v8
    v_mfma_f32_16x16x32_bf16 a[32:35], v[40:43], v[180:183], a[32:35]
    buffer_load_dwordx4 v3, s[4:7], s55 offen offset:1024 sc1 lds
    v_mul_f32 v126, v126, v22
    v_fma_f32 v27, v27, v13, v13
    v_mfma_f32_16x16x32_bf16 a[36:39], v[40:43], v[184:187], a[36:39]
    ds_read_b128 v[32:35], v4 offset:25600
    v_mul_f32 v16, v16, v132
    v_mul_f32 v21, v141, v141
    v_mfma_f32_16x16x32_bf16 a[40:43], v[44:47], v[180:183], a[40:43]
    v_cvt_pk_bf16_f32 v222, v124, v125
    v_mfma_f32_16x16x32_bf16 a[44:47], v[44:47], v[184:187], a[44:47]
    ds_read_b128 v[36:39], v4 offset:26624
    v_rcp_f32 v25, v25
    v_mfma_f32_16x16x32_bf16 a[48:51], v[48:51], v[180:183], a[48:51]
    v_exp_f32 v30, v30
    v_fma_f32 v19, v19, v10, v8
    v_mul_f32 v127, v127, v23
    v_mfma_f32_16x16x32_bf16 a[52:55], v[48:51], v[184:187], a[52:55]
    s_waitcnt lgkmcnt(7)
    ds_read_b128 v[40:43], v4 offset:27648
    v_fma_f32 v28, v28, v13, v13
    v_mul_f32 v17, v17, v133
    v_mfma_f32_16x16x32_bf16 a[56:59], v[52:55], v[180:183], a[56:59]
    v_mul_f32 v22, v142, v142
    v_mfma_f32_16x16x32_bf16 a[60:63], v[52:55], v[184:187], a[60:63]
    ds_read_b128 v[44:47], v4 offset:28672
    v_rcp_f32 v26, v26
    v_mfma_f32_16x16x32_bf16 a[64:67], v[56:59], v[180:183], a[64:67]
    ds_read_b128 v[48:51], v4 offset:29696
    v_exp_f32 v31, v31
    v_fma_f32 v20, v20, v10, v8
    v_mfma_f32_16x16x32_bf16 a[68:71], v[60:63], v[180:183], a[68:71]
    s_waitcnt lgkmcnt(7)
    ds_read_b128 v[52:55], v4 offset:30720
    v_mul_f32 v120, v120, v24
    v_fma_f32 v29, v29, v13, v13
    v_mfma_f32_16x16x32_bf16 a[0:3], v[64:67], v[188:191], a[0:3]
    s_add_u32 s58, s34, 5120
    buffer_load_dwordx4 a[188:191], v3, s[4:7], s58 offen sc1
    v_mul_f32 v18, v18, v134
    v_mfma_f32_16x16x32_bf16 a[4:7], v[64:67], v[192:195], a[4:7]
    ds_read_b128 v[56:59], v4 offset:31744
    v_mul_f32 v23, v143, v143
    v_cvt_pk_bf16_f32 v223, v126, v127
    v_mfma_f32_16x16x32_bf16 a[8:11], v[68:71], v[188:191], a[8:11]
    buffer_store_dwordx4 v[220:223], v3, s[4:7], s24 offen offset:2048 sc1
    v_rcp_f32 v27, v27
    v_mfma_f32_16x16x32_bf16 a[12:15], v[68:71], v[192:195], a[12:15]
    s_barrier
    ds_read_b128 v[60:63], v4 offset:32768
    v_exp_f32 v16, v16
    v_mfma_f32_16x16x32_bf16 a[16:19], v[72:75], v[188:191], a[16:19]
    s_add_u32 m0, s54, 49152
    s_add_u32 s55, s55, 20480
    buffer_load_dwordx4 v3, s[4:7], s55 offen offset:0 sc1 lds
    v_fma_f32 v21, v21, v10, v8
    v_mfma_f32_16x16x32_bf16 a[20:23], v[72:75], v[192:195], a[20:23]
    s_waitcnt lgkmcnt(7)
    ds_read_b128 v[64:67], v4 offset:33792
    v_mul_f32 v121, v121, v25
    v_fma_f32 v30, v30, v13, v13
    v_mfma_f32_16x16x32_bf16 a[24:27], v[76:79], v[188:191], a[24:27]
    v_mul_f32 v19, v19, v135
    v_mul_f32 v24, v136, v136
    v_mfma_f32_16x16x32_bf16 a[28:31], v[76:79], v[192:195], a[28:31]
    ds_read_b128 v[68:71], v4 offset:34816
    v_rcp_f32 v28, v28
    v_mfma_f32_16x16x32_bf16 a[32:35], v[80:83], v[188:191], a[32:35]
    v_exp_f32 v17, v17
    v_fma_f32 v22, v22, v10, v8
    v_mfma_f32_16x16x32_bf16 a[36:39], v[80:83], v[192:195], a[36:39]
    ds_read_b128 v[72:75], v4 offset:35840
    v_mul_f32 v122, v122, v26
    v_fma_f32 v31, v31, v13, v13
    v_mfma_f32_16x16x32_bf16 a[40:43], v[32:35], v[188:191], a[40:43]
    buffer_load_dwordx4 v3, s[4:7], s55 offen offset:1024 sc1 lds
    v_mul_f32 v20, v20, v140
    v_mul_f32 v25, v137, v137
    v_mfma_f32_16x16x32_bf16 a[44:47], v[32:35], v[192:195], a[44:47]
    s_waitcnt lgkmcnt(7)
    ds_read_b128 v[76:79], v4 offset:36864
    v_cvt_pk_bf16_f32 v224, v120, v121
    v_mfma_f32_16x16x32_bf16 a[48:51], v[36:39], v[188:191], a[48:51]
    s_mov_b64 exec, 15
    buffer_load_dword v243, v15, s[4:7], s27 offen sc1
    s_mov_b64 exec, -1
    v_mfma_f32_16x16x32_bf16 a[52:55], v[36:39], v[192:195], a[52:55]
    ds_read_b128 v[80:83], v4 offset:37888
    v_rcp_f32 v29, v29
    v_mfma_f32_16x16x32_bf16 a[56:59], v[40:43], v[188:191], a[56:59]
    s_add_u32 s58, s35, 1024
    buffer_load_dwordx4 a[192:195], v3, s[4:7], s58 offen sc1
    v_exp_f32 v18, v18
    v_fma_f32 v23, v23, v10, v8
    v_mfma_f32_16x16x32_bf16 a[60:63], v[40:43], v[192:195], a[60:63]
    ds_read_b128 v[32:35], v4 offset:38912
    v_mul_f32 v123, v123, v27
    v_fma_f32 v16, v16, v12, v12
    v_mfma_f32_16x16x32_bf16 a[64:67], v[44:47], v[188:191], a[64:67]
    s_waitcnt lgkmcnt(7)
    ds_read_b128 v[36:39], v4 offset:39936
    buffer_load_dwordx4 v3, s[4:7], s55 offen offset:2048 sc1 lds
    v_mfma_f32_16x16x32_bf16 a[68:71], v[48:51], v[188:191], a[68:71]
    ds_read_b128 v[40:43], v4 offset:40960
    v_mul_f32 v21, v21, v141
    v_mul_f32 v26, v138, v138
    v_mfma_f32_16x16x32_bf16 a[0:3], v[52:55], v[196:199], a[0:3]
    v_rcp_f32 v30, v30
    v_mfma_f32_16x16x32_bf16 a[4:7], v[52:55], v[200:203], a[4:7]
    ds_read_b128 v[44:47], v4 offset:41984
    v_exp_f32 v19, v19
    v_fma_f32 v24, v24, v11, v9
    v_mfma_f32_16x16x32_bf16 a[8:11], v[56:59], v[196:199], a[8:11]
    buffer_load_dwordx4 v3, s[4:7], s55 offen offset:3072 sc1 lds
    v_mul_f32 v128, v128, v28
    v_mfma_f32_16x16x32_bf16 a[12:15], v[56:59], v[200:203], a[12:15]
    s_waitcnt lgkmcnt(7)
    ds_read_b128 v[48:51], v4 offset:43008
    v_fma_f32 v17, v17, v12, v12
    v_mul_f32 v22, v22, v142
    v_mfma_f32_16x16x32_bf16 a[16:19], v[60:63], v[196:199], a[16:19]
    v_mul_f32 v27, v139, v139
    v_cvt_pk_bf16_f32 v225, v122, v123
    v_mfma_f32_16x16x32_bf16 a[20:23], v[60:63], v[200:203], a[20:23]
    ds_read_b128 v[52:55], v4 offset:44032
    v_rcp_f32 v31, v31
    v_mfma_f32_16x16x32_bf16 a[24:27], v[64:67], v[196:199], a[24:27]
    s_add_u32 s58, s35, 0
    buffer_load_dwordx4 a[196:199], v3, s[4:7], s58 offen sc1
    v_exp_f32 v20, v20
    v_mfma_f32_16x16x32_bf16 a[28:31], v[64:67], v[200:203], a[28:31]
    ds_read_b128 v[56:59], v4 offset:45056
    v_fma_f32 v25, v25, v11, v9
    v_mul_f32 v129, v129, v29
    v_mfma_f32_16x16x32_bf16 a[32:35], v[68:71], v[196:199], a[32:35]
    s_add_u32 m0, m0, 4096
    s_add_u32 s55, s55, 4096
    buffer_load_dwordx4 v3, s[4:7], s55 offen offset:0 sc1 lds
    v_fma_f32 v18, v18, v12, v12
    v_mul_f32 v23, v23, v143
    v_mfma_f32_16x16x32_bf16 a[36:39], v[68:71], v[200:203], a[36:39]
    s_waitcnt lgkmcnt(7)
    ds_read_b128 v[60:63], v4 offset:46080
    v_mul_f32 v28, v144, v144
    v_mfma_f32_16x16x32_bf16 a[40:43], v[72:75], v[196:199], a[40:43]
    v_rcp_f32 v16, v16
    v_mfma_f32_16x16x32_bf16 a[44:47], v[72:75], v[200:203], a[44:47]
    ds_read_b128 v[64:67], v4 offset:47104
    v_exp_f32 v21, v21
    v_fma_f32 v26, v26, v11, v9
    v_mfma_f32_16x16x32_bf16 a[48:51], v[76:79], v[196:199], a[48:51]
    v_mul_f32 v130, v130, v30
    v_fma_f32 v19, v19, v12, v12
    v_mul_f32 v24, v24, v136
    v_mfma_f32_16x16x32_bf16 a[52:55], v[76:79], v[200:203], a[52:55]
    ds_read_b128 v[68:71], v4 offset:48128
    v_mul_f32 v29, v145, v145
    v_cvt_pk_bf16_f32 v226, v128, v129
    v_mfma_f32_16x16x32_bf16 a[56:59], v[80:83], v[196:199], a[56:59]
    buffer_load_dwordx4 v3, s[4:7], s55 offen offset:1024 sc1 lds
    v_mfma_f32_16x16x32_bf16 a[60:63], v[80:83], v[200:203], a[60:63]
    s_waitcnt lgkmcnt(7)
    ds_read_b128 v[72:75], v4 offset:49152
    v_rcp_f32 v17, v17
    v_mfma_f32_16x16x32_bf16 a[64:67], v[32:35], v[196:199], a[64:67]
    ds_read_b128 v[76:79], v4 offset:50176
    v_exp_f32 v22, v22
    v_fma_f32 v27, v27, v11, v9
    v_mfma_f32_16x16x32_bf16 a[68:71], v[36:39], v[196:199], a[68:71]
    ds_read_b128 v[80:83], v4 offset:51200
    v_mul_f32 v131, v131, v31
    v_fma_f32 v20, v20, v12, v12
    v_mfma_f32_16x16x32_bf16 a[0:3], v[40:43], v[204:207], a[0:3]
    s_add_u32 s58, s35, 3072
    buffer_load_dwordx4 a[200:203], v3, s[4:7], s58 offen sc1
    v_mul_f32 v25, v25, v137
    v_mfma_f32_16x16x32_bf16 a[4:7], v[40:43], v[208:211], a[4:7]
    s_waitcnt lgkmcnt(7)
    ds_read_b128 v[32:35], v4 offset:52224
    v_mul_f32 v30, v146, v146
    v_mfma_f32_16x16x32_bf16 a[8:11], v[44:47], v[204:207], a[8:11]
    v_rcp_f32 v18, v18
    v_exp_f32 v23, v23
    v_mfma_f32_16x16x32_bf16 a[12:15], v[44:47], v[208:211], a[12:15]
    ds_read_b128 v[36:39], v4 offset:53248
    v_fma_f32 v28, v28, v11, v9
    v_mul_f32 v132, v132, v16
    v_mfma_f32_16x16x32_bf16 a[16:19], v[48:51], v[204:207], a[16:19]
    v_fma_f32 v21, v21, v12, v12
    v_mul_f32 v26, v26, v138
    v_mfma_f32_16x16x32_bf16 a[20:23], v[48:51], v[208:211], a[20:23]
    ds_read_b128 v[40:43], v4 offset:54272
    v_mul_f32 v31, v147, v147
    v_cvt_pk_bf16_f32 v227, v130, v131
    v_mfma_f32_16x16x32_bf16 a[24:27], v[52:55], v[204:207], a[24:27]
    buffer_store_dwordx4 v[224:227], v3, s[4:7], s24 offen offset:3072 sc1
    v_rcp_f32 v19, v19
    v_mfma_f32_16x16x32_bf16 a[28:31], v[52:55], v[208:211], a[28:31]
    s_waitcnt lgkmcnt(7)
    ds_read_b128 v[44:47], v4 offset:55296
    v_exp_f32 v24, v24
    v_mfma_f32_16x16x32_bf16 a[32:35], v[56:59], v[204:207], a[32:35]
    v_fma_f32 v29, v29, v11, v9
    v_mul_f32 v133, v133, v17
    v_mfma_f32_16x16x32_bf16 a[36:39], v[56:59], v[208:211], a[36:39]
    ds_read_b128 v[48:51], v4 offset:56320
    v_fma_f32 v22, v22, v12, v12
    v_mul_f32 v27, v27, v139
    v_mfma_f32_16x16x32_bf16 a[40:43], v[60:63], v[204:207], a[40:43]
    v_rcp_f32 v20, v20
    v_mfma_f32_16x16x32_bf16 a[44:47], v[60:63], v[208:211], a[44:47]
    s_waitcnt vmcnt(36)
    s_barrier
    ds_read_b128 v[52:55], v4 offset:57344
    v_exp_f32 v25, v25
    v_fma_f32 v30, v30, v11, v9
    v_mfma_f32_16x16x32_bf16 a[48:51], v[64:67], v[204:207], a[48:51]
    s_add_u32 m0, s54, 73728
    s_add_u32 s55, s55, 20480
    buffer_load_dwordx4 v3, s[4:7], s55 offen offset:0 sc1 lds
    v_mul_f32 v134, v134, v18
    v_mfma_f32_16x16x32_bf16 a[52:55], v[64:67], v[208:211], a[52:55]
    s_waitcnt lgkmcnt(7)
    ds_read_b128 v[56:59], v4 offset:58368
    v_fma_f32 v23, v23, v12, v12
    v_mul_f32 v28, v28, v144
    v_mfma_f32_16x16x32_bf16 a[56:59], v[68:71], v[204:207], a[56:59]
    s_add_u32 s58, s35, 2048
    buffer_load_dwordx4 a[204:207], v3, s[4:7], s58 offen sc1
    v_cvt_pk_bf16_f32 v228, v132, v133
    v_mfma_f32_16x16x32_bf16 a[60:63], v[68:71], v[208:211], a[60:63]
    ds_read_b128 v[60:63], v4 offset:59392
    v_rcp_f32 v21, v21
    v_mfma_f32_16x16x32_bf16 a[64:67], v[72:75], v[204:207], a[64:67]
    ds_read_b128 v[64:67], v4 offset:60416
    v_exp_f32 v26, v26
    v_mfma_f32_16x16x32_bf16 a[68:71], v[76:79], v[204:207], a[68:71]
    s_waitcnt lgkmcnt(7)
    ds_read_b128 v[68:71], v4 offset:61440
    buffer_load_dwordx4 v3, s[4:7], s55 offen offset:1024 sc1 lds
    v_fma_f32 v31, v31, v11, v9
    v_mfma_f32_16x16x32_bf16 a[0:3], v[80:83], v[212:215], a[0:3]
    v_mul_f32 v135, v135, v19
    v_fma_f32 v24, v24, v13, v13
    v_mul_f32 v29, v29, v145
    v_mfma_f32_16x16x32_bf16 a[4:7], v[80:83], v[216:219], a[4:7]
    ds_read_b128 v[72:75], v4 offset:62464
    v_rcp_f32 v22, v22
    v_mfma_f32_16x16x32_bf16 a[8:11], v[32:35], v[212:215], a[8:11]
    v_exp_f32 v27, v27
    v_mfma_f32_16x16x32_bf16 a[12:15], v[32:35], v[216:219], a[12:15]
    ds_read_b128 v[76:79], v4 offset:63488
    v_mul_f32 v140, v140, v20
    v_fma_f32 v25, v25, v13, v13
    v_mfma_f32_16x16x32_bf16 a[16:19], v[36:39], v[212:215], a[16:19]
    buffer_load_dwordx4 v3, s[4:7], s55 offen offset:2048 sc1 lds
    v_mul_f32 v30, v30, v146
    v_cvt_pk_bf16_f32 v229, v134, v135
    v_mfma_f32_16x16x32_bf16 a[20:23], v[36:39], v[216:219], a[20:23]
    s_waitcnt lgkmcnt(7)
    ds_read_b128 v[80:83], v4 offset:64512
    v_rcp_f32 v23, v23
    v_mfma_f32_16x16x32_bf16 a[24:27], v[40:43], v[212:215], a[24:27]
    s_add_u32 s58, s35, 5120
    buffer_load_dwordx4 a[208:211], v3, s[4:7], s58 offen sc1
    v_mfma_f32_16x16x32_bf16 a[28:31], v[40:43], v[216:219], a[28:31]
    ds_read_b128 v[32:35], v5 offset:0
    v_exp_f32 v28, v28
    v_mul_f32 v141, v141, v21
    v_mfma_f32_16x16x32_bf16 a[32:35], v[44:47], v[212:215], a[32:35]
    v_fma_f32 v26, v26, v13, v13
    v_mul_f32 v31, v31, v147
    v_mfma_f32_16x16x32_bf16 a[36:39], v[44:47], v[216:219], a[36:39]
    ds_read_b128 v[36:39], v5 offset:1024
    v_rcp_f32 v24, v24
    v_mfma_f32_16x16x32_bf16 a[40:43], v[48:51], v[212:215], a[40:43]
    buffer_load_dwordx4 v3, s[4:7], s55 offen offset:3072 sc1 lds
    v_exp_f32 v29, v29
    v_mfma_f32_16x16x32_bf16 a[44:47], v[48:51], v[216:219], a[44:47]
    s_waitcnt lgkmcnt(7)
    ds_read_b128 v[40:43], v5 offset:2048
    v_mul_f32 v142, v142, v22
    v_fma_f32 v27, v27, v13, v13
    v_mfma_f32_16x16x32_bf16 a[48:51], v[52:55], v[212:215], a[48:51]
    v_cvt_pk_bf16_f32 v230, v140, v141
    v_rcp_f32 v25, v25
    v_mfma_f32_16x16x32_bf16 a[52:55], v[52:55], v[216:219], a[52:55]
    ds_read_b128 v[44:47], v5 offset:3072
    v_exp_f32 v30, v30
    v_mfma_f32_16x16x32_bf16 a[56:59], v[56:59], v[212:215], a[56:59]
    v_mul_f32 v143, v143, v23
    v_fma_f32 v28, v28, v13, v13
    v_mfma_f32_16x16x32_bf16 a[60:63], v[56:59], v[216:219], a[60:63]
    ds_read_b128 v[48:51], v5 offset:4096
    v_rcp_f32 v26, v26
    v_mfma_f32_16x16x32_bf16 a[64:67], v[60:63], v[212:215], a[64:67]
    s_waitcnt lgkmcnt(7)
    ds_read_b128 v[52:55], v5 offset:5120
    s_add_u32 m0, m0, 4096
    s_add_u32 s55, s55, 4096
    buffer_load_dwordx4 v3, s[4:7], s55 offen offset:0 sc1 lds
    v_mfma_f32_16x16x32_bf16 a[68:71], v[64:67], v[212:215], a[68:71]
    ds_read_b128 v[56:59], v5 offset:6144
    v_exp_f32 v31, v31
    v_mul_f32 v136, v136, v24
    v_mfma_f32_16x16x32_bf16 a[0:3], v[68:71], v[220:223], a[0:3]
    s_add_u32 s58, s35, 4096
    buffer_load_dwordx4 a[212:215], v3, s[4:7], s58 offen sc1
    v_fma_f32 v29, v29, v13, v13
    v_mfma_f32_16x16x32_bf16 a[4:7], v[68:71], v[224:227], a[4:7]
    ds_read_b128 v[60:63], v5 offset:7168
    v_cvt_pk_bf16_f32 v231, v142, v143
    v_mfma_f32_16x16x32_bf16 a[8:11], v[72:75], v[220:223], a[8:11]
    s_waitcnt vmcnt(16)
    v_cmp_ge_u32 vcc, 1, v243
    s_nop 0
    s_and_b32 s30, vcc_lo, 15
    s_cbranch_scc1 main_kernel_w1
main_kernel_r1:
    v_mfma_f32_16x16x32_bf16 a[12:15], v[72:75], v[224:227], a[12:15]
    s_waitcnt lgkmcnt(7)
    ds_read_b128 v[64:67], v5 offset:8192
    v_rcp_f32 v27, v27
    v_mfma_f32_16x16x32_bf16 a[16:19], v[76:79], v[220:223], a[16:19]
    s_add_u32 s24, s24, 4096
    buffer_store_dwordx4 v[228:231], v3, s[4:7], s24 offen offset:0 sc1
    v_mul_f32 v137, v137, v25
    v_mfma_f32_16x16x32_bf16 a[20:23], v[76:79], v[224:227], a[20:23]
    ds_read_b128 v[68:71], v5 offset:9216
    v_fma_f32 v30, v30, v13, v13
    v_mfma_f32_16x16x32_bf16 a[24:27], v[80:83], v[220:223], a[24:27]
    buffer_load_dwordx4 v3, s[4:7], s55 offen offset:1024 sc1 lds
    v_rcp_f32 v28, v28
    v_mul_f32 v138, v138, v26
    v_mfma_f32_16x16x32_bf16 a[28:31], v[80:83], v[224:227], a[28:31]
    ds_read_b128 v[72:75], v5 offset:10240
    v_fma_f32 v31, v31, v13, v13
    v_cvt_pk_bf16_f32 v232, v136, v137
    v_mfma_f32_16x16x32_bf16 a[32:35], v[32:35], v[220:223], a[32:35]
    v_rcp_f32 v29, v29
    v_mfma_f32_16x16x32_bf16 a[36:39], v[32:35], v[224:227], a[36:39]
    s_waitcnt lgkmcnt(7)
    ds_read_b128 v[76:79], v5 offset:11264
    v_mul_f32 v139, v139, v27
    v_mfma_f32_16x16x32_bf16 a[40:43], v[36:39], v[220:223], a[40:43]
    v_rcp_f32 v30, v30
    v_mul_f32 v144, v144, v28
    v_cvt_pk_bf16_f32 v233, v138, v139
    v_mfma_f32_16x16x32_bf16 a[44:47], v[36:39], v[224:227], a[44:47]
    ds_read_b128 v[80:83], v5 offset:12288
    v_rcp_f32 v31, v31
    v_mfma_f32_16x16x32_bf16 a[48:51], v[40:43], v[220:223], a[48:51]
    s_add_u32 s58, s25, 7168
    buffer_load_dwordx4 a[216:219], v3, s[4:7], s58 offen sc1
    v_mul_f32 v145, v145, v29
    v_mfma_f32_16x16x32_bf16 a[52:55], v[40:43], v[224:227], a[52:55]
    ds_read_b128 v[32:35], v5 offset:13312
    v_mul_f32 v146, v146, v30
    v_cvt_pk_bf16_f32 v234, v144, v145
    v_mfma_f32_16x16x32_bf16 a[56:59], v[44:47], v[220:223], a[56:59]
    v_mul_f32 v147, v147, v31
    v_cvt_pk_bf16_f32 v235, v146, v147
    v_mfma_f32_16x16x32_bf16 a[60:63], v[44:47], v[224:227], a[60:63]
    s_waitcnt lgkmcnt(7)
    ds_read_b128 v[36:39], v5 offset:14336
    v_mfma_f32_16x16x32_bf16 a[64:67], v[48:51], v[220:223], a[64:67]
    ds_read_b128 v[40:43], v5 offset:15360
    buffer_store_dwordx4 v[232:235], v3, s[4:7], s24 offen offset:1024 sc1
    v_mfma_f32_16x16x32_bf16 a[68:71], v[52:55], v[220:223], a[68:71]
    s_barrier
    ds_read_b128 v[44:47], v3 offset:0
    s_add_u32 m0, s54, 98304
    s_add_u32 s55, s55, 20480
    buffer_load_dwordx4 v3, s[4:7], s55 offen offset:0 sc1 lds
    v_mfma_f32_16x16x32_bf16 a[0:3], v[56:59], v[228:231], a[0:3]
    v_mfma_f32_16x16x32_bf16 a[4:7], v[56:59], v[232:235], a[4:7]
    s_waitcnt lgkmcnt(7)
    ds_read_b128 v[48:51], v3 offset:1024
    v_mfma_f32_16x16x32_bf16 a[8:11], v[60:63], v[228:231], a[8:11]
    v_mfma_f32_16x16x32_bf16 a[12:15], v[60:63], v[232:235], a[12:15]
    ds_read_b128 v[52:55], v3 offset:2048
    v_mfma_f32_16x16x32_bf16 a[16:19], v[64:67], v[228:231], a[16:19]
    buffer_load_dwordx4 v3, s[4:7], s55 offen offset:1024 sc1 lds
    v_mfma_f32_16x16x32_bf16 a[20:23], v[64:67], v[232:235], a[20:23]
    ds_read_b128 v[56:59], v3 offset:3072
    v_mfma_f32_16x16x32_bf16 a[24:27], v[68:71], v[228:231], a[24:27]
    s_add_u32 s58, s25, 6144
    buffer_load_dwordx4 a[220:223], v3, s[4:7], s58 offen sc1
    v_mfma_f32_16x16x32_bf16 a[28:31], v[68:71], v[232:235], a[28:31]
    s_waitcnt lgkmcnt(7)
    ds_read_b128 v[60:63], v3 offset:4096
    v_mfma_f32_16x16x32_bf16 a[32:35], v[72:75], v[228:231], a[32:35]
    v_mfma_f32_16x16x32_bf16 a[36:39], v[72:75], v[232:235], a[36:39]
    ds_read_b128 v[64:67], v3 offset:5120
    v_mfma_f32_16x16x32_bf16 a[40:43], v[76:79], v[228:231], a[40:43]
    buffer_load_dwordx4 v3, s[4:7], s55 offen offset:2048 sc1 lds
    v_mfma_f32_16x16x32_bf16 a[44:47], v[76:79], v[232:235], a[44:47]
    ds_read_b128 v[68:71], v3 offset:6144
    v_mfma_f32_16x16x32_bf16 a[48:51], v[80:83], v[228:231], a[48:51]
    v_mfma_f32_16x16x32_bf16 a[52:55], v[80:83], v[232:235], a[52:55]
    s_waitcnt lgkmcnt(7)
    ds_read_b128 v[72:75], v3 offset:7168
    v_mfma_f32_16x16x32_bf16 a[56:59], v[32:35], v[228:231], a[56:59]
    v_mfma_f32_16x16x32_bf16 a[60:63], v[32:35], v[232:235], a[60:63]
    ds_read_b128 v[76:79], v3 offset:8192
    v_mfma_f32_16x16x32_bf16 a[64:67], v[36:39], v[228:231], a[64:67]
    ds_read_b128 v[80:83], v3 offset:9216
    buffer_load_dwordx4 v3, s[4:7], s55 offen offset:3072 sc1 lds
    v_mfma_f32_16x16x32_bf16 a[68:71], v[40:43], v[228:231], a[68:71]
    s_waitcnt lgkmcnt(7)
    ds_read_b128 v[32:35], v3 offset:10240
    v_mfma_f32_16x16x32_bf16 a[0:3], v[44:47], a[144:147], a[0:3]
    s_add_u32 s58, s25, 9216
    buffer_load_dwordx4 a[224:227], v3, s[4:7], s58 offen sc1
    v_mfma_f32_16x16x32_bf16 a[4:7], v[44:47], a[148:151], a[4:7]
    ds_read_b128 v[36:39], v3 offset:11264
    v_mfma_f32_16x16x32_bf16 a[8:11], v[48:51], a[144:147], a[8:11]
    s_add_u32 m0, m0, 4096
    s_add_u32 s55, s55, 4096
    buffer_load_dwordx4 v3, s[4:7], s55 offen offset:0 sc1 lds
    v_mfma_f32_16x16x32_bf16 a[12:15], v[48:51], a[148:151], a[12:15]
    ds_read_b128 v[40:43], v3 offset:12288
    v_mfma_f32_16x16x32_bf16 a[16:19], v[52:55], a[144:147], a[16:19]
    v_mfma_f32_16x16x32_bf16 a[20:23], v[52:55], a[148:151], a[20:23]
    s_waitcnt lgkmcnt(7)
    ds_read_b128 v[44:47], v3 offset:13312
    v_mfma_f32_16x16x32_bf16 a[24:27], v[56:59], a[144:147], a[24:27]
    v_mfma_f32_16x16x32_bf16 a[28:31], v[56:59], a[148:151], a[28:31]
    ds_read_b128 v[48:51], v3 offset:14336
    v_mfma_f32_16x16x32_bf16 a[32:35], v[60:63], a[144:147], a[32:35]
    buffer_load_dwordx4 v3, s[4:7], s55 offen offset:1024 sc1 lds
    v_mfma_f32_16x16x32_bf16 a[36:39], v[60:63], a[148:151], a[36:39]
    ds_read_b128 v[52:55], v3 offset:15360
    v_mfma_f32_16x16x32_bf16 a[40:43], v[64:67], a[144:147], a[40:43]
    v_mfma_f32_16x16x32_bf16 a[44:47], v[64:67], a[148:151], a[44:47]
    s_waitcnt lgkmcnt(7)
    ds_read_b128 v[56:59], v3 offset:16384
    v_mfma_f32_16x16x32_bf16 a[48:51], v[68:71], a[144:147], a[48:51]
    s_add_u32 s58, s25, 8192
    buffer_load_dwordx4 a[228:231], v3, s[4:7], s58 offen sc1
    v_mfma_f32_16x16x32_bf16 a[52:55], v[68:71], a[148:151], a[52:55]
    ds_read_b128 v[60:63], v3 offset:17408
    v_mfma_f32_16x16x32_bf16 a[56:59], v[72:75], a[144:147], a[56:59]
    v_mfma_f32_16x16x32_bf16 a[60:63], v[72:75], a[148:151], a[60:63]
    ds_read_b128 v[64:67], v3 offset:18432
    v_mfma_f32_16x16x32_bf16 a[64:67], v[76:79], a[144:147], a[64:67]
    s_waitcnt lgkmcnt(7)
    ds_read_b128 v[68:71], v3 offset:19456
    v_mfma_f32_16x16x32_bf16 a[68:71], v[80:83], a[144:147], a[68:71]
    ds_read_b128 v[72:75], v3 offset:20480
    v_mfma_f32_16x16x32_bf16 a[0:3], v[32:35], a[152:155], a[0:3]
    v_mfma_f32_16x16x32_bf16 a[4:7], v[32:35], a[156:159], a[4:7]
    ds_read_b128 v[76:79], v3 offset:21504
    v_mfma_f32_16x16x32_bf16 a[8:11], v[36:39], a[152:155], a[8:11]
    v_mfma_f32_16x16x32_bf16 a[12:15], v[36:39], a[156:159], a[12:15]
    s_waitcnt lgkmcnt(7)
    ds_read_b128 v[80:83], v3 offset:22528
    v_mfma_f32_16x16x32_bf16 a[16:19], v[40:43], a[152:155], a[16:19]
    s_add_u32 s58, s25, 11264
    buffer_load_dwordx4 a[232:235], v3, s[4:7], s58 offen sc1
    v_mfma_f32_16x16x32_bf16 a[20:23], v[40:43], a[156:159], a[20:23]
    ds_read_b128 v[32:35], v3 offset:23552
    v_mfma_f32_16x16x32_bf16 a[24:27], v[44:47], a[152:155], a[24:27]
    v_mfma_f32_16x16x32_bf16 a[28:31], v[44:47], a[156:159], a[28:31]
    s_barrier
    ds_read_b128 v[36:39], v3 offset:24576
    v_mfma_f32_16x16x32_bf16 a[32:35], v[48:51], a[152:155], a[32:35]
    s_add_u32 m0, s54, 122880
    s_add_u32 s55, s55, 20480
    buffer_load_dwordx4 v3, s[4:7], s55 offen offset:0 sc1 lds
    v_mfma_f32_16x16x32_bf16 a[36:39], v[48:51], a[156:159], a[36:39]
    s_waitcnt lgkmcnt(7)
    ds_read_b128 v[40:43], v3 offset:25600
    v_mfma_f32_16x16x32_bf16 a[40:43], v[52:55], a[152:155], a[40:43]
    v_mfma_f32_16x16x32_bf16 a[44:47], v[52:55], a[156:159], a[44:47]
    ds_read_b128 v[44:47], v3 offset:26624
    v_mfma_f32_16x16x32_bf16 a[48:51], v[56:59], a[152:155], a[48:51]
    v_mfma_f32_16x16x32_bf16 a[52:55], v[56:59], a[156:159], a[52:55]
    ds_read_b128 v[48:51], v3 offset:27648
    v_mfma_f32_16x16x32_bf16 a[56:59], v[60:63], a[152:155], a[56:59]
    buffer_load_dwordx4 v3, s[4:7], s55 offen offset:1024 sc1 lds
    v_mfma_f32_16x16x32_bf16 a[60:63], v[60:63], a[156:159], a[60:63]
    s_waitcnt lgkmcnt(7)
    ds_read_b128 v[52:55], v3 offset:28672
    v_mfma_f32_16x16x32_bf16 a[64:67], v[64:67], a[152:155], a[64:67]
    ds_read_b128 v[56:59], v3 offset:29696
    v_mfma_f32_16x16x32_bf16 a[68:71], v[68:71], a[152:155], a[68:71]
    ds_read_b128 v[60:63], v3 offset:30720
    v_mfma_f32_16x16x32_bf16 a[0:3], v[72:75], a[160:163], a[0:3]
    buffer_load_dwordx4 v3, s[4:7], s55 offen offset:2048 sc1 lds
    v_mfma_f32_16x16x32_bf16 a[4:7], v[72:75], a[164:167], a[4:7]
    s_waitcnt lgkmcnt(7)
    ds_read_b128 v[64:67], v3 offset:31744
    v_mfma_f32_16x16x32_bf16 a[8:11], v[76:79], a[160:163], a[8:11]
    s_add_u32 s58, s25, 10240
    buffer_load_dwordx4 a[236:239], v3, s[4:7], s58 offen sc1
    v_mfma_f32_16x16x32_bf16 a[12:15], v[76:79], a[164:167], a[12:15]
    ds_read_b128 v[68:71], v3 offset:32768
    v_mfma_f32_16x16x32_bf16 a[16:19], v[80:83], a[160:163], a[16:19]
    v_mfma_f32_16x16x32_bf16 a[20:23], v[80:83], a[164:167], a[20:23]
    ds_read_b128 v[72:75], v3 offset:33792
    v_mfma_f32_16x16x32_bf16 a[24:27], v[32:35], a[160:163], a[24:27]
    s_waitcnt vmcnt(14)
    s_mov_b64 exec, 1
    buffer_store_dword v238, v7, s[4:7], s26 offen sc1
    s_mov_b64 exec, -1
    v_mfma_f32_16x16x32_bf16 a[28:31], v[32:35], a[164:167], a[28:31]
    s_waitcnt lgkmcnt(7)
    ds_read_b128 v[76:79], v3 offset:34816
    v_mfma_f32_16x16x32_bf16 a[32:35], v[36:39], a[160:163], a[32:35]
    buffer_load_dwordx4 v3, s[4:7], s55 offen offset:3072 sc1 lds
    v_mfma_f32_16x16x32_bf16 a[36:39], v[36:39], a[164:167], a[36:39]
    ds_read_b128 v[80:83], v3 offset:35840
    v_mfma_f32_16x16x32_bf16 a[40:43], v[40:43], a[160:163], a[40:43]
    v_mfma_f32_16x16x32_bf16 a[44:47], v[40:43], a[164:167], a[44:47]
    ds_read_b128 v[32:35], v3 offset:36864
    v_mfma_f32_16x16x32_bf16 a[48:51], v[44:47], a[160:163], a[48:51]
    v_mfma_f32_16x16x32_bf16 a[52:55], v[44:47], a[164:167], a[52:55]
    s_waitcnt lgkmcnt(7)
    ds_read_b128 v[36:39], v3 offset:37888
    v_mfma_f32_16x16x32_bf16 a[56:59], v[48:51], a[160:163], a[56:59]
    s_add_u32 m0, m0, 4096
    s_add_u32 s55, s55, 4096
    buffer_load_dwordx4 v3, s[4:7], s55 offen offset:0 sc1 lds
    v_mfma_f32_16x16x32_bf16 a[60:63], v[48:51], a[164:167], a[60:63]
    ds_read_b128 v[40:43], v3 offset:38912
    v_mfma_f32_16x16x32_bf16 a[64:67], v[52:55], a[160:163], a[64:67]
    ds_read_b128 v[44:47], v3 offset:39936
    v_mfma_f32_16x16x32_bf16 a[68:71], v[56:59], a[160:163], a[68:71]
    s_waitcnt lgkmcnt(7)
    ds_read_b128 v[48:51], v3 offset:40960
    v_mfma_f32_16x16x32_bf16 a[0:3], v[60:63], a[168:171], a[0:3]
    buffer_load_dwordx4 v3, s[4:7], s55 offen offset:1024 sc1 lds
    v_mfma_f32_16x16x32_bf16 a[4:7], v[60:63], a[172:175], a[4:7]
    ds_read_b128 v[52:55], v3 offset:41984
    v_mfma_f32_16x16x32_bf16 a[8:11], v[64:67], a[168:171], a[8:11]
    s_add_u32 s58, s34, 6144
    buffer_load_dwordx4 a[240:243], v3, s[4:7], s58 offen sc1
    v_mfma_f32_16x16x32_bf16 a[12:15], v[64:67], a[172:175], a[12:15]
    ds_read_b128 v[56:59], v3 offset:43008
    v_mfma_f32_16x16x32_bf16 a[16:19], v[68:71], a[168:171], a[16:19]
    v_mfma_f32_16x16x32_bf16 a[20:23], v[68:71], a[172:175], a[20:23]
    s_waitcnt lgkmcnt(7)
    ds_read_b128 v[60:63], v3 offset:44032
    v_mfma_f32_16x16x32_bf16 a[24:27], v[72:75], a[168:171], a[24:27]
    v_mfma_f32_16x16x32_bf16 a[28:31], v[72:75], a[172:175], a[28:31]
    ds_read_b128 v[64:67], v3 offset:45056
    v_mfma_f32_16x16x32_bf16 a[32:35], v[76:79], a[168:171], a[32:35]
    v_mfma_f32_16x16x32_bf16 a[36:39], v[76:79], a[172:175], a[36:39]
    ds_read_b128 v[68:71], v3 offset:46080
    v_mfma_f32_16x16x32_bf16 a[40:43], v[80:83], a[168:171], a[40:43]
    v_mfma_f32_16x16x32_bf16 a[44:47], v[80:83], a[172:175], a[44:47]
    s_waitcnt lgkmcnt(7)
    ds_read_b128 v[72:75], v3 offset:47104
    v_mfma_f32_16x16x32_bf16 a[48:51], v[32:35], a[168:171], a[48:51]
    v_mfma_f32_16x16x32_bf16 a[52:55], v[32:35], a[172:175], a[52:55]
    ds_read_b128 v[76:79], v3 offset:48128
    v_mfma_f32_16x16x32_bf16 a[56:59], v[36:39], a[168:171], a[56:59]
    s_add_u32 s58, s34, 7168
    buffer_load_dwordx4 a[244:247], v3, s[4:7], s58 offen sc1
    v_mfma_f32_16x16x32_bf16 a[60:63], v[36:39], a[172:175], a[60:63]
    s_barrier
    ds_read_b128 v[80:83], v3 offset:49152
    v_mfma_f32_16x16x32_bf16 a[64:67], v[40:43], a[168:171], a[64:67]
    s_waitcnt lgkmcnt(7)
    ds_read_b128 v[32:35], v3 offset:50176
    s_add_u32 m0, s54, 0
    s_add_u32 s55, s55, 20480
    buffer_load_dwordx4 v3, s[4:7], s55 offen offset:0 sc1 lds
    v_mfma_f32_16x16x32_bf16 a[68:71], v[44:47], a[168:171], a[68:71]
    ds_read_b128 v[36:39], v3 offset:51200
    v_mfma_f32_16x16x32_bf16 a[0:3], v[48:51], a[176:179], a[0:3]
    v_mfma_f32_16x16x32_bf16 a[4:7], v[48:51], a[180:183], a[4:7]
    ds_read_b128 v[40:43], v3 offset:52224
    v_mfma_f32_16x16x32_bf16 a[8:11], v[52:55], a[176:179], a[8:11]
    buffer_load_dwordx4 v3, s[4:7], s55 offen offset:1024 sc1 lds
    v_mfma_f32_16x16x32_bf16 a[12:15], v[52:55], a[180:183], a[12:15]
    s_waitcnt lgkmcnt(7)
    ds_read_b128 v[44:47], v3 offset:53248
    v_mfma_f32_16x16x32_bf16 a[16:19], v[56:59], a[176:179], a[16:19]
    v_mfma_f32_16x16x32_bf16 a[20:23], v[56:59], a[180:183], a[20:23]
    ds_read_b128 v[48:51], v3 offset:54272
    v_mfma_f32_16x16x32_bf16 a[24:27], v[60:63], a[176:179], a[24:27]
    s_add_u32 s58, s34, 8192
    buffer_load_dwordx4 a[248:251], v3, s[4:7], s58 offen sc1
    v_mfma_f32_16x16x32_bf16 a[28:31], v[60:63], a[180:183], a[28:31]
    ds_read_b128 v[52:55], v3 offset:55296
    v_mfma_f32_16x16x32_bf16 a[32:35], v[64:67], a[176:179], a[32:35]
    buffer_load_dwordx4 v3, s[4:7], s55 offen offset:2048 sc1 lds
    v_mfma_f32_16x16x32_bf16 a[36:39], v[64:67], a[180:183], a[36:39]
    s_waitcnt lgkmcnt(7)
    ds_read_b128 v[56:59], v3 offset:56320
    v_mfma_f32_16x16x32_bf16 a[40:43], v[68:71], a[176:179], a[40:43]
    v_mfma_f32_16x16x32_bf16 a[44:47], v[68:71], a[180:183], a[44:47]
    ds_read_b128 v[60:63], v3 offset:57344
    v_mfma_f32_16x16x32_bf16 a[48:51], v[72:75], a[176:179], a[48:51]
    v_mfma_f32_16x16x32_bf16 a[52:55], v[72:75], a[180:183], a[52:55]
    ds_read_b128 v[64:67], v3 offset:58368
    v_mfma_f32_16x16x32_bf16 a[56:59], v[76:79], a[176:179], a[56:59]
    buffer_load_dwordx4 v3, s[4:7], s55 offen offset:3072 sc1 lds
    v_mfma_f32_16x16x32_bf16 a[60:63], v[76:79], a[180:183], a[60:63]
    s_waitcnt lgkmcnt(7)
    ds_read_b128 v[68:71], v3 offset:59392
    v_mfma_f32_16x16x32_bf16 a[64:67], v[80:83], a[176:179], a[64:67]
    ds_read_b128 v[72:75], v3 offset:60416
    v_mfma_f32_16x16x32_bf16 a[68:71], v[32:35], a[176:179], a[68:71]
    ds_read_b128 v[76:79], v3 offset:61440
    v_mfma_f32_16x16x32_bf16 a[0:3], v[36:39], a[184:187], a[0:3]
    s_add_u32 m0, m0, 4096
    s_add_u32 s55, s55, 4096
    buffer_load_dwordx4 v3, s[4:7], s55 offen offset:0 sc1 lds
    v_mfma_f32_16x16x32_bf16 a[4:7], v[36:39], a[188:191], a[4:7]
    s_waitcnt lgkmcnt(7)
    ds_read_b128 v[80:83], v3 offset:62464
    v_mfma_f32_16x16x32_bf16 a[8:11], v[40:43], a[184:187], a[8:11]
    s_add_u32 s58, s34, 9216
    buffer_load_dwordx4 a[252:255], v3, s[4:7], s58 offen sc1
    v_mfma_f32_16x16x32_bf16 a[12:15], v[40:43], a[188:191], a[12:15]
    ds_read_b128 v[32:35], v3 offset:63488
    v_mfma_f32_16x16x32_bf16 a[16:19], v[44:47], a[184:187], a[16:19]
    v_mfma_f32_16x16x32_bf16 a[20:23], v[44:47], a[188:191], a[20:23]
    ds_read_b128 v[36:39], v3 offset:64512
    v_mfma_f32_16x16x32_bf16 a[24:27], v[48:51], a[184:187], a[24:27]
    s_mov_b64 exec, 15
    buffer_load_dword v2, v15, s[4:7], s27 offen sc1
    s_mov_b64 exec, -1
    v_mfma_f32_16x16x32_bf16 a[28:31], v[48:51], a[188:191], a[28:31]
    s_waitcnt lgkmcnt(7)
    ds_read_b128 v[40:43], v4 offset:0
    v_mfma_f32_16x16x32_bf16 a[32:35], v[52:55], a[184:187], a[32:35]
    buffer_load_dwordx4 v3, s[4:7], s55 offen offset:1024 sc1 lds
    v_mfma_f32_16x16x32_bf16 a[36:39], v[52:55], a[188:191], a[36:39]
    ds_read_b128 v[44:47], v4 offset:1024
    v_mfma_f32_16x16x32_bf16 a[40:43], v[56:59], a[184:187], a[40:43]
    v_mfma_f32_16x16x32_bf16 a[44:47], v[56:59], a[188:191], a[44:47]
    ds_read_b128 v[48:51], v4 offset:2048
    v_mfma_f32_16x16x32_bf16 a[48:51], v[60:63], a[184:187], a[48:51]
    v_mfma_f32_16x16x32_bf16 a[52:55], v[60:63], a[188:191], a[52:55]
    s_waitcnt lgkmcnt(7)
    ds_read_b128 v[52:55], v4 offset:3072
    v_mfma_f32_16x16x32_bf16 a[56:59], v[64:67], a[184:187], a[56:59]
    s_add_u32 s58, s34, 10240
    buffer_load_dwordx4 a[72:75], v3, s[4:7], s58 offen sc1
    v_mfma_f32_16x16x32_bf16 a[60:63], v[64:67], a[188:191], a[60:63]
    ds_read_b128 v[56:59], v4 offset:4096
    v_mfma_f32_16x16x32_bf16 a[64:67], v[68:71], a[184:187], a[64:67]
    ds_read_b128 v[60:63], v4 offset:5120
    v_mfma_f32_16x16x32_bf16 a[68:71], v[72:75], a[184:187], a[68:71]
    s_waitcnt lgkmcnt(7)
    ds_read_b128 v[64:67], v4 offset:6144
    v_mfma_f32_16x16x32_bf16 a[0:3], v[76:79], a[192:195], a[0:3]
    v_mfma_f32_16x16x32_bf16 a[4:7], v[76:79], a[196:199], a[4:7]
    ds_read_b128 v[68:71], v4 offset:7168
    v_mfma_f32_16x16x32_bf16 a[8:11], v[80:83], a[192:195], a[8:11]
    v_mfma_f32_16x16x32_bf16 a[12:15], v[80:83], a[196:199], a[12:15]
    s_barrier
    ds_read_b128 v[72:75], v4 offset:8192
    v_mfma_f32_16x16x32_bf16 a[16:19], v[32:35], a[192:195], a[16:19]
    s_add_u32 m0, s54, 24576
    s_add_u32 s55, s55, 20480
    buffer_load_dwordx4 v3, s[4:7], s55 offen offset:0 sc1 lds
    v_mfma_f32_16x16x32_bf16 a[20:23], v[32:35], a[196:199], a[20:23]
    s_waitcnt lgkmcnt(7)
    ds_read_b128 v[76:79], v4 offset:9216
    v_mfma_f32_16x16x32_bf16 a[24:27], v[36:39], a[192:195], a[24:27]
    s_add_u32 s58, s34, 11264
    buffer_load_dwordx4 a[76:79], v3, s[4:7], s58 offen sc1
    v_mfma_f32_16x16x32_bf16 a[28:31], v[36:39], a[196:199], a[28:31]
    ds_read_b128 v[80:83], v4 offset:10240
    v_mfma_f32_16x16x32_bf16 a[32:35], v[40:43], a[192:195], a[32:35]
    v_mfma_f32_16x16x32_bf16 a[36:39], v[40:43], a[196:199], a[36:39]
    ds_read_b128 v[32:35], v4 offset:11264
    v_mfma_f32_16x16x32_bf16 a[40:43], v[44:47], a[192:195], a[40:43]
    buffer_load_dwordx4 v3, s[4:7], s55 offen offset:1024 sc1 lds
    v_mfma_f32_16x16x32_bf16 a[44:47], v[44:47], a[196:199], a[44:47]
    s_waitcnt lgkmcnt(7)
    ds_read_b128 v[36:39], v4 offset:12288
    v_mfma_f32_16x16x32_bf16 a[48:51], v[48:51], a[192:195], a[48:51]
    v_mfma_f32_16x16x32_bf16 a[52:55], v[48:51], a[196:199], a[52:55]
    ds_read_b128 v[40:43], v4 offset:13312
    v_mfma_f32_16x16x32_bf16 a[56:59], v[52:55], a[192:195], a[56:59]
    v_mfma_f32_16x16x32_bf16 a[60:63], v[52:55], a[196:199], a[60:63]
    ds_read_b128 v[44:47], v4 offset:14336
    v_mfma_f32_16x16x32_bf16 a[64:67], v[56:59], a[192:195], a[64:67]
    s_waitcnt lgkmcnt(7)
    ds_read_b128 v[48:51], v4 offset:15360
    buffer_load_dwordx4 v3, s[4:7], s55 offen offset:2048 sc1 lds
    v_mfma_f32_16x16x32_bf16 a[68:71], v[60:63], a[192:195], a[68:71]
    ds_read_b128 v[52:55], v4 offset:16384
    v_mfma_f32_16x16x32_bf16 a[0:3], v[64:67], a[200:203], a[0:3]
    s_add_u32 s58, s35, 7168
    buffer_load_dwordx4 a[80:83], v3, s[4:7], s58 offen sc1
    v_mfma_f32_16x16x32_bf16 a[4:7], v[64:67], a[204:207], a[4:7]
    ds_read_b128 v[56:59], v4 offset:17408
    v_mfma_f32_16x16x32_bf16 a[8:11], v[68:71], a[200:203], a[8:11]
    buffer_load_dwordx4 v3, s[4:7], s55 offen offset:3072 sc1 lds
    v_mfma_f32_16x16x32_bf16 a[12:15], v[68:71], a[204:207], a[12:15]
    s_waitcnt lgkmcnt(7)
    ds_read_b128 v[60:63], v4 offset:18432
    v_mfma_f32_16x16x32_bf16 a[16:19], v[72:75], a[200:203], a[16:19]
    v_mfma_f32_16x16x32_bf16 a[20:23], v[72:75], a[204:207], a[20:23]
    ds_read_b128 v[64:67], v4 offset:19456
    v_mfma_f32_16x16x32_bf16 a[24:27], v[76:79], a[200:203], a[24:27]
    v_mfma_f32_16x16x32_bf16 a[28:31], v[76:79], a[204:207], a[28:31]
    ds_read_b128 v[68:71], v4 offset:20480
    v_mfma_f32_16x16x32_bf16 a[32:35], v[80:83], a[200:203], a[32:35]
    s_add_u32 m0, m0, 4096
    s_add_u32 s55, s55, 4096
    buffer_load_dwordx4 v3, s[4:7], s55 offen offset:0 sc1 lds
    v_mfma_f32_16x16x32_bf16 a[36:39], v[80:83], a[204:207], a[36:39]
    s_waitcnt lgkmcnt(7)
    ds_read_b128 v[72:75], v4 offset:21504
    v_mfma_f32_16x16x32_bf16 a[40:43], v[32:35], a[200:203], a[40:43]
    v_mfma_f32_16x16x32_bf16 a[44:47], v[32:35], a[204:207], a[44:47]
    ds_read_b128 v[76:79], v4 offset:22528
    v_mfma_f32_16x16x32_bf16 a[48:51], v[36:39], a[200:203], a[48:51]
    s_add_u32 s58, s35, 6144
    buffer_load_dwordx4 a[84:87], v3, s[4:7], s58 offen sc1
    v_mfma_f32_16x16x32_bf16 a[52:55], v[36:39], a[204:207], a[52:55]
    ds_read_b128 v[80:83], v4 offset:23552
    v_mfma_f32_16x16x32_bf16 a[56:59], v[40:43], a[200:203], a[56:59]
    buffer_load_dwordx4 v3, s[4:7], s55 offen offset:1024 sc1 lds
    v_mfma_f32_16x16x32_bf16 a[60:63], v[40:43], a[204:207], a[60:63]
    s_waitcnt lgkmcnt(7)
    ds_read_b128 v[32:35], v4 offset:24576
    v_mfma_f32_16x16x32_bf16 a[64:67], v[44:47], a[200:203], a[64:67]
    ds_read_b128 v[36:39], v4 offset:25600
    v_mfma_f32_16x16x32_bf16 a[68:71], v[48:51], a[200:203], a[68:71]
    ds_read_b128 v[40:43], v4 offset:26624
    v_mfma_f32_16x16x32_bf16 a[0:3], v[52:55], a[208:211], a[0:3]
    v_mfma_f32_16x16x32_bf16 a[4:7], v[52:55], a[212:215], a[4:7]
    s_waitcnt lgkmcnt(7)
    ds_read_b128 v[44:47], v4 offset:27648
    v_mfma_f32_16x16x32_bf16 a[8:11], v[56:59], a[208:211], a[8:11]
    v_mfma_f32_16x16x32_bf16 a[12:15], v[56:59], a[212:215], a[12:15]
    ds_read_b128 v[48:51], v4 offset:28672
    v_mfma_f32_16x16x32_bf16 a[16:19], v[60:63], a[208:211], a[16:19]
    s_add_u32 s58, s35, 9216
    buffer_load_dwordx4 a[88:91], v3, s[4:7], s58 offen sc1
    v_mfma_f32_16x16x32_bf16 a[20:23], v[60:63], a[212:215], a[20:23]
    ds_read_b128 v[52:55], v4 offset:29696
    v_mfma_f32_16x16x32_bf16 a[24:27], v[64:67], a[208:211], a[24:27]
    v_mfma_f32_16x16x32_bf16 a[28:31], v[64:67], a[212:215], a[28:31]
    s_waitcnt lgkmcnt(7)
    ds_read_b128 v[56:59], v4 offset:30720
    v_mfma_f32_16x16x32_bf16 a[32:35], v[68:71], a[208:211], a[32:35]
    v_mfma_f32_16x16x32_bf16 a[36:39], v[68:71], a[212:215], a[36:39]
    ds_read_b128 v[60:63], v4 offset:31744
    v_mfma_f32_16x16x32_bf16 a[40:43], v[72:75], a[208:211], a[40:43]
    v_mfma_f32_16x16x32_bf16 a[44:47], v[72:75], a[212:215], a[44:47]
    s_waitcnt vmcnt(32)
    s_barrier
    ds_read_b128 v[64:67], v4 offset:32768
    v_mfma_f32_16x16x32_bf16 a[48:51], v[76:79], a[208:211], a[48:51]
    s_add_u32 m0, s54, 49152
    s_add_u32 s55, s55, 20480
    buffer_load_dwordx4 v3, s[4:7], s55 offen offset:0 sc1 lds
    v_mfma_f32_16x16x32_bf16 a[52:55], v[76:79], a[212:215], a[52:55]
    s_waitcnt lgkmcnt(7)
    ds_read_b128 v[68:71], v4 offset:33792
    v_mfma_f32_16x16x32_bf16 a[56:59], v[80:83], a[208:211], a[56:59]
    v_mfma_f32_16x16x32_bf16 a[60:63], v[80:83], a[212:215], a[60:63]
    ds_read_b128 v[72:75], v4 offset:34816
    v_mfma_f32_16x16x32_bf16 a[64:67], v[32:35], a[208:211], a[64:67]
    ds_read_b128 v[76:79], v4 offset:35840
    v_mfma_f32_16x16x32_bf16 a[68:71], v[36:39], a[208:211], a[68:71]
    s_waitcnt lgkmcnt(7)
    ds_read_b128 v[80:83], v4 offset:36864
    buffer_load_dwordx4 v3, s[4:7], s55 offen offset:1024 sc1 lds
    v_mfma_f32_16x16x32_bf16 a[0:3], v[40:43], a[216:219], a[0:3]
    s_waitcnt vmcnt(14)
    v_cmp_ge_u32 vcc, 2, v2
    s_nop 0
    s_and_b32 s30, vcc_lo, 15
    s_cbranch_scc1 main_kernel_w2
main_kernel_r2:
    v_mfma_f32_16x16x32_bf16 a[4:7], v[40:43], a[220:223], a[4:7]
    ds_read_b128 v[32:35], v4 offset:37888
    v_mfma_f32_16x16x32_bf16 a[8:11], v[44:47], a[216:219], a[8:11]
    s_add_u32 s58, s35, 8192
    buffer_load_dwordx4 a[92:95], v3, s[4:7], s58 offen sc1
    v_mfma_f32_16x16x32_bf16 a[12:15], v[44:47], a[220:223], a[12:15]
    ds_read_b128 v[36:39], v4 offset:38912
    v_mfma_f32_16x16x32_bf16 a[16:19], v[48:51], a[216:219], a[16:19]
    buffer_load_dwordx4 v3, s[4:7], s55 offen offset:2048 sc1 lds
    v_mfma_f32_16x16x32_bf16 a[20:23], v[48:51], a[220:223], a[20:23]
    s_waitcnt lgkmcnt(7)
    ds_read_b128 v[40:43], v4 offset:39936
    v_mfma_f32_16x16x32_bf16 a[24:27], v[52:55], a[216:219], a[24:27]
    v_mfma_f32_16x16x32_bf16 a[28:31], v[52:55], a[220:223], a[28:31]
    ds_read_b128 v[44:47], v4 offset:40960
    v_mfma_f32_16x16x32_bf16 a[32:35], v[56:59], a[216:219], a[32:35]
    v_mfma_f32_16x16x32_bf16 a[36:39], v[56:59], a[220:223], a[36:39]
    ds_read_b128 v[48:51], v4 offset:41984
    v_mfma_f32_16x16x32_bf16 a[40:43], v[60:63], a[216:219], a[40:43]
    buffer_load_dwordx4 v3, s[4:7], s55 offen offset:3072 sc1 lds
    v_mfma_f32_16x16x32_bf16 a[44:47], v[60:63], a[220:223], a[44:47]
    s_waitcnt lgkmcnt(7)
    ds_read_b128 v[52:55], v4 offset:43008
    v_mfma_f32_16x16x32_bf16 a[48:51], v[64:67], a[216:219], a[48:51]
    v_mfma_f32_16x16x32_bf16 a[52:55], v[64:67], a[220:223], a[52:55]
    ds_read_b128 v[56:59], v4 offset:44032
    v_mfma_f32_16x16x32_bf16 a[56:59], v[68:71], a[216:219], a[56:59]
    s_add_u32 s58, s35, 11264
    buffer_load_dwordx4 a[96:99], v3, s[4:7], s58 offen sc1
    v_mfma_f32_16x16x32_bf16 a[60:63], v[68:71], a[220:223], a[60:63]
    ds_read_b128 v[60:63], v4 offset:45056
    v_mfma_f32_16x16x32_bf16 a[64:67], v[72:75], a[216:219], a[64:67]
    s_waitcnt lgkmcnt(7)
    ds_read_b128 v[64:67], v4 offset:46080
    s_add_u32 m0, m0, 4096
    s_add_u32 s55, s55, 4096
    buffer_load_dwordx4 v3, s[4:7], s55 offen offset:0 sc1 lds
    v_mfma_f32_16x16x32_bf16 a[68:71], v[76:79], a[216:219], a[68:71]
    ds_read_b128 v[68:71], v4 offset:47104
    v_mfma_f32_16x16x32_bf16 a[0:3], v[80:83], a[224:227], a[0:3]
    v_mfma_f32_16x16x32_bf16 a[4:7], v[80:83], a[228:231], a[4:7]
    ds_read_b128 v[72:75], v4 offset:48128
    v_mfma_f32_16x16x32_bf16 a[8:11], v[32:35], a[224:227], a[8:11]
    buffer_load_dwordx4 v3, s[4:7], s55 offen offset:1024 sc1 lds
    v_mfma_f32_16x16x32_bf16 a[12:15], v[32:35], a[228:231], a[12:15]
    s_waitcnt lgkmcnt(7)
    ds_read_b128 v[76:79], v4 offset:49152
    v_mfma_f32_16x16x32_bf16 a[16:19], v[36:39], a[224:227], a[16:19]
    v_mfma_f32_16x16x32_bf16 a[20:23], v[36:39], a[228:231], a[20:23]
    ds_read_b128 v[80:83], v4 offset:50176
    v_mfma_f32_16x16x32_bf16 a[24:27], v[40:43], a[224:227], a[24:27]
    s_add_u32 s58, s35, 10240
    buffer_load_dwordx4 a[100:103], v3, s[4:7], s58 offen sc1
    v_mfma_f32_16x16x32_bf16 a[28:31], v[40:43], a[228:231], a[28:31]
    ds_read_b128 v[32:35], v4 offset:51200
    v_mfma_f32_16x16x32_bf16 a[32:35], v[44:47], a[224:227], a[32:35]
    v_mfma_f32_16x16x32_bf16 a[36:39], v[44:47], a[228:231], a[36:39]
    s_waitcnt lgkmcnt(7)
    ds_read_b128 v[36:39], v4 offset:52224
    v_mfma_f32_16x16x32_bf16 a[40:43], v[48:51], a[224:227], a[40:43]
    s_add_u32 s58, s25, 13312
    buffer_load_dwordx4 a[104:107], v3, s[4:7], s58 offen sc1
    v_mfma_f32_16x16x32_bf16 a[44:47], v[48:51], a[228:231], a[44:47]
    ds_read_b128 v[40:43], v4 offset:53248
    v_mfma_f32_16x16x32_bf16 a[48:51], v[52:55], a[224:227], a[48:51]
    v_mfma_f32_16x16x32_bf16 a[52:55], v[52:55], a[228:231], a[52:55]
    ds_read_b128 v[44:47], v4 offset:54272
    v_mfma_f32_16x16x32_bf16 a[56:59], v[56:59], a[224:227], a[56:59]
    s_add_u32 s58, s25, 12288
    buffer_load_dwordx4 a[108:111], v3, s[4:7], s58 offen sc1
    v_mfma_f32_16x16x32_bf16 a[60:63], v[56:59], a[228:231], a[60:63]
    s_waitcnt lgkmcnt(7)
    ds_read_b128 v[48:51], v4 offset:55296
    v_mfma_f32_16x16x32_bf16 a[64:67], v[60:63], a[224:227], a[64:67]
    ds_read_b128 v[52:55], v4 offset:56320
    v_mfma_f32_16x16x32_bf16 a[68:71], v[64:67], a[224:227], a[68:71]
    s_barrier
    ds_read_b128 v[56:59], v4 offset:57344
    s_add_u32 m0, s54, 73728
    s_add_u32 s55, s55, 20480
    buffer_load_dwordx4 v3, s[4:7], s55 offen offset:0 sc1 lds
    v_mfma_f32_16x16x32_bf16 a[0:3], v[68:71], a[232:235], a[0:3]
    s_add_u32 s58, s25, 15360
    buffer_load_dwordx4 a[112:115], v3, s[4:7], s58 offen sc1
    v_mfma_f32_16x16x32_bf16 a[4:7], v[68:71], a[236:239], a[4:7]
    s_waitcnt lgkmcnt(7)
    ds_read_b128 v[60:63], v4 offset:58368
    v_mfma_f32_16x16x32_bf16 a[8:11], v[72:75], a[232:235], a[8:11]
    v_mfma_f32_16x16x32_bf16 a[12:15], v[72:75], a[236:239], a[12:15]
    ds_read_b128 v[64:67], v4 offset:59392
    v_mfma_f32_16x16x32_bf16 a[16:19], v[76:79], a[232:235], a[16:19]
    buffer_load_dwordx4 v3, s[4:7], s55 offen offset:1024 sc1 lds
    v_mfma_f32_16x16x32_bf16 a[20:23], v[76:79], a[236:239], a[20:23]
    ds_read_b128 v[68:71], v4 offset:60416
    v_mfma_f32_16x16x32_bf16 a[24:27], v[80:83], a[232:235], a[24:27]
    s_add_u32 s58, s25, 14336
    buffer_load_dwordx4 a[116:119], v3, s[4:7], s58 offen sc1
    v_mfma_f32_16x16x32_bf16 a[28:31], v[80:83], a[236:239], a[28:31]
    s_waitcnt lgkmcnt(7)
    ds_read_b128 v[72:75], v4 offset:61440
    v_mfma_f32_16x16x32_bf16 a[32:35], v[32:35], a[232:235], a[32:35]
    v_mfma_f32_16x16x32_bf16 a[36:39], v[32:35], a[236:239], a[36:39]
    ds_read_b128 v[76:79], v4 offset:62464
    v_mfma_f32_16x16x32_bf16 a[40:43], v[36:39], a[232:235], a[40:43]
    buffer_load_dwordx4 v3, s[4:7], s55 offen offset:2048 sc1 lds
    v_mfma_f32_16x16x32_bf16 a[44:47], v[36:39], a[236:239], a[44:47]
    ds_read_b128 v[80:83], v4 offset:63488
    v_mfma_f32_16x16x32_bf16 a[48:51], v[40:43], a[232:235], a[48:51]
    s_add_u32 s58, s25, 17408
    buffer_load_dwordx4 a[120:123], v3, s[4:7], s58 offen sc1
    v_mfma_f32_16x16x32_bf16 a[52:55], v[40:43], a[236:239], a[52:55]
    s_waitcnt lgkmcnt(7)
    ds_read_b128 v[32:35], v4 offset:64512
    v_mfma_f32_16x16x32_bf16 a[56:59], v[44:47], a[232:235], a[56:59]
    v_mfma_f32_16x16x32_bf16 a[60:63], v[44:47], a[236:239], a[60:63]
    ds_read_b128 v[36:39], v5 offset:0
    v_mfma_f32_16x16x32_bf16 a[64:67], v[48:51], a[232:235], a[64:67]
    ds_read_b128 v[40:43], v5 offset:1024
    buffer_load_dwordx4 v3, s[4:7], s55 offen offset:3072 sc1 lds
    v_mfma_f32_16x16x32_bf16 a[68:71], v[52:55], a[232:235], a[68:71]
    s_waitcnt lgkmcnt(7)
    ds_read_b128 v[44:47], v5 offset:2048
    v_mfma_f32_16x16x32_bf16 a[0:3], v[56:59], a[240:243], a[0:3]
    s_add_u32 s58, s25, 16384
    buffer_load_dwordx4 a[124:127], v3, s[4:7], s58 offen sc1
    v_mfma_f32_16x16x32_bf16 a[4:7], v[56:59], a[244:247], a[4:7]
    ds_read_b128 v[48:51], v5 offset:3072
    v_mfma_f32_16x16x32_bf16 a[8:11], v[60:63], a[240:243], a[8:11]
    s_add_u32 m0, m0, 4096
    s_add_u32 s55, s55, 4096
    buffer_load_dwordx4 v3, s[4:7], s55 offen offset:0 sc1 lds
    v_mfma_f32_16x16x32_bf16 a[12:15], v[60:63], a[244:247], a[12:15]
    ds_read_b128 v[52:55], v5 offset:4096
    v_mfma_f32_16x16x32_bf16 a[16:19], v[64:67], a[240:243], a[16:19]
    s_add_u32 s58, s34, 12288
    buffer_load_dwordx4 a[128:131], v3, s[4:7], s58 offen sc1
    v_mfma_f32_16x16x32_bf16 a[20:23], v[64:67], a[244:247], a[20:23]
    s_waitcnt lgkmcnt(7)
    ds_read_b128 v[56:59], v5 offset:5120
    v_mfma_f32_16x16x32_bf16 a[24:27], v[68:71], a[240:243], a[24:27]
    v_mfma_f32_16x16x32_bf16 a[28:31], v[68:71], a[244:247], a[28:31]
    ds_read_b128 v[60:63], v5 offset:6144
    v_mfma_f32_16x16x32_bf16 a[32:35], v[72:75], a[240:243], a[32:35]
    buffer_load_dwordx4 v3, s[4:7], s55 offen offset:1024 sc1 lds
    v_mfma_f32_16x16x32_bf16 a[36:39], v[72:75], a[244:247], a[36:39]
    ds_read_b128 v[64:67], v5 offset:7168
    v_mfma_f32_16x16x32_bf16 a[40:43], v[76:79], a[240:243], a[40:43]
    s_add_u32 s58, s34, 13312
    buffer_load_dwordx4 a[132:135], v3, s[4:7], s58 offen sc1
    v_mfma_f32_16x16x32_bf16 a[44:47], v[76:79], a[244:247], a[44:47]
    s_waitcnt lgkmcnt(7)
    ds_read_b128 v[68:71], v5 offset:8192
    v_mfma_f32_16x16x32_bf16 a[48:51], v[80:83], a[240:243], a[48:51]
    v_mfma_f32_16x16x32_bf16 a[52:55], v[80:83], a[244:247], a[52:55]
    ds_read_b128 v[72:75], v5 offset:9216
    v_mfma_f32_16x16x32_bf16 a[56:59], v[32:35], a[240:243], a[56:59]
    s_add_u32 s58, s34, 14336
    buffer_load_dwordx4 a[136:139], v3, s[4:7], s58 offen sc1
    v_mfma_f32_16x16x32_bf16 a[60:63], v[32:35], a[244:247], a[60:63]
    ds_read_b128 v[76:79], v5 offset:10240
    v_mfma_f32_16x16x32_bf16 a[64:67], v[36:39], a[240:243], a[64:67]
    s_waitcnt lgkmcnt(7)
    ds_read_b128 v[80:83], v5 offset:11264
    v_mfma_f32_16x16x32_bf16 a[68:71], v[40:43], a[240:243], a[68:71]
    ds_read_b128 v[32:35], v5 offset:12288
    v_mfma_f32_16x16x32_bf16 a[0:3], v[44:47], a[248:251], a[0:3]
    s_mov_b32 s101, code_end-16384-main_kernel_pc
    s_load_dword s100, s[98:99], s101
    s_load_dword s100, s[98:99], s101 offset:64
    v_mfma_f32_16x16x32_bf16 a[4:7], v[44:47], a[252:255], a[4:7]
    ds_read_b128 v[36:39], v5 offset:13312
    v_mfma_f32_16x16x32_bf16 a[8:11], v[48:51], a[248:251], a[8:11]
    s_add_u32 s58, s34, 15360
    buffer_load_dwordx4 a[140:143], v3, s[4:7], s58 offen sc1
    v_mfma_f32_16x16x32_bf16 a[12:15], v[48:51], a[252:255], a[12:15]
    s_waitcnt lgkmcnt(7)
    ds_read_b128 v[40:43], v5 offset:14336
    v_mfma_f32_16x16x32_bf16 a[16:19], v[52:55], a[248:251], a[16:19]
    v_mfma_f32_16x16x32_bf16 a[20:23], v[52:55], a[252:255], a[20:23]
    ds_read_b128 v[44:47], v5 offset:15360
    v_mfma_f32_16x16x32_bf16 a[24:27], v[56:59], a[248:251], a[24:27]
    s_add_u32 s58, s34, 16384
    buffer_load_dwordx4 v[84:87], v3, s[4:7], s58 offen sc1
    v_mfma_f32_16x16x32_bf16 a[28:31], v[56:59], a[252:255], a[28:31]
    s_waitcnt vmcnt(37)
    s_barrier
    ds_read_b128 v[48:51], v3 offset:0
    v_mfma_f32_16x16x32_bf16 a[32:35], v[60:63], a[248:251], a[32:35]
    s_add_u32 m0, s54, 98304
    s_add_u32 s55, s55, 20480
    buffer_load_dwordx4 v3, s[4:7], s55 offen offset:0 sc1 lds
    v_mfma_f32_16x16x32_bf16 a[36:39], v[60:63], a[252:255], a[36:39]
    s_waitcnt lgkmcnt(7)
    ds_read_b128 v[52:55], v3 offset:1024
    v_mfma_f32_16x16x32_bf16 a[40:43], v[64:67], a[248:251], a[40:43]
    s_add_u32 s58, s34, 17408
    buffer_load_dwordx4 v[88:91], v3, s[4:7], s58 offen sc1
    v_mfma_f32_16x16x32_bf16 a[44:47], v[64:67], a[252:255], a[44:47]
    ds_read_b128 v[56:59], v3 offset:2048
    v_mfma_f32_16x16x32_bf16 a[48:51], v[68:71], a[248:251], a[48:51]
    v_mfma_f32_16x16x32_bf16 a[52:55], v[68:71], a[252:255], a[52:55]
    ds_read_b128 v[60:63], v3 offset:3072
    v_mfma_f32_16x16x32_bf16 a[56:59], v[72:75], a[248:251], a[56:59]
    buffer_load_dwordx4 v3, s[4:7], s55 offen offset:1024 sc1 lds
    v_mfma_f32_16x16x32_bf16 a[60:63], v[72:75], a[252:255], a[60:63]
    s_waitcnt lgkmcnt(7)
    ds_read_b128 v[64:67], v3 offset:4096
    v_mfma_f32_16x16x32_bf16 a[64:67], v[76:79], a[248:251], a[64:67]
    ds_read_b128 v[68:71], v3 offset:5120
    v_mfma_f32_16x16x32_bf16 a[68:71], v[80:83], a[248:251], a[68:71]
    s_waitcnt vmcnt(37)
    ds_read_b128 v[72:75], v3 offset:6144
    v_mfma_f32_16x16x32_bf16 a[0:3], v[32:35], a[72:75], a[0:3]
    buffer_load_dwordx4 v3, s[4:7], s55 offen offset:2048 sc1 lds
    v_mfma_f32_16x16x32_bf16 a[4:7], v[32:35], a[76:79], a[4:7]
    s_waitcnt lgkmcnt(7)
    ds_read_b128 v[76:79], v3 offset:7168
    v_mfma_f32_16x16x32_bf16 a[8:11], v[36:39], a[72:75], a[8:11]
    s_add_u32 s58, s35, 13312
    buffer_load_dwordx4 v[92:95], v3, s[4:7], s58 offen sc1
    v_mfma_f32_16x16x32_bf16 a[12:15], v[36:39], a[76:79], a[12:15]
    ds_read_b128 v[80:83], v3 offset:8192
    v_mfma_f32_16x16x32_bf16 a[16:19], v[40:43], a[72:75], a[16:19]
    v_mfma_f32_16x16x32_bf16 a[20:23], v[40:43], a[76:79], a[20:23]
    ds_read_b128 v[32:35], v3 offset:9216
    v_mfma_f32_16x16x32_bf16 a[24:27], v[44:47], a[72:75], a[24:27]
    buffer_load_dwordx4 v3, s[4:7], s55 offen offset:3072 sc1 lds
    v_mfma_f32_16x16x32_bf16 a[28:31], v[44:47], a[76:79], a[28:31]
    s_waitcnt lgkmcnt(7)
    ds_read_b128 v[36:39], v3 offset:10240
    v_mfma_f32_16x16x32_bf16 a[32:35], v[48:51], a[72:75], a[32:35]
    s_add_u32 s58, s35, 12288
    buffer_load_dwordx4 v[96:99], v3, s[4:7], s58 offen sc1
    v_mfma_f32_16x16x32_bf16 a[36:39], v[48:51], a[76:79], a[36:39]
    ds_read_b128 v[40:43], v3 offset:11264
    v_mfma_f32_16x16x32_bf16 a[40:43], v[52:55], a[72:75], a[40:43]
    v_mfma_f32_16x16x32_bf16 a[44:47], v[52:55], a[76:79], a[44:47]
    ds_read_b128 v[44:47], v3 offset:12288
    v_mfma_f32_16x16x32_bf16 a[48:51], v[56:59], a[72:75], a[48:51]
    s_add_u32 m0, m0, 4096
    s_add_u32 s55, s55, 4096
    buffer_load_dwordx4 v3, s[4:7], s55 offen offset:0 sc1 lds
    v_mfma_f32_16x16x32_bf16 a[52:55], v[56:59], a[76:79], a[52:55]
    s_waitcnt lgkmcnt(7)
    ds_read_b128 v[48:51], v3 offset:13312
    v_mfma_f32_16x16x32_bf16 a[56:59], v[60:63], a[72:75], a[56:59]
    s_add_u32 s58, s35, 15360
    buffer_load_dwordx4 v[100:103], v3, s[4:7], s58 offen sc1
    v_mfma_f32_16x16x32_bf16 a[60:63], v[60:63], a[76:79], a[60:63]
    ds_read_b128 v[52:55], v3 offset:14336
    v_mfma_f32_16x16x32_bf16 a[64:67], v[64:67], a[72:75], a[64:67]
    ds_read_b128 v[56:59], v3 offset:15360
    v_mfma_f32_16x16x32_bf16 a[68:71], v[68:71], a[72:75], a[68:71]
    s_waitcnt vmcnt(37)
    s_waitcnt lgkmcnt(7)
    ds_read_b128 v[60:63], v3 offset:16384
    buffer_load_dwordx4 v3, s[4:7], s55 offen offset:1024 sc1 lds
    v_mfma_f32_16x16x32_bf16 a[0:3], v[72:75], a[80:83], a[0:3]
    s_add_u32 s58, s35, 14336
    buffer_load_dwordx4 v[104:107], v3, s[4:7], s58 offen sc1
    v_mfma_f32_16x16x32_bf16 a[4:7], v[72:75], a[84:87], a[4:7]
    ds_read_b128 v[64:67], v3 offset:17408
    v_mfma_f32_16x16x32_bf16 a[8:11], v[76:79], a[80:83], a[8:11]
    v_mfma_f32_16x16x32_bf16 a[12:15], v[76:79], a[84:87], a[12:15]
    s_waitcnt vmcnt(34)
    ds_read_b128 v[68:71], v3 offset:18432
    v_mfma_f32_16x16x32_bf16 a[0:3], v[80:83], a[88:91], a[0:3]
    s_add_u32 s58, s35, 17408
    buffer_load_dwordx4 v[108:111], v3, s[4:7], s58 offen sc1
    v_mfma_f32_16x16x32_bf16 a[4:7], v[80:83], a[92:95], a[4:7]
    s_waitcnt lgkmcnt(7)
    ds_read_b128 v[72:75], v3 offset:19456
    v_mfma_f32_16x16x32_bf16 a[8:11], v[32:35], a[88:91], a[8:11]
    v_mfma_f32_16x16x32_bf16 a[12:15], v[32:35], a[92:95], a[12:15]
    s_waitcnt vmcnt(29)
    ds_read_b128 v[76:79], v3 offset:20480
    v_mfma_f32_16x16x32_bf16 a[0:3], v[36:39], a[96:99], a[0:3]
    s_add_u32 s58, s35, 16384
    buffer_load_dwordx4 v[112:115], v3, s[4:7], s58 offen sc1
    v_mfma_f32_16x16x32_bf16 a[4:7], v[36:39], a[100:103], a[4:7]
    ds_read_b128 v[80:83], v3 offset:21504
    v_mfma_f32_16x16x32_bf16 a[8:11], v[40:43], a[96:99], a[8:11]
    v_mfma_f32_16x16x32_bf16 a[12:15], v[40:43], a[100:103], a[12:15]
    s_waitcnt vmcnt(28)
    s_waitcnt lgkmcnt(7)
    ds_read_b128 v[32:35], v3 offset:22528
    v_mfma_f32_16x16x32_bf16 a[0:3], v[44:47], a[104:107], a[0:3]
    v_mfma_f32_16x16x32_bf16 a[4:7], v[44:47], a[108:111], a[4:7]
    ds_read_b128 v[36:39], v3 offset:23552
    v_mfma_f32_16x16x32_bf16 a[8:11], v[48:51], a[104:107], a[8:11]
    v_mfma_f32_16x16x32_bf16 a[12:15], v[48:51], a[108:111], a[12:15]
    s_waitcnt vmcnt(24)
    s_barrier
    ds_read_b128 v[40:43], v3 offset:24576
    v_mfma_f32_16x16x32_bf16 a[0:3], v[52:55], a[112:115], a[0:3]
    s_add_u32 m0, s54, 122880
    s_add_u32 s55, s55, 20480
    buffer_load_dwordx4 v3, s[4:7], s55 offen offset:0 sc1 lds
    v_mfma_f32_16x16x32_bf16 a[4:7], v[52:55], a[116:119], a[4:7]
    s_waitcnt lgkmcnt(7)
    ds_read_b128 v[44:47], v3 offset:25600
    v_mfma_f32_16x16x32_bf16 a[8:11], v[56:59], a[112:115], a[8:11]
    v_mfma_f32_16x16x32_bf16 a[12:15], v[56:59], a[116:119], a[12:15]
    s_waitcnt vmcnt(21)
    ds_read_b128 v[48:51], v3 offset:26624
    v_mfma_f32_16x16x32_bf16 a[0:3], v[60:63], a[120:123], a[0:3]
    v_mfma_f32_16x16x32_bf16 a[4:7], v[60:63], a[124:127], a[4:7]
    ds_read_b128 v[52:55], v3 offset:27648
    v_mfma_f32_16x16x32_bf16 a[8:11], v[64:67], a[120:123], a[8:11]
    buffer_load_dwordx4 v3, s[4:7], s55 offen offset:1024 sc1 lds
    v_mfma_f32_16x16x32_bf16 a[12:15], v[64:67], a[124:127], a[12:15]
    s_waitcnt vmcnt(18)
    s_waitcnt lgkmcnt(7)
    ds_read_b128 v[56:59], v3 offset:28672
    v_mfma_f32_16x16x32_bf16 a[0:3], v[68:71], a[128:131], a[0:3]
    v_mfma_f32_16x16x32_bf16 a[4:7], v[68:71], a[132:135], a[4:7]
    ds_read_b128 v[60:63], v3 offset:29696
    v_mfma_f32_16x16x32_bf16 a[8:11], v[72:75], a[128:131], a[8:11]
    v_mfma_f32_16x16x32_bf16 a[12:15], v[72:75], a[132:135], a[12:15]
    s_waitcnt vmcnt(16)
    ds_read_b128 v[64:67], v3 offset:30720
    v_mfma_f32_16x16x32_bf16 a[0:3], v[76:79], a[136:139], a[0:3]
    buffer_load_dwordx4 v3, s[4:7], s55 offen offset:2048 sc1 lds
    v_mfma_f32_16x16x32_bf16 a[4:7], v[76:79], a[140:143], a[4:7]
    s_waitcnt lgkmcnt(7)
    ds_read_b128 v[68:71], v3 offset:31744
    v_mfma_f32_16x16x32_bf16 a[8:11], v[80:83], a[136:139], a[8:11]
    v_mfma_f32_16x16x32_bf16 a[12:15], v[80:83], a[140:143], a[12:15]
    s_waitcnt vmcnt(14)
    ds_read_b128 v[72:75], v3 offset:32768
    v_mfma_f32_16x16x32_bf16 a[0:3], v[32:35], v[84:87], a[0:3]
    v_mfma_f32_16x16x32_bf16 a[4:7], v[32:35], v[88:91], a[4:7]
    ds_read_b128 v[76:79], v3 offset:33792
    v_mfma_f32_16x16x32_bf16 a[8:11], v[36:39], v[84:87], a[8:11]
    buffer_load_dwordx4 v3, s[4:7], s55 offen offset:3072 sc1 lds
    v_mfma_f32_16x16x32_bf16 a[12:15], v[36:39], v[88:91], a[12:15]
    s_waitcnt vmcnt(10)
    s_waitcnt lgkmcnt(7)
    ds_read_b128 v[80:83], v3 offset:34816
    v_mfma_f32_16x16x32_bf16 a[0:3], v[40:43], v[92:95], a[0:3]
    v_mfma_f32_16x16x32_bf16 a[4:7], v[40:43], v[96:99], a[4:7]
    ds_read_b128 v[32:35], v3 offset:35840
    v_mfma_f32_16x16x32_bf16 a[8:11], v[44:47], v[92:95], a[8:11]
    v_mfma_f32_16x16x32_bf16 a[12:15], v[44:47], v[96:99], a[12:15]
    s_waitcnt vmcnt(6)
    ds_read_b128 v[36:39], v3 offset:36864
    v_mfma_f32_16x16x32_bf16 a[0:3], v[48:51], v[100:103], a[0:3]
    s_add_u32 m0, m0, 4096
    s_add_u32 s55, s55, 4096
    buffer_load_dwordx4 v3, s[4:7], s55 offen offset:0 sc1 lds
    v_mfma_f32_16x16x32_bf16 a[4:7], v[48:51], v[104:107], a[4:7]
    s_waitcnt lgkmcnt(7)
    ds_read_b128 v[40:43], v3 offset:37888
    v_mfma_f32_16x16x32_bf16 a[8:11], v[52:55], v[100:103], a[8:11]
    v_mfma_f32_16x16x32_bf16 a[12:15], v[52:55], v[104:107], a[12:15]
    s_waitcnt vmcnt(5)
    ds_read_b128 v[44:47], v3 offset:38912
    v_mfma_f32_16x16x32_bf16 a[0:3], v[56:59], v[108:111], a[0:3]
    v_mfma_f32_16x16x32_bf16 a[4:7], v[56:59], v[112:115], a[4:7]
    ds_read_b128 v[48:51], v3 offset:39936
    v_mfma_f32_16x16x32_bf16 a[8:11], v[60:63], v[108:111], a[8:11]
    buffer_load_dwordx4 v3, s[4:7], s55 offen offset:1024 sc1 lds
    v_mfma_f32_16x16x32_bf16 a[12:15], v[60:63], v[112:115], a[12:15]
    s_waitcnt lgkmcnt(7)
    ds_read_b128 v[52:55], v3 offset:40960
    v_mfma_f32_16x16x32_bf16 a[16:19], v[64:67], a[80:83], a[16:19]
    v_mfma_f32_16x16x32_bf16 a[20:23], v[64:67], a[84:87], a[20:23]
    ds_read_b128 v[56:59], v3 offset:41984
    v_mfma_f32_16x16x32_bf16 a[24:27], v[68:71], a[80:83], a[24:27]
    v_accvgpr_read_b32 v16, a0
    v_accvgpr_read_b32 v17, a1
    v_mfma_f32_16x16x32_bf16 a[28:31], v[68:71], a[84:87], a[28:31]
    ds_read_b128 v[60:63], v3 offset:43008
    v_accvgpr_read_b32 v18, a2
    v_accvgpr_read_b32 v19, a3
    v_mfma_f32_16x16x32_bf16 a[16:19], v[72:75], a[88:91], a[16:19]
    v_accvgpr_read_b32 v20, a8
    v_accvgpr_read_b32 v21, a9
    v_accvgpr_read_b32 v22, a10
    v_mfma_f32_16x16x32_bf16 a[20:23], v[72:75], a[92:95], a[20:23]
    s_waitcnt lgkmcnt(7)
    ds_read_b128 v[64:67], v3 offset:44032
    v_accvgpr_read_b32 v23, a11
    v_cvt_pk_bf16_f32 v164, v16, v17
    v_mfma_f32_16x16x32_bf16 a[24:27], v[76:79], a[88:91], a[24:27]
    v_cvt_pk_bf16_f32 v165, v18, v19
    v_cvt_pk_bf16_f32 v166, v20, v21
    v_mfma_f32_16x16x32_bf16 a[28:31], v[76:79], a[92:95], a[28:31]
    ds_read_b128 v[68:71], v3 offset:45056
    v_cvt_pk_bf16_f32 v167, v22, v23
    v_accvgpr_read_b32 v24, a4
    v_mfma_f32_16x16x32_bf16 a[16:19], v[80:83], a[96:99], a[16:19]
    buffer_store_dwordx4 v[164:167], v14, s[4:7], s28 offen offset:0 sc1
    v_accvgpr_read_b32 v25, a5
    v_accvgpr_read_b32 v26, a6
    v_mfma_f32_16x16x32_bf16 a[20:23], v[80:83], a[100:103], a[20:23]
    ds_read_b128 v[72:75], v3 offset:46080
    v_accvgpr_read_b32 v27, a7
    v_accvgpr_read_b32 v28, a12
    v_mfma_f32_16x16x32_bf16 a[24:27], v[32:35], a[96:99], a[24:27]
    v_accvgpr_read_b32 v29, a13
    v_accvgpr_read_b32 v30, a14
    v_mfma_f32_16x16x32_bf16 a[28:31], v[32:35], a[100:103], a[28:31]
    s_waitcnt lgkmcnt(7)
    ds_read_b128 v[76:79], v3 offset:47104
    v_accvgpr_read_b32 v31, a15
    v_cvt_pk_bf16_f32 v168, v24, v25
    v_mfma_f32_16x16x32_bf16 a[16:19], v[36:39], a[104:107], a[16:19]
    v_cvt_pk_bf16_f32 v169, v26, v27
    v_cvt_pk_bf16_f32 v170, v28, v29
    v_cvt_pk_bf16_f32 v171, v30, v31
    v_mfma_f32_16x16x32_bf16 a[20:23], v[36:39], a[108:111], a[20:23]
    ds_read_b128 v[80:83], v3 offset:48128
    v_mfma_f32_16x16x32_bf16 a[24:27], v[40:43], a[104:107], a[24:27]
    buffer_store_dwordx4 v[168:171], v6, s[4:7], s28 offen offset:0 sc1
    v_mfma_f32_16x16x32_bf16 a[28:31], v[40:43], a[108:111], a[28:31]
    s_barrier
    ds_read_b128 v[32:35], v3 offset:49152
    v_mfma_f32_16x16x32_bf16 a[16:19], v[44:47], a[112:115], a[16:19]
    s_add_u32 m0, s50, 0
    s_add_u32 s56, s51, 0
    buffer_load_dwordx4 v3, s[4:7], s56 offen lds
    v_mfma_f32_16x16x32_bf16 a[20:23], v[44:47], a[116:119], a[20:23]
    s_waitcnt lgkmcnt(7)
    ds_read_b128 v[36:39], v3 offset:50176
    v_mfma_f32_16x16x32_bf16 a[24:27], v[48:51], a[112:115], a[24:27]
    v_mfma_f32_16x16x32_bf16 a[28:31], v[48:51], a[116:119], a[28:31]
    ds_read_b128 v[40:43], v3 offset:51200
    v_mfma_f32_16x16x32_bf16 a[16:19], v[52:55], a[120:123], a[16:19]
    v_mfma_f32_16x16x32_bf16 a[20:23], v[52:55], a[124:127], a[20:23]
    ds_read_b128 v[44:47], v3 offset:52224
    v_mfma_f32_16x16x32_bf16 a[24:27], v[56:59], a[120:123], a[24:27]
    s_add_u32 m0, s53, 0
    s_add_u32 s56, s52, 0
    buffer_load_dwordx4 v3, s[4:7], s56 offen lds
    v_mfma_f32_16x16x32_bf16 a[28:31], v[56:59], a[124:127], a[28:31]
    s_waitcnt lgkmcnt(7)
    ds_read_b128 v[48:51], v3 offset:53248
    v_mfma_f32_16x16x32_bf16 a[16:19], v[60:63], a[128:131], a[16:19]
    v_mfma_f32_16x16x32_bf16 a[20:23], v[60:63], a[132:135], a[20:23]
    ds_read_b128 v[52:55], v3 offset:54272
    v_mfma_f32_16x16x32_bf16 a[24:27], v[64:67], a[128:131], a[24:27]
    v_mfma_f32_16x16x32_bf16 a[28:31], v[64:67], a[132:135], a[28:31]
    ds_read_b128 v[56:59], v3 offset:55296
    v_mfma_f32_16x16x32_bf16 a[16:19], v[68:71], a[136:139], a[16:19]
    s_add_u32 m0, s50, 8192
    s_add_u32 s56, s51, 7168
    buffer_load_dwordx4 v3, s[4:7], s56 offen lds
    v_mfma_f32_16x16x32_bf16 a[20:23], v[68:71], a[140:143], a[20:23]
    s_waitcnt lgkmcnt(7)
    ds_read_b128 v[60:63], v3 offset:56320
    v_mfma_f32_16x16x32_bf16 a[24:27], v[72:75], a[136:139], a[24:27]
    v_mfma_f32_16x16x32_bf16 a[28:31], v[72:75], a[140:143], a[28:31]
    ds_read_b128 v[64:67], v3 offset:57344
    v_mfma_f32_16x16x32_bf16 a[16:19], v[76:79], v[84:87], a[16:19]
    v_mfma_f32_16x16x32_bf16 a[20:23], v[76:79], v[88:91], a[20:23]
    ds_read_b128 v[68:71], v3 offset:58368
    v_mfma_f32_16x16x32_bf16 a[24:27], v[80:83], v[84:87], a[24:27]
    s_add_u32 m0, s53, 8192
    s_add_u32 s56, s52, 7168
    buffer_load_dwordx4 v3, s[4:7], s56 offen lds
    v_mfma_f32_16x16x32_bf16 a[28:31], v[80:83], v[88:91], a[28:31]
    s_waitcnt lgkmcnt(7)
    ds_read_b128 v[72:75], v3 offset:59392
    v_mfma_f32_16x16x32_bf16 a[16:19], v[32:35], v[92:95], a[16:19]
    v_mfma_f32_16x16x32_bf16 a[20:23], v[32:35], v[96:99], a[20:23]
    ds_read_b128 v[76:79], v3 offset:60416
    v_mfma_f32_16x16x32_bf16 a[24:27], v[36:39], v[92:95], a[24:27]
    v_mfma_f32_16x16x32_bf16 a[28:31], v[36:39], v[96:99], a[28:31]
    ds_read_b128 v[80:83], v3 offset:61440
    v_mfma_f32_16x16x32_bf16 a[16:19], v[40:43], v[100:103], a[16:19]
    s_add_u32 m0, s50, 16384
    s_add_u32 s56, s51, 14336
    buffer_load_dwordx4 v3, s[4:7], s56 offen lds
    v_mfma_f32_16x16x32_bf16 a[20:23], v[40:43], v[104:107], a[20:23]
    s_waitcnt lgkmcnt(7)
    ds_read_b128 v[32:35], v3 offset:62464
    v_mfma_f32_16x16x32_bf16 a[24:27], v[44:47], v[100:103], a[24:27]
    v_mfma_f32_16x16x32_bf16 a[28:31], v[44:47], v[104:107], a[28:31]
    ds_read_b128 v[36:39], v3 offset:63488
    v_mfma_f32_16x16x32_bf16 a[16:19], v[48:51], v[108:111], a[16:19]
    v_mfma_f32_16x16x32_bf16 a[20:23], v[48:51], v[112:115], a[20:23]
    ds_read_b128 v[40:43], v3 offset:64512
    v_mfma_f32_16x16x32_bf16 a[24:27], v[52:55], v[108:111], a[24:27]
    s_add_u32 m0, s53, 16384
    s_add_u32 s56, s52, 14336
    buffer_load_dwordx4 v3, s[4:7], s56 offen lds
    v_mfma_f32_16x16x32_bf16 a[28:31], v[52:55], v[112:115], a[28:31]
    s_waitcnt lgkmcnt(7)
    ds_read_b128 v[44:47], v4 offset:0
    v_mfma_f32_16x16x32_bf16 a[32:35], v[56:59], a[80:83], a[32:35]
    v_mfma_f32_16x16x32_bf16 a[36:39], v[56:59], a[84:87], a[36:39]
    ds_read_b128 v[48:51], v4 offset:1024
    v_mfma_f32_16x16x32_bf16 a[40:43], v[60:63], a[80:83], a[40:43]
    v_accvgpr_read_b32 v16, a16
    v_accvgpr_read_b32 v17, a17
    v_mfma_f32_16x16x32_bf16 a[44:47], v[60:63], a[84:87], a[44:47]
    ds_read_b128 v[52:55], v4 offset:2048
    v_accvgpr_read_b32 v18, a18
    v_accvgpr_read_b32 v19, a19
    v_mfma_f32_16x16x32_bf16 a[32:35], v[64:67], a[88:91], a[32:35]
    v_accvgpr_read_b32 v20, a24
    v_accvgpr_read_b32 v21, a25
    v_accvgpr_read_b32 v22, a26
    v_mfma_f32_16x16x32_bf16 a[36:39], v[64:67], a[92:95], a[36:39]
    s_waitcnt lgkmcnt(7)
    ds_read_b128 v[56:59], v4 offset:3072
    v_accvgpr_read_b32 v23, a27
    v_cvt_pk_bf16_f32 v172, v16, v17
    v_mfma_f32_16x16x32_bf16 a[40:43], v[68:71], a[88:91], a[40:43]
    v_cvt_pk_bf16_f32 v173, v18, v19
    v_cvt_pk_bf16_f32 v174, v20, v21
    v_mfma_f32_16x16x32_bf16 a[44:47], v[68:71], a[92:95], a[44:47]
    ds_read_b128 v[60:63], v4 offset:4096
    v_cvt_pk_bf16_f32 v175, v22, v23
    v_accvgpr_read_b32 v24, a20
    v_mfma_f32_16x16x32_bf16 a[32:35], v[72:75], a[96:99], a[32:35]
    buffer_store_dwordx4 v[172:175], v14, s[4:7], s28 offen offset:1024 sc1
    v_accvgpr_read_b32 v25, a21
    v_accvgpr_read_b32 v26, a22
    v_mfma_f32_16x16x32_bf16 a[36:39], v[72:75], a[100:103], a[36:39]
    ds_read_b128 v[64:67], v4 offset:5120
    v_accvgpr_read_b32 v27, a23
    v_accvgpr_read_b32 v28, a28
    v_mfma_f32_16x16x32_bf16 a[40:43], v[76:79], a[96:99], a[40:43]
    v_accvgpr_read_b32 v29, a29
    v_accvgpr_read_b32 v30, a30
    v_mfma_f32_16x16x32_bf16 a[44:47], v[76:79], a[100:103], a[44:47]
    s_waitcnt lgkmcnt(7)
    ds_read_b128 v[68:71], v4 offset:6144
    v_accvgpr_read_b32 v31, a31
    v_cvt_pk_bf16_f32 v176, v24, v25
    v_mfma_f32_16x16x32_bf16 a[32:35], v[80:83], a[104:107], a[32:35]
    v_cvt_pk_bf16_f32 v177, v26, v27
    v_cvt_pk_bf16_f32 v178, v28, v29
    v_cvt_pk_bf16_f32 v179, v30, v31
    v_mfma_f32_16x16x32_bf16 a[36:39], v[80:83], a[108:111], a[36:39]
    ds_read_b128 v[72:75], v4 offset:7168
    v_mfma_f32_16x16x32_bf16 a[40:43], v[32:35], a[104:107], a[40:43]
    buffer_store_dwordx4 v[176:179], v6, s[4:7], s28 offen offset:1024 sc1
    v_mfma_f32_16x16x32_bf16 a[44:47], v[32:35], a[108:111], a[44:47]
    s_barrier
    ds_read_b128 v[76:79], v4 offset:8192
    v_mfma_f32_16x16x32_bf16 a[32:35], v[36:39], a[112:115], a[32:35]
    s_add_u32 m0, s50, 24576
    s_add_u32 s56, s51, 21504
    buffer_load_dwordx4 v3, s[4:7], s56 offen lds
    v_mfma_f32_16x16x32_bf16 a[36:39], v[36:39], a[116:119], a[36:39]
    s_waitcnt lgkmcnt(7)
    ds_read_b128 v[80:83], v4 offset:9216
    v_mfma_f32_16x16x32_bf16 a[40:43], v[40:43], a[112:115], a[40:43]
    v_mfma_f32_16x16x32_bf16 a[44:47], v[40:43], a[116:119], a[44:47]
    ds_read_b128 v[32:35], v4 offset:10240
    v_mfma_f32_16x16x32_bf16 a[32:35], v[44:47], a[120:123], a[32:35]
    v_mfma_f32_16x16x32_bf16 a[36:39], v[44:47], a[124:127], a[36:39]
    ds_read_b128 v[36:39], v4 offset:11264
    v_mfma_f32_16x16x32_bf16 a[40:43], v[48:51], a[120:123], a[40:43]
    s_add_u32 m0, s53, 24576
    s_add_u32 s56, s52, 21504
    buffer_load_dwordx4 v3, s[4:7], s56 offen lds
    v_mfma_f32_16x16x32_bf16 a[44:47], v[48:51], a[124:127], a[44:47]
    s_waitcnt lgkmcnt(7)
    ds_read_b128 v[40:43], v4 offset:12288
    v_mfma_f32_16x16x32_bf16 a[32:35], v[52:55], a[128:131], a[32:35]
    v_mfma_f32_16x16x32_bf16 a[36:39], v[52:55], a[132:135], a[36:39]
    ds_read_b128 v[44:47], v4 offset:13312
    v_mfma_f32_16x16x32_bf16 a[40:43], v[56:59], a[128:131], a[40:43]
    v_mfma_f32_16x16x32_bf16 a[44:47], v[56:59], a[132:135], a[44:47]
    ds_read_b128 v[48:51], v4 offset:14336
    v_mfma_f32_16x16x32_bf16 a[32:35], v[60:63], a[136:139], a[32:35]
    s_add_u32 m0, s50, 32768
    s_add_u32 s56, s51, 28672
    buffer_load_dwordx4 v3, s[4:7], s56 offen lds
    v_mfma_f32_16x16x32_bf16 a[36:39], v[60:63], a[140:143], a[36:39]
    s_waitcnt lgkmcnt(7)
    ds_read_b128 v[52:55], v4 offset:15360
    v_mfma_f32_16x16x32_bf16 a[40:43], v[64:67], a[136:139], a[40:43]
    v_mfma_f32_16x16x32_bf16 a[44:47], v[64:67], a[140:143], a[44:47]
    ds_read_b128 v[56:59], v4 offset:16384
    v_mfma_f32_16x16x32_bf16 a[32:35], v[68:71], v[84:87], a[32:35]
    v_mfma_f32_16x16x32_bf16 a[36:39], v[68:71], v[88:91], a[36:39]
    ds_read_b128 v[60:63], v4 offset:17408
    v_mfma_f32_16x16x32_bf16 a[40:43], v[72:75], v[84:87], a[40:43]
    s_add_u32 m0, s53, 32768
    s_add_u32 s56, s52, 28672
    buffer_load_dwordx4 v3, s[4:7], s56 offen lds
    v_mfma_f32_16x16x32_bf16 a[44:47], v[72:75], v[88:91], a[44:47]
    s_waitcnt lgkmcnt(7)
    ds_read_b128 v[64:67], v4 offset:18432
    v_mfma_f32_16x16x32_bf16 a[32:35], v[76:79], v[92:95], a[32:35]
    v_mfma_f32_16x16x32_bf16 a[36:39], v[76:79], v[96:99], a[36:39]
    ds_read_b128 v[68:71], v4 offset:19456
    v_mfma_f32_16x16x32_bf16 a[40:43], v[80:83], v[92:95], a[40:43]
    v_mfma_f32_16x16x32_bf16 a[44:47], v[80:83], v[96:99], a[44:47]
    ds_read_b128 v[72:75], v4 offset:20480
    v_mfma_f32_16x16x32_bf16 a[32:35], v[32:35], v[100:103], a[32:35]
    s_add_u32 m0, s50, 40960
    s_add_u32 s56, s51, 35840
    buffer_load_dwordx4 v3, s[4:7], s56 offen lds
    v_mfma_f32_16x16x32_bf16 a[36:39], v[32:35], v[104:107], a[36:39]
    s_waitcnt lgkmcnt(7)
    ds_read_b128 v[76:79], v4 offset:21504
    v_mfma_f32_16x16x32_bf16 a[40:43], v[36:39], v[100:103], a[40:43]
    v_mfma_f32_16x16x32_bf16 a[44:47], v[36:39], v[104:107], a[44:47]
    ds_read_b128 v[80:83], v4 offset:22528
    v_mfma_f32_16x16x32_bf16 a[32:35], v[40:43], v[108:111], a[32:35]
    v_mfma_f32_16x16x32_bf16 a[36:39], v[40:43], v[112:115], a[36:39]
    ds_read_b128 v[32:35], v4 offset:23552
    v_mfma_f32_16x16x32_bf16 a[40:43], v[44:47], v[108:111], a[40:43]
    s_add_u32 m0, s53, 40960
    s_add_u32 s56, s52, 35840
    buffer_load_dwordx4 v3, s[4:7], s56 offen lds
    v_mfma_f32_16x16x32_bf16 a[44:47], v[44:47], v[112:115], a[44:47]
    s_waitcnt lgkmcnt(7)
    ds_read_b128 v[36:39], v4 offset:24576
    v_mfma_f32_16x16x32_bf16 a[48:51], v[48:51], a[80:83], a[48:51]
    v_mfma_f32_16x16x32_bf16 a[52:55], v[48:51], a[84:87], a[52:55]
    ds_read_b128 v[40:43], v4 offset:25600
    v_mfma_f32_16x16x32_bf16 a[56:59], v[52:55], a[80:83], a[56:59]
    v_accvgpr_read_b32 v16, a32
    v_accvgpr_read_b32 v17, a33
    v_mfma_f32_16x16x32_bf16 a[60:63], v[52:55], a[84:87], a[60:63]
    ds_read_b128 v[44:47], v4 offset:26624
    v_accvgpr_read_b32 v18, a34
    v_accvgpr_read_b32 v19, a35
    v_mfma_f32_16x16x32_bf16 a[48:51], v[56:59], a[88:91], a[48:51]
    v_accvgpr_read_b32 v20, a40
    v_accvgpr_read_b32 v21, a41
    v_accvgpr_read_b32 v22, a42
    v_mfma_f32_16x16x32_bf16 a[52:55], v[56:59], a[92:95], a[52:55]
    s_waitcnt lgkmcnt(7)
    ds_read_b128 v[48:51], v4 offset:27648
    v_accvgpr_read_b32 v23, a43
    v_cvt_pk_bf16_f32 v180, v16, v17
    v_mfma_f32_16x16x32_bf16 a[56:59], v[60:63], a[88:91], a[56:59]
    v_cvt_pk_bf16_f32 v181, v18, v19
    v_cvt_pk_bf16_f32 v182, v20, v21
    v_mfma_f32_16x16x32_bf16 a[60:63], v[60:63], a[92:95], a[60:63]
    ds_read_b128 v[52:55], v4 offset:28672
    v_cvt_pk_bf16_f32 v183, v22, v23
    v_accvgpr_read_b32 v24, a36
    v_mfma_f32_16x16x32_bf16 a[48:51], v[64:67], a[96:99], a[48:51]
    buffer_store_dwordx4 v[180:183], v14, s[4:7], s28 offen offset:2048 sc1
    v_accvgpr_read_b32 v25, a37
    v_accvgpr_read_b32 v26, a38
    v_mfma_f32_16x16x32_bf16 a[52:55], v[64:67], a[100:103], a[52:55]
    ds_read_b128 v[56:59], v4 offset:29696
    v_accvgpr_read_b32 v27, a39
    v_accvgpr_read_b32 v28, a44
    v_mfma_f32_16x16x32_bf16 a[56:59], v[68:71], a[96:99], a[56:59]
    v_accvgpr_read_b32 v29, a45
    v_accvgpr_read_b32 v30, a46
    v_mfma_f32_16x16x32_bf16 a[60:63], v[68:71], a[100:103], a[60:63]
    s_waitcnt lgkmcnt(7)
    ds_read_b128 v[60:63], v4 offset:30720
    v_accvgpr_read_b32 v31, a47
    v_cvt_pk_bf16_f32 v184, v24, v25
    v_mfma_f32_16x16x32_bf16 a[48:51], v[72:75], a[104:107], a[48:51]
    v_cvt_pk_bf16_f32 v185, v26, v27
    v_cvt_pk_bf16_f32 v186, v28, v29
    v_cvt_pk_bf16_f32 v187, v30, v31
    v_mfma_f32_16x16x32_bf16 a[52:55], v[72:75], a[108:111], a[52:55]
    ds_read_b128 v[64:67], v4 offset:31744
    v_mfma_f32_16x16x32_bf16 a[56:59], v[76:79], a[104:107], a[56:59]
    buffer_store_dwordx4 v[184:187], v6, s[4:7], s28 offen offset:2048 sc1
    v_mfma_f32_16x16x32_bf16 a[60:63], v[76:79], a[108:111], a[60:63]
    s_barrier
    ds_read_b128 v[68:71], v4 offset:32768
    v_mfma_f32_16x16x32_bf16 a[48:51], v[80:83], a[112:115], a[48:51]
    s_add_u32 m0, s50, 49152
    s_add_u32 s56, s51, 43008
    buffer_load_dwordx4 v3, s[4:7], s56 offen lds
    v_mfma_f32_16x16x32_bf16 a[52:55], v[80:83], a[116:119], a[52:55]
    s_waitcnt lgkmcnt(7)
    ds_read_b128 v[72:75], v4 offset:33792
    v_mfma_f32_16x16x32_bf16 a[56:59], v[32:35], a[112:115], a[56:59]
    v_mfma_f32_16x16x32_bf16 a[60:63], v[32:35], a[116:119], a[60:63]
    ds_read_b128 v[76:79], v4 offset:34816
    v_mfma_f32_16x16x32_bf16 a[48:51], v[36:39], a[120:123], a[48:51]
    v_mfma_f32_16x16x32_bf16 a[52:55], v[36:39], a[124:127], a[52:55]
    ds_read_b128 v[80:83], v4 offset:35840
    v_mfma_f32_16x16x32_bf16 a[56:59], v[40:43], a[120:123], a[56:59]
    s_add_u32 m0, s53, 49152
    s_add_u32 s56, s52, 43008
    buffer_load_dwordx4 v3, s[4:7], s56 offen lds
    v_mfma_f32_16x16x32_bf16 a[60:63], v[40:43], a[124:127], a[60:63]
    s_waitcnt lgkmcnt(7)
    ds_read_b128 v[32:35], v4 offset:36864
    v_mfma_f32_16x16x32_bf16 a[48:51], v[44:47], a[128:131], a[48:51]
    v_mfma_f32_16x16x32_bf16 a[52:55], v[44:47], a[132:135], a[52:55]
    ds_read_b128 v[36:39], v4 offset:37888
    v_mfma_f32_16x16x32_bf16 a[56:59], v[48:51], a[128:131], a[56:59]
    v_mfma_f32_16x16x32_bf16 a[60:63], v[48:51], a[132:135], a[60:63]
    ds_read_b128 v[40:43], v4 offset:38912
    v_mfma_f32_16x16x32_bf16 a[48:51], v[52:55], a[136:139], a[48:51]
    s_add_u32 m0, s50, 57344
    s_add_u32 s56, s51, 50176
    buffer_load_dwordx4 v3, s[4:7], s56 offen lds
    v_mfma_f32_16x16x32_bf16 a[52:55], v[52:55], a[140:143], a[52:55]
    s_waitcnt lgkmcnt(7)
    ds_read_b128 v[44:47], v4 offset:39936
    v_mfma_f32_16x16x32_bf16 a[56:59], v[56:59], a[136:139], a[56:59]
    v_mfma_f32_16x16x32_bf16 a[60:63], v[56:59], a[140:143], a[60:63]
    ds_read_b128 v[48:51], v4 offset:40960
    v_mfma_f32_16x16x32_bf16 a[48:51], v[60:63], v[84:87], a[48:51]
    v_mfma_f32_16x16x32_bf16 a[52:55], v[60:63], v[88:91], a[52:55]
    ds_read_b128 v[52:55], v4 offset:41984
    v_mfma_f32_16x16x32_bf16 a[56:59], v[64:67], v[84:87], a[56:59]
    s_add_u32 m0, s53, 57344
    s_add_u32 s56, s52, 50176
    buffer_load_dwordx4 v3, s[4:7], s56 offen lds
    v_mfma_f32_16x16x32_bf16 a[60:63], v[64:67], v[88:91], a[60:63]
    s_waitcnt lgkmcnt(7)
    ds_read_b128 v[56:59], v4 offset:43008
    v_mfma_f32_16x16x32_bf16 a[48:51], v[68:71], v[92:95], a[48:51]
    v_mfma_f32_16x16x32_bf16 a[52:55], v[68:71], v[96:99], a[52:55]
    ds_read_b128 v[60:63], v4 offset:44032
    v_mfma_f32_16x16x32_bf16 a[56:59], v[72:75], v[92:95], a[56:59]
    v_mfma_f32_16x16x32_bf16 a[60:63], v[72:75], v[96:99], a[60:63]
    ds_read_b128 v[64:67], v4 offset:45056
    v_mfma_f32_16x16x32_bf16 a[48:51], v[76:79], v[100:103], a[48:51]
    s_add_u32 m0, s50, 65536
    s_add_u32 s56, s51, 57344
    buffer_load_dwordx4 v3, s[4:7], s56 offen lds
    v_mfma_f32_16x16x32_bf16 a[52:55], v[76:79], v[104:107], a[52:55]
    s_waitcnt lgkmcnt(7)
    ds_read_b128 v[68:71], v4 offset:46080
    v_mfma_f32_16x16x32_bf16 a[56:59], v[80:83], v[100:103], a[56:59]
    v_mfma_f32_16x16x32_bf16 a[60:63], v[80:83], v[104:107], a[60:63]
    ds_read_b128 v[72:75], v4 offset:47104
    v_mfma_f32_16x16x32_bf16 a[48:51], v[32:35], v[108:111], a[48:51]
    v_mfma_f32_16x16x32_bf16 a[52:55], v[32:35], v[112:115], a[52:55]
    ds_read_b128 v[76:79], v4 offset:48128
    v_mfma_f32_16x16x32_bf16 a[56:59], v[36:39], v[108:111], a[56:59]
    s_add_u32 m0, s53, 65536
    s_add_u32 s56, s52, 57344
    buffer_load_dwordx4 v3, s[4:7], s56 offen lds
    v_mfma_f32_16x16x32_bf16 a[60:63], v[36:39], v[112:115], a[60:63]
    s_waitcnt lgkmcnt(7)
    ds_read_b128 v[80:83], v4 offset:49152
    v_mfma_f32_16x16x32_bf16 a[64:67], v[40:43], a[80:83], a[64:67]
    ds_read_b128 v[32:35], v4 offset:50176
    v_mfma_f32_16x16x32_bf16 a[68:71], v[44:47], a[80:83], a[68:71]
    ds_read_b128 v[36:39], v4 offset:51200
    v_accvgpr_read_b32 v16, a48
    v_mfma_f32_16x16x32_bf16 a[64:67], v[48:51], a[88:91], a[64:67]
    s_waitcnt lgkmcnt(7)
    ds_read_b128 v[40:43], v4 offset:52224
    v_accvgpr_read_b32 v17, a49
    v_accvgpr_read_b32 v18, a50
    v_mfma_f32_16x16x32_bf16 a[68:71], v[52:55], a[88:91], a[68:71]
    ds_read_b128 v[44:47], v4 offset:53248
    v_accvgpr_read_b32 v19, a51
    v_accvgpr_read_b32 v20, a56
    v_mfma_f32_16x16x32_bf16 a[64:67], v[56:59], a[96:99], a[64:67]
    ds_read_b128 v[48:51], v4 offset:54272
    v_accvgpr_read_b32 v21, a57
    v_accvgpr_read_b32 v22, a58
    v_mfma_f32_16x16x32_bf16 a[68:71], v[60:63], a[96:99], a[68:71]
    s_waitcnt lgkmcnt(7)
    ds_read_b128 v[52:55], v4 offset:55296
    v_accvgpr_read_b32 v23, a59
    v_mfma_f32_16x16x32_bf16 a[64:67], v[64:67], a[104:107], a[64:67]
    ds_read_b128 v[56:59], v4 offset:56320
    v_cvt_pk_bf16_f32 v188, v16, v17
    v_cvt_pk_bf16_f32 v189, v18, v19
    v_mfma_f32_16x16x32_bf16 a[68:71], v[68:71], a[104:107], a[68:71]
    s_waitcnt vmcnt(24)
    s_barrier
    ds_read_b128 v[60:63], v4 offset:57344
    s_add_u32 m0, s50, 73728
    s_add_u32 s56, s51, 64512
    buffer_load_dwordx4 v3, s[4:7], s56 offen lds
    v_cvt_pk_bf16_f32 v190, v20, v21
    v_mfma_f32_16x16x32_bf16 a[64:67], v[72:75], a[112:115], a[64:67]
    s_waitcnt lgkmcnt(7)
    ds_read_b128 v[64:67], v4 offset:58368
    v_cvt_pk_bf16_f32 v191, v22, v23
    v_accvgpr_read_b32 v24, a52
    v_mfma_f32_16x16x32_bf16 a[68:71], v[76:79], a[112:115], a[68:71]
    ds_read_b128 v[68:71], v4 offset:59392
    buffer_store_dwordx4 v[188:191], v14, s[4:7], s28 offen offset:3072 sc1
    v_mfma_f32_16x16x32_bf16 a[64:67], v[80:83], a[120:123], a[64:67]
    ds_read_b128 v[72:75], v4 offset:60416
    s_add_u32 m0, s53, 73728
    s_add_u32 s56, s52, 64512
    buffer_load_dwordx4 v3, s[4:7], s56 offen lds
    v_accvgpr_read_b32 v25, a53
    v_mfma_f32_16x16x32_bf16 a[68:71], v[32:35], a[120:123], a[68:71]
    s_waitcnt lgkmcnt(7)
    ds_read_b128 v[76:79], v4 offset:61440
    v_accvgpr_read_b32 v26, a54
    v_accvgpr_read_b32 v27, a55
    v_mfma_f32_16x16x32_bf16 a[64:67], v[36:39], a[128:131], a[64:67]
    ds_read_b128 v[80:83], v4 offset:62464
    v_accvgpr_read_b32 v28, a60
    v_accvgpr_read_b32 v29, a61
    v_mfma_f32_16x16x32_bf16 a[68:71], v[40:43], a[128:131], a[68:71]
    s_add_u32 m0, s50, 81920
    s_add_u32 s56, s51, 71680
    buffer_load_dwordx4 v3, s[4:7], s56 offen lds
    v_accvgpr_read_b32 v30, a62
    v_mfma_f32_16x16x32_bf16 a[64:67], v[44:47], a[136:139], a[64:67]
    s_waitcnt lgkmcnt(6)
    v_accvgpr_read_b32 v31, a63
    v_cvt_pk_bf16_f32 v192, v24, v25
    v_cvt_pk_bf16_f32 v193, v26, v27
    v_mfma_f32_16x16x32_bf16 a[68:71], v[48:51], a[136:139], a[68:71]
    v_cvt_pk_bf16_f32 v194, v28, v29
    v_cvt_pk_bf16_f32 v195, v30, v31
    v_mfma_f32_16x16x32_bf16 a[64:67], v[52:55], v[84:87], a[64:67]
    buffer_store_dwordx4 v[192:195], v6, s[4:7], s28 offen offset:3072 sc1
    v_mfma_f32_16x16x32_bf16 a[68:71], v[56:59], v[84:87], a[68:71]
    s_waitcnt lgkmcnt(3)
    s_add_u32 m0, s53, 81920
    s_add_u32 s56, s52, 71680
    buffer_load_dwordx4 v3, s[4:7], s56 offen lds
    v_mfma_f32_16x16x32_bf16 a[64:67], v[60:63], v[92:95], a[64:67]
    v_mfma_f32_16x16x32_bf16 a[68:71], v[64:67], v[92:95], a[68:71]
    v_mfma_f32_16x16x32_bf16 a[64:67], v[68:71], v[100:103], a[64:67]
    s_waitcnt lgkmcnt(0)
    s_add_u32 m0, s50, 90112
    s_add_u32 s56, s51, 78848
    buffer_load_dwordx4 v3, s[4:7], s56 offen lds
    v_mfma_f32_16x16x32_bf16 a[68:71], v[72:75], v[100:103], a[68:71]
    v_mfma_f32_16x16x32_bf16 a[64:67], v[76:79], v[108:111], a[64:67]
    v_mfma_f32_16x16x32_bf16 a[68:71], v[80:83], v[108:111], a[68:71]
    s_add_u32 m0, s53, 90112
    s_add_u32 s56, s52, 78848
    buffer_load_dwordx4 v3, s[4:7], s56 offen lds
    s_nop 3
    v_accvgpr_read_b32 v16, a64
    v_accvgpr_read_b32 v17, a65
    v_accvgpr_read_b32 v18, a66
    v_accvgpr_read_b32 v19, a67
    v_accvgpr_read_b32 v20, a68
    v_accvgpr_read_b32 v21, a69
    v_accvgpr_read_b32 v22, a70
    v_accvgpr_read_b32 v23, a71
    v_cvt_pk_bf16_f32 v196, v16, v17
    v_cvt_pk_bf16_f32 v197, v18, v19
    v_cvt_pk_bf16_f32 v198, v20, v21
    v_cvt_pk_bf16_f32 v199, v22, v23
    buffer_store_dwordx4 v[196:199], v14, s[4:7], s36 offen sc1
    s_mov_b32 s30, 0
    v_cmp_eq_u32 vcc, 0, v1
    s_nop 1
    v_cndmask_b32 v252, 0, 1, vcc
    v_mov_b32 v255, 48
    v_sub_u32 v253, v255, v252
    s_waitcnt vmcnt(0)
    s_barrier
    s_cmp_lg_u32 s3, 0
    s_cbranch_scc1 main_kernel_sa2
    s_mov_b64 exec, 1
    buffer_atomic_add v252, v254, s[4:7], s11 offen
    s_mov_b64 exec, -1
main_kernel_sa2:
    s_load_dwordx4 s[36:39], s[0:1], 56
    v_and_b32 v4, 15, v1
    v_lshrrev_b32 v5, 4, v1
    s_lshl_b32 s12, s8, 4
    s_add_u32 s12, s12, s9
    s_mul_i32 s12, s12, 9
    s_add_u32 s12, s12, s3
    s_lshl_b32 s12, s12, 10
    s_add_u32 s13, s12, 4096
    s_add_u32 s14, s12, 8192
    s_cmp_lg_u32 s3, 0
    s_cselect_b32 s14, 268435456, s14
    s_and_b32 s15, s9, 1
    s_mul_i32 s16, s15, 9
    s_add_u32 s16, s16, s3
    s_lshl_b32 s16, s16, 6
    s_add_u32 s17, s16, 512
    s_cmp_lg_u32 s3, 0
    s_cselect_b32 s17, 268435456, s17
    v_lshlrev_b32 v6, 3, v5
    s_waitcnt lgkmcnt(0)
    s_mov_b32 s40, s36
    s_and_b32 s41, s37, 0xffff
    s_mov_b32 s42, 1152
    s_mov_b32 s43, 0x00020000
    s_add_u32 s20, s12, 7241728
    s_add_u32 s21, s13, 7241728
    s_add_u32 s22, s14, 7241728
    s_add_u32 s18, s12, 4816896
    buffer_load_dwordx4 v[160:163], v3, s[4:7], s18 offen sc1
    s_add_u32 s18, s13, 4816896
    buffer_load_dwordx4 v[164:167], v3, s[4:7], s18 offen sc1
    s_add_u32 s18, s14, 4816896
    buffer_load_dwordx4 v[168:171], v3, s[4:7], s18 offen sc1
    buffer_load_dwordx2 v[172:173], v6, s[40:43], s16 offen offset:0
    buffer_load_dwordx2 v[174:175], v6, s[40:43], s16 offen offset:32
    buffer_load_dwordx2 v[176:177], v6, s[40:43], s16 offen offset:256
    buffer_load_dwordx2 v[178:179], v6, s[40:43], s16 offen offset:288
    buffer_load_dwordx2 v[180:181], v6, s[40:43], s17 offen offset:0
    buffer_load_dwordx2 v[182:183], v6, s[40:43], s17 offen offset:32
    s_cmp_lg_u32 s3, 0
    s_cbranch_scc1 main_kernel_sb2
    s_mov_b64 exec, 1
main_kernel_sp2:
    buffer_load_dword v252, v254, s[4:7], s11 offen sc1
    s_add_u32 s57, s57, 1
    s_waitcnt vmcnt(0)
    v_cmp_gt_u32 vcc, v255, v252
    s_nop 4
    s_cbranch_vccz main_kernel_sq2
    s_cmp_lt_u32 s57, 0x40000
    s_cbranch_scc1 main_kernel_sp2
main_kernel_sq2:
    s_mov_b64 exec, -1
main_kernel_sb2:
    s_waitcnt vmcnt(0) lgkmcnt(0)
    s_barrier
    s_cmp_ge_u32 s30, 16
    s_cbranch_scc1 main_kernel_e2
    s_add_u32 s20, s12, 7241728
    buffer_load_dwordx4 v[196:199], v3, s[4:7], s20 offen sc1
    s_add_u32 s20, s20, 2359296
    buffer_load_dwordx4 v[200:203], v3, s[4:7], s20 offen sc1
    s_add_u32 s20, s20, 2359296
    buffer_load_dwordx4 v[204:207], v3, s[4:7], s20 offen sc1
    s_add_u32 s20, s20, 2359296
    buffer_load_dwordx4 v[208:211], v3, s[4:7], s20 offen sc1
main_kernel_e2:
    buffer_load_dwordx4 v[64:67], v3, s[4:7], s21 offen sc1
    s_add_u32 s21, s21, 2359296
    buffer_load_dwordx4 v[68:71], v3, s[4:7], s22 offen sc1
    s_add_u32 s22, s22, 2359296
    buffer_load_dwordx4 v[72:75], v3, s[4:7], s21 offen sc1
    s_add_u32 s21, s21, 2359296
    buffer_load_dwordx4 v[76:79], v3, s[4:7], s22 offen sc1
    s_add_u32 s22, s22, 2359296
    buffer_load_dwordx4 v[80:83], v3, s[4:7], s21 offen sc1
    s_add_u32 s21, s21, 2359296
    buffer_load_dwordx4 v[84:87], v3, s[4:7], s22 offen sc1
    s_add_u32 s22, s22, 2359296
    buffer_load_dwordx4 v[88:91], v3, s[4:7], s21 offen sc1
    buffer_load_dwordx4 v[92:95], v3, s[4:7], s22 offen sc1
    v_mov_b32 v6, 0x00003f80
    v_mov_b32 v7, 0x3f800000
    v_lshlrev_b32 v16, 16, v172
    v_and_b32 v17, 0xffff0000, v172
    v_lshlrev_b32 v18, 16, v173
    v_and_b32 v19, 0xffff0000, v173
    v_lshlrev_b32 v20, 16, v174
    v_and_b32 v21, 0xffff0000, v174
    v_lshlrev_b32 v22, 16, v175
    v_and_b32 v23, 0xffff0000, v175
    v_lshlrev_b32 v24, 16, v176
    v_and_b32 v25, 0xffff0000, v176
    v_lshlrev_b32 v26, 16, v177
    v_and_b32 v27, 0xffff0000, v177
    v_lshlrev_b32 v28, 16, v178
    v_and_b32 v29, 0xffff0000, v178
    v_lshlrev_b32 v30, 16, v179
    v_and_b32 v31, 0xffff0000, v179
    v_lshlrev_b32 v32, 16, v180
    v_and_b32 v33, 0xffff0000, v180
    v_lshlrev_b32 v34, 16, v181
    v_and_b32 v35, 0xffff0000, v181
    v_lshlrev_b32 v36, 16, v182
    v_and_b32 v37, 0xffff0000, v182
    v_lshlrev_b32 v38, 16, v183
    v_and_b32 v39, 0xffff0000, v183
    v_dot2c_f32_bf16 v16, v160, v6
    v_dot2c_f32_bf16 v17, v160, v7
    v_dot2c_f32_bf16 v18, v161, v6
    v_dot2c_f32_bf16 v19, v161, v7
    v_dot2c_f32_bf16 v20, v162, v6
    v_dot2c_f32_bf16 v21, v162, v7
    v_dot2c_f32_bf16 v22, v163, v6
    v_dot2c_f32_bf16 v23, v163, v7
    v_dot2c_f32_bf16 v24, v164, v6
    v_dot2c_f32_bf16 v25, v164, v7
    v_dot2c_f32_bf16 v26, v165, v6
    v_dot2c_f32_bf16 v27, v165, v7
    v_dot2c_f32_bf16 v28, v166, v6
    v_dot2c_f32_bf16 v29, v166, v7
    v_dot2c_f32_bf16 v30, v167, v6
    v_dot2c_f32_bf16 v31, v167, v7
    v_dot2c_f32_bf16 v32, v168, v6
    v_dot2c_f32_bf16 v33, v168, v7
    v_dot2c_f32_bf16 v34, v169, v6
    v_dot2c_f32_bf16 v35, v169, v7
    v_dot2c_f32_bf16 v36, v170, v6
    v_dot2c_f32_bf16 v37, v170, v7
    v_dot2c_f32_bf16 v38, v171, v6
    v_dot2c_f32_bf16 v39, v171, v7
    s_waitcnt vmcnt(8)
    v_dot2c_f32_bf16 v16, v196, v6
    v_dot2c_f32_bf16 v17, v196, v7
    v_dot2c_f32_bf16 v18, v197, v6
    v_dot2c_f32_bf16 v19, v197, v7
    v_dot2c_f32_bf16 v20, v198, v6
    v_dot2c_f32_bf16 v21, v198, v7
    v_dot2c_f32_bf16 v22, v199, v6
    v_dot2c_f32_bf16 v23, v199, v7
    v_dot2c_f32_bf16 v16, v200, v6
    v_dot2c_f32_bf16 v17, v200, v7
    v_dot2c_f32_bf16 v18, v201, v6
    v_dot2c_f32_bf16 v19, v201, v7
    v_dot2c_f32_bf16 v20, v202, v6
    v_dot2c_f32_bf16 v21, v202, v7
    v_dot2c_f32_bf16 v22, v203, v6
    v_dot2c_f32_bf16 v23, v203, v7
    v_dot2c_f32_bf16 v16, v204, v6
    v_dot2c_f32_bf16 v17, v204, v7
    v_dot2c_f32_bf16 v18, v205, v6
    v_dot2c_f32_bf16 v19, v205, v7
    v_dot2c_f32_bf16 v20, v206, v6
    v_dot2c_f32_bf16 v21, v206, v7
    v_dot2c_f32_bf16 v22, v207, v6
    v_dot2c_f32_bf16 v23, v207, v7
    v_dot2c_f32_bf16 v16, v208, v6
    v_dot2c_f32_bf16 v17, v208, v7
    v_dot2c_f32_bf16 v18, v209, v6
    v_dot2c_f32_bf16 v19, v209, v7
    v_dot2c_f32_bf16 v20, v210, v6
    v_dot2c_f32_bf16 v21, v210, v7
    v_dot2c_f32_bf16 v22, v211, v6
    v_dot2c_f32_bf16 v23, v211, v7
    s_waitcnt vmcnt(6)
    v_dot2c_f32_bf16 v24, v64, v6
    v_dot2c_f32_bf16 v25, v64, v7
    v_dot2c_f32_bf16 v26, v65, v6
    v_dot2c_f32_bf16 v27, v65, v7
    v_dot2c_f32_bf16 v28, v66, v6
    v_dot2c_f32_bf16 v29, v66, v7
    v_dot2c_f32_bf16 v30, v67, v6
    v_dot2c_f32_bf16 v31, v67, v7
    v_dot2c_f32_bf16 v32, v68, v6
    v_dot2c_f32_bf16 v33, v68, v7
    v_dot2c_f32_bf16 v34, v69, v6
    v_dot2c_f32_bf16 v35, v69, v7
    v_dot2c_f32_bf16 v36, v70, v6
    v_dot2c_f32_bf16 v37, v70, v7
    v_dot2c_f32_bf16 v38, v71, v6
    v_dot2c_f32_bf16 v39, v71, v7
    s_waitcnt vmcnt(4)
    v_dot2c_f32_bf16 v24, v72, v6
    v_dot2c_f32_bf16 v25, v72, v7
    v_dot2c_f32_bf16 v26, v73, v6
    v_dot2c_f32_bf16 v27, v73, v7
    v_dot2c_f32_bf16 v28, v74, v6
    v_dot2c_f32_bf16 v29, v74, v7
    v_dot2c_f32_bf16 v30, v75, v6
    v_dot2c_f32_bf16 v31, v75, v7
    v_dot2c_f32_bf16 v32, v76, v6
    v_dot2c_f32_bf16 v33, v76, v7
    v_dot2c_f32_bf16 v34, v77, v6
    v_dot2c_f32_bf16 v35, v77, v7
    v_dot2c_f32_bf16 v36, v78, v6
    v_dot2c_f32_bf16 v37, v78, v7
    v_dot2c_f32_bf16 v38, v79, v6
    v_dot2c_f32_bf16 v39, v79, v7
    s_waitcnt vmcnt(2)
    v_dot2c_f32_bf16 v24, v80, v6
    v_dot2c_f32_bf16 v25, v80, v7
    v_dot2c_f32_bf16 v26, v81, v6
    v_dot2c_f32_bf16 v27, v81, v7
    v_dot2c_f32_bf16 v28, v82, v6
    v_dot2c_f32_bf16 v29, v82, v7
    v_dot2c_f32_bf16 v30, v83, v6
    v_dot2c_f32_bf16 v31, v83, v7
    v_dot2c_f32_bf16 v32, v84, v6
    v_dot2c_f32_bf16 v33, v84, v7
    v_dot2c_f32_bf16 v34, v85, v6
    v_dot2c_f32_bf16 v35, v85, v7
    v_dot2c_f32_bf16 v36, v86, v6
    v_dot2c_f32_bf16 v37, v86, v7
    v_dot2c_f32_bf16 v38, v87, v6
    v_dot2c_f32_bf16 v39, v87, v7
    s_waitcnt vmcnt(0)
    v_dot2c_f32_bf16 v24, v88, v6
    v_dot2c_f32_bf16 v25, v88, v7
    v_dot2c_f32_bf16 v26, v89, v6
    v_dot2c_f32_bf16 v27, v89, v7
    v_dot2c_f32_bf16 v28, v90, v6
    v_dot2c_f32_bf16 v29, v90, v7
    v_dot2c_f32_bf16 v30, v91, v6
    v_dot2c_f32_bf16 v31, v91, v7
    v_dot2c_f32_bf16 v32, v92, v6
    v_dot2c_f32_bf16 v33, v92, v7
    v_dot2c_f32_bf16 v34, v93, v6
    v_dot2c_f32_bf16 v35, v93, v7
    v_dot2c_f32_bf16 v36, v94, v6
    v_dot2c_f32_bf16 v37, v94, v7
    v_dot2c_f32_bf16 v38, v95, v6
    v_dot2c_f32_bf16 v39, v95, v7
    v_cvt_pk_bf16_f32 v40, v16, v17
    v_cvt_pk_bf16_f32 v41, v18, v19
    v_cvt_pk_bf16_f32 v42, v20, v21
    v_cvt_pk_bf16_f32 v43, v22, v23
    v_cvt_pk_bf16_f32 v44, v24, v25
    v_cvt_pk_bf16_f32 v45, v26, v27
    v_cvt_pk_bf16_f32 v46, v28, v29
    v_cvt_pk_bf16_f32 v47, v30, v31
    v_cvt_pk_bf16_f32 v48, v32, v33
    v_cvt_pk_bf16_f32 v49, v34, v35
    v_cvt_pk_bf16_f32 v50, v36, v37
    v_cvt_pk_bf16_f32 v51, v38, v39
    s_cmp_lg_u32 s59, 0
    s_nop 1
    s_cbranch_scc1 main_kernel_fin
    s_add_u32 s18, s12, 45023232
    buffer_store_dwordx4 v[40:43], v3, s[4:7], s18 offen sc1
    s_add_u32 s18, s13, 45023232
    buffer_store_dwordx4 v[44:47], v3, s[4:7], s18 offen sc1
    s_add_u32 s18, s14, 45023232
    buffer_store_dwordx4 v[48:51], v3, s[4:7], s18 offen sc1
    v_add_f32 v56, v16, v17
    v_mul_f32 v57, v16, v16
    v_fmac_f32 v57, v17, v17
    v_add_f32 v56, v56, v18
    v_fmac_f32 v57, v18, v18
    v_add_f32 v56, v56, v19
    v_fmac_f32 v57, v19, v19
    v_add_f32 v56, v56, v20
    v_fmac_f32 v57, v20, v20
    v_add_f32 v56, v56, v21
    v_fmac_f32 v57, v21, v21
    v_add_f32 v56, v56, v22
    v_fmac_f32 v57, v22, v22
    v_add_f32 v56, v56, v23
    v_fmac_f32 v57, v23, v23
    v_add_f32 v56, v56, v24
    v_fmac_f32 v57, v24, v24
    v_add_f32 v56, v56, v25
    v_fmac_f32 v57, v25, v25
    v_add_f32 v56, v56, v26
    v_fmac_f32 v57, v26, v26
    v_add_f32 v56, v56, v27
    v_fmac_f32 v57, v27, v27
    v_add_f32 v58, v28, v29
    v_mul_f32 v59, v28, v28
    v_fmac_f32 v59, v29, v29
    v_add_f32 v58, v58, v30
    v_fmac_f32 v59, v30, v30
    v_add_f32 v58, v58, v31
    v_fmac_f32 v59, v31, v31
    v_add_f32 v58, v58, v32
    v_fmac_f32 v59, v32, v32
    v_add_f32 v58, v58, v33
    v_fmac_f32 v59, v33, v33
    v_add_f32 v58, v58, v34
    v_fmac_f32 v59, v34, v34
    v_add_f32 v58, v58, v35
    v_fmac_f32 v59, v35, v35
    v_add_f32 v58, v58, v36
    v_fmac_f32 v59, v36, v36
    v_add_f32 v58, v58, v37
    v_fmac_f32 v59, v37, v37
    v_add_f32 v58, v58, v38
    v_fmac_f32 v59, v38, v38
    v_add_f32 v58, v58, v39
    v_fmac_f32 v59, v39, v39
    v_add_f32 v56, v56, v58
    v_add_f32 v57, v57, v59
    v_lshlrev_b32 v58, 3, v0
    v_add_u32 v58, 147456, v58
    ds_write_b64 v58, v[56:57]
    v_lshlrev_b32 v58, 3, v1
    v_add_u32 v58, 147456, v58
    v_lshlrev_b32 v59, 3, v4
    v_lshl_add_u32 v59, v5, 6, v59
    v_and_b32 v60, 1, v5
    v_lshl_add_u32 v59, v60, 30, v59
    s_lshl_b32 s20, s8, 3
    s_lshr_b32 s21, s9, 1
    s_add_u32 s20, s20, s21
    s_lshl_b32 s20, s20, 9
    s_lshl_b32 s21, s15, 8
    s_add_u32 s20, s20, s21
    s_add_u32 s20, s20, 47382528
    s_cmp_lg_u32 s3, 0
    s_cselect_b32 s20, 268435456, s20
    s_waitcnt lgkmcnt(0)
    s_barrier
    ds_read_b64 v[64:65], v58 offset:0
    ds_read_b64 v[66:67], v58 offset:512
    ds_read_b64 v[68:69], v58 offset:1024
    ds_read_b64 v[70:71], v58 offset:1536
    s_waitcnt lgkmcnt(0)
    v_add_f32 v64, v64, v66
    v_add_f32 v68, v68, v70
    v_add_f32 v65, v65, v67
    v_add_f32 v69, v69, v71
    v_add_f32 v64, v64, v68
    v_add_f32 v65, v65, v69
    v_mov_b32 v66, v64
    v_mov_b32 v67, v65
    s_nop 0
    v_permlane16_swap_b32 v64, v66
    v_permlane16_swap_b32 v65, v67
    v_add_f32 v64, v64, v66
    v_add_f32 v65, v65, v67
    buffer_store_dwordx2 v[64:65], v59, s[4:7], s20 offen sc1
    v_cmp_eq_u32 vcc, 0, v1
    s_nop 1
    v_cndmask_b32 v252, 0, 1, vcc
    v_mov_b32 v255, 64
    v_sub_u32 v253, v255, v252
    s_waitcnt vmcnt(0)
    s_barrier
    s_cmp_lg_u32 s3, 0
    s_cbranch_scc1 main_kernel_sa3
    s_mov_b64 exec, 1
    buffer_atomic_add v252, v254, s[4:7], s11 offen
    s_mov_b64 exec, -1
main_kernel_sa3:
    s_mov_b32 s59, 44990464
    v_and_b32 v4, 15, v1
    v_lshrrev_b32 v5, 4, v1
    s_lshl_b32 s16, s8, 3
    s_lshl_b32 s17, s3, 1
    s_add_u32 s17, s17, s16
    s_mul_i32 s18, s17, 18432
    s_add_u32 s18, s18, 32768
    s_mul_i32 s22, s16, 18432
    s_add_u32 s22, s22, 14336
    s_cmp_eq_u32 s8, 0
    s_cselect_b32 s22, 268435456, s22
    s_lshl_b32 s25, s17, 9
    s_add_u32 s25, s25, 2392064
    s_lshl_b32 s26, s16, 9
    s_add_u32 s26, s26, 2391552
    s_cmp_eq_u32 s8, 0
    s_cselect_b32 s26, 268435456, s26
    s_sub_u32 s23, s25, 512
    s_cmp_eq_u32 s17, 0
    s_cselect_b32 s23, 268435456, s23
    s_lshl_b32 s27, s3, 2
    s_lshr_b32 s28, 0x1654, s27
    s_and_b32 s28, s28, 15
    s_lshr_b32 s27, 0x0632, s27
    s_and_b32 s27, s27, 15
    v_lshlrev_b32 v6, 3, v1
    v_lshlrev_b32 v7, 4, v5
    v_lshlrev_b32 v8, 2, v4
    v_add_u32 v15, 18432, v3
    v_min_u32 v12, 71, v0
    v_lshrrev_b32 v13, 2, v12
    v_lshlrev_b32 v13, 13, v13
    v_and_b32 v12, 3, v12
    v_lshl_add_u32 v13, v12, 8, v13
    v_mov_b32 v16, 0x3f803f80
    v_mov_b32 v17, 0x3f803f80
    v_mov_b32 v18, 0x3f803f80
    v_mov_b32 v19, 0x3f803f80
    ds_write_b128 v13, v[16:19] offset:7168
    v_mov_b32 v9, v3
    s_lshl_b32 s32, s27, 10
    v_add_u32 v10, s32, v3
    s_lshl_b32 s32, s28, 10
    v_add_u32 v11, s32, v3
    v_mov_b32 v12, 0xee013f39
    v_lshlrev_b32 v13, 2, v5
    v_sub_u32 v13, v4, v13
    s_cmp_eq_u32 s17, 0
    s_cselect_b32 s33, -100, -2
    v_subrev_u32 v14, 0, v13
    v_and_b32 v2, 1, v14
    v_cmp_eq_u32 s[34:35], 0, v2
    v_cmp_le_i32 vcc, 0, v14
    s_nop 0
    s_and_b64 vcc, vcc, s[34:35]
    v_cndmask_b32 v228, v12, 0, vcc
    v_cmp_ge_i32 vcc, -2, v14
    s_nop 0
    s_and_b64 vcc, vcc, s[34:35]
    v_cndmask_b32 v236, v12, 0, vcc
    v_cmp_ge_i32 vcc, s33, v14
    s_nop 0
    s_and_b64 vcc, vcc, s[34:35]
    v_cndmask_b32 v232, v12, 0, vcc
    v_subrev_u32 v14, 1, v13
    v_and_b32 v2, 1, v14
    v_cmp_eq_u32 s[34:35], 0, v2
    v_cmp_le_i32 vcc, 0, v14
    s_nop 0
    s_and_b64 vcc, vcc, s[34:35]
    v_cndmask_b32 v229, v12, 0, vcc
    v_cmp_ge_i32 vcc, -2, v14
    s_nop 0
    s_and_b64 vcc, vcc, s[34:35]
    v_cndmask_b32 v237, v12, 0, vcc
    v_cmp_ge_i32 vcc, s33, v14
    s_nop 0
    s_and_b64 vcc, vcc, s[34:35]
    v_cndmask_b32 v233, v12, 0, vcc
    v_subrev_u32 v14, 2, v13
    v_and_b32 v2, 1, v14
    v_cmp_eq_u32 s[34:35], 0, v2
    v_cmp_le_i32 vcc, 0, v14
    s_nop 0
    s_and_b64 vcc, vcc, s[34:35]
    v_cndmask_b32 v230, v12, 0, vcc
    v_cmp_ge_i32 vcc, -2, v14
    s_nop 0
    s_and_b64 vcc, vcc, s[34:35]
    v_cndmask_b32 v238, v12, 0, vcc
    v_cmp_ge_i32 vcc, s33, v14
    s_nop 0
    s_and_b64 vcc, vcc, s[34:35]
    v_cndmask_b32 v234, v12, 0, vcc
    v_subrev_u32 v14, 3, v13
    v_and_b32 v2, 1, v14
    v_cmp_eq_u32 s[34:35], 0, v2
    v_cmp_le_i32 vcc, 0, v14
    s_nop 0
    s_and_b64 vcc, vcc, s[34:35]
    v_cndmask_b32 v231, v12, 0, vcc
    v_cmp_ge_i32 vcc, -2, v14
    s_nop 0
    s_and_b64 vcc, vcc, s[34:35]
    v_cndmask_b32 v239, v12, 0, vcc
    v_cmp_ge_i32 vcc, s33, v14
    s_nop 0
    s_and_b64 vcc, vcc, s[34:35]
    v_cndmask_b32 v235, v12, 0, vcc
    v_and_b32 v2, 1, v4
    v_cmp_eq_u32 s[30:31], 1, v2
    v_lshlrev_b32 v14, 4, v2
    v_mov_b32 v12, 0xffff
    v_lshlrev_b32 v14, v14, v12
    v_sub_u32 v13, v13, v2
    v_cmp_le_i32 vcc, 0, v13
    s_nop 1
    v_cndmask_b32 v248, 0, v14, vcc
    v_cndmask_b32 v250, v14, 0, vcc
    v_cmp_le_i32 vcc, 2, v13
    s_nop 1
    v_cndmask_b32 v249, 0, v14, vcc
    v_cndmask_b32 v251, v14, 0, vcc
    s_lshl_b32 s32, s3, 9
    s_add_u32 s32, s32, 147456
    v_add_u32 v12, s32, v8
    v_add_u32 v13, s32, v7
    v_add_u32 v240, 4096, v3
    v_add_u32 v241, 8192, v3
    v_add_u32 v242, 12288, v3
    v_add_u32 v243, 16384, v3
    s_and_b32 s40, s9, 3
    s_and_b32 s41, s40, 1
    s_mul_i32 s42, s40, 9
    s_add_u32 s42, s42, s41
    s_lshr_b32 s42, s42, 1
    s_add_u32 s43, s42, s3
    s_lshr_b32 s46, s40, 1
    s_mul_i32 s46, s46, 9
    s_add_u32 s46, s46, 4
    s_mul_i32 s47, s43, 36864
    s_add_u32 s47, s47, 92045312
    s_sub_u32 s47, s47, s59
    s_add_u32 s48, s47, 18432
    s_lshl_b32 s49, s46, 1
    s_add_u32 s49, s49, s3
    s_mul_i32 s49, s49, 18432
    s_add_u32 s49, s49, 92045312
    s_sub_u32 s49, s49, s59
    s_cmp_ge_u32 s3, 2
    s_cselect_b32 s49, 268435456, s49
    s_lshl_b32 s24, s3, 13
    s_add_u32 s24, s24, 7168
    s_lshl_b32 s21, s3, 10
    s_add_u32 s22, s22, s21
    s_mov_b32 s44, 0xfffefffe
    s_mov_b32 s45, 0xfffefffe
    s_add_u32 m0, s50, 98304
    s_add_u32 s56, s51, 86016
    buffer_load_dwordx4 v3, s[4:7], s56 offen lds
    s_add_u32 m0, s53, 98304
    s_add_u32 s56, s52, 86016
    buffer_load_dwordx4 v3, s[4:7], s56 offen lds
    s_add_u32 m0, s50, 106496
    s_add_u32 s56, s51, 93184
    buffer_load_dwordx4 v3, s[4:7], s56 offen lds
    s_add_u32 m0, s53, 106496
    s_add_u32 s56, s52, 93184
    buffer_load_dwordx4 v3, s[4:7], s56 offen lds
    s_add_u32 m0, s50, 114688
    s_add_u32 s56, s51, 100352
    buffer_load_dwordx4 v3, s[4:7], s56 offen lds
    s_add_u32 m0, s53, 114688
    s_add_u32 s56, s52, 100352
    buffer_load_dwordx4 v3, s[4:7], s56 offen lds
    s_add_u32 m0, s50, 122880
    s_add_u32 s56, s51, 107520
    buffer_load_dwordx4 v3, s[4:7], s56 offen lds
    s_add_u32 m0, s53, 122880
    s_add_u32 s56, s52, 107520
    buffer_load_dwordx4 v3, s[4:7], s56 offen lds
    s_add_u32 m0, s50, 131072
    s_add_u32 s56, s51, 114688
    buffer_load_dwordx4 v3, s[4:7], s56 offen lds
    s_add_u32 m0, s53, 131072
    s_add_u32 s56, s52, 114688
    buffer_load_dwordx4 v3, s[4:7], s56 offen lds
    s_add_u32 m0, s50, 139264
    s_add_u32 s56, s51, 121856
    buffer_load_dwordx4 v3, s[4:7], s56 offen lds
    s_add_u32 m0, s53, 139264
    s_add_u32 s56, s52, 121856
    buffer_load_dwordx4 v3, s[4:7], s56 offen lds
    s_cmp_lg_u32 s3, 0
    s_cbranch_scc1 main_kernel_sb3
    s_mov_b64 exec, 3
main_kernel_sp3:
    buffer_load_dword v252, v254, s[4:7], s11 offen sc1
    s_add_u32 s57, s57, 1
    s_waitcnt vmcnt(0)
    v_cmp_gt_u32 vcc, v255, v252
    s_nop 4
    s_cbranch_vccz main_kernel_sq3
    s_cmp_lt_u32 s57, 0x40000
    s_cbranch_scc1 main_kernel_sp3
main_kernel_sq3:
    s_mov_b64 exec, -1
main_kernel_sb3:
    s_waitcnt vmcnt(0) lgkmcnt(0)
    s_barrier
    s_add_u32 s4, s4, 44990464
    s_addc_u32 s5, s5, 0
    buffer_load_dwordx2 v[200:201], v6, s[4:7], s25 offen offset:0 sc1
    buffer_load_dwordx2 v[202:203], v6, s[4:7], s25 offen offset:512 sc1
    buffer_load_dwordx2 v[204:205], v6, s[4:7], s26 offen offset:0 sc1
    buffer_load_dwordx2 v[206:207], v6, s[4:7], s23 offen offset:0 sc1
    buffer_load_dwordx4 a[0:3], v3, s[4:7], s18 offen offset:0 sc1
    buffer_load_dwordx4 a[72:75], v15, s[4:7], s18 offen offset:0 sc1
    s_mov_b64 exec, s[44:45]
    s_mov_b32 m0, s24
    s_nop 0
    buffer_load_dwordx4 v3, s[4:7], s22 offen sc1 lds
    s_add_u32 s22, s22, 4096
    s_add_u32 s24, s24, 32768
    s_mov_b32 m0, s24
    s_nop 0
    buffer_load_dwordx4 v3, s[4:7], s22 offen sc1 lds
    s_add_u32 s22, s22, 4096
    s_add_u32 s24, s24, 32768
    s_mov_b32 m0, s24
    s_nop 0
    buffer_load_dwordx4 v3, s[4:7], s22 offen sc1 lds
    s_add_u32 s22, s22, 4096
    s_add_u32 s24, s24, 32768
    s_mov_b32 m0, s24
    s_nop 0
    buffer_load_dwordx4 v3, s[4:7], s22 offen sc1 lds
    s_add_u32 s22, s22, 4096
    s_add_u32 s24, s24, 32768
    s_cmp_ge_u32 s3, 2
    s_cselect_b32 s22, 268435456, s22
    s_mov_b32 m0, s24
    s_nop 0
    buffer_load_dwordx4 v3, s[4:7], s22 offen sc1 lds
    s_add_u32 s22, s22, 4096
    s_add_u32 s24, s24, 32768
    s_mov_b64 exec, -1
    buffer_load_dwordx4 a[4:7], v3, s[4:7], s18 offen offset:1024 sc1
    buffer_load_dwordx4 a[76:79], v15, s[4:7], s18 offen offset:1024 sc1
    buffer_load_dwordx4 a[8:11], v3, s[4:7], s18 offen offset:2048 sc1
    buffer_load_dwordx4 a[80:83], v15, s[4:7], s18 offen offset:2048 sc1
    buffer_load_dwordx4 a[12:15], v3, s[4:7], s18 offen offset:3072 sc1
    buffer_load_dwordx4 a[84:87], v15, s[4:7], s18 offen offset:3072 sc1
    s_add_u32 s18, s18, 4096
    buffer_load_dwordx4 a[16:19], v3, s[4:7], s18 offen offset:0 sc1
    buffer_load_dwordx4 a[88:91], v15, s[4:7], s18 offen offset:0 sc1
    buffer_load_dwordx4 a[20:23], v3, s[4:7], s18 offen offset:1024 sc1
    buffer_load_dwordx4 a[92:95], v15, s[4:7], s18 offen offset:1024 sc1
    s_waitcnt vmcnt(10)
    s_waitcnt lgkmcnt(0)
    s_barrier
    ds_read_b128 v[116:119], v9 offset:7168
    ds_read_b128 v[120:123], v10 offset:0
    ds_read_b128 v[124:127], v11 offset:0
    ds_read_b128 v[88:91], v9 offset:0
    ds_read_b128 v[92:95], v9 offset:1024
    ds_read_b128 v[96:99], v9 offset:2048
    ds_read_b128 v[100:103], v9 offset:3072
    ds_read_b128 v[112:115], v9 offset:6144
    ds_read_b128 v[104:107], v9 offset:4096
    ds_read_b128 v[108:111], v9 offset:5120
    s_waitcnt lgkmcnt(0)
    v_mfma_f32_16x16x32_bf16 v[80:83], v[120:123], v[116:119], 0
    ds_read_b128 v[156:159], v9 offset:15360
    v_mfma_f32_16x16x32_bf16 v[84:87], v[116:119], v[124:127], 0
    ds_read_b128 v[160:163], v10 offset:8192
    v_mfma_f32_16x16x32_bf16 v[16:19], v[88:91], a[0:3], 0
    ds_read_b128 v[164:167], v11 offset:8192
    v_mfma_f32_16x16x32_bf16 v[48:51], v[88:91], a[72:75], 0
    ds_read_b128 v[128:131], v9 offset:8192
    v_mfma_f32_16x16x32_bf16 v[20:23], v[92:95], a[0:3], 0
    ds_read_b128 v[132:135], v9 offset:9216
    v_mfma_f32_16x16x32_bf16 v[52:55], v[92:95], a[72:75], 0
    ds_read_b128 v[136:139], v9 offset:10240
    v_mfma_f32_16x16x32_bf16 v[24:27], v[96:99], a[0:3], 0
    ds_read_b128 v[140:143], v9 offset:11264
    v_mfma_f32_16x16x32_bf16 v[56:59], v[96:99], a[72:75], 0
    ds_read_b128 v[152:155], v9 offset:14336
    v_mfma_f32_16x16x32_bf16 v[28:31], v[100:103], a[0:3], 0
    ds_read_b128 v[144:147], v9 offset:12288
    v_mfma_f32_16x16x32_bf16 v[60:63], v[100:103], a[72:75], 0
    ds_read_b128 v[148:151], v9 offset:13312
    v_mfma_f32_16x16x32_bf16 v[32:35], v[112:115], a[0:3], 0
    buffer_load_dwordx4 a[24:27], v3, s[4:7], s18 offen offset:2048 sc1
    v_mfma_f32_16x16x32_bf16 v[64:67], v[112:115], a[72:75], 0
    v_mfma_f32_16x16x32_bf16 v[36:39], a[0:3], v[104:107], 0
    buffer_load_dwordx4 a[96:99], v15, s[4:7], s18 offen offset:2048 sc1
    v_mfma_f32_16x16x32_bf16 v[68:71], a[72:75], v[104:107], 0
    v_mfma_f32_16x16x32_bf16 v[40:43], a[0:3], v[108:111], 0
    v_mfma_f32_16x16x32_bf16 v[72:75], a[72:75], v[108:111], 0
    v_mfma_f32_16x16x32_bf16 v[44:47], a[0:3], v[112:115], 0
    v_mfma_f32_16x16x32_bf16 v[76:79], a[72:75], v[112:115], 0
    s_waitcnt lgkmcnt(0)
    s_waitcnt vmcnt(10)
    v_mfma_f32_16x16x32_bf16 v[80:83], v[160:163], v[156:159], v[80:83]
    ds_read_b128 v[116:119], v9 offset:23552
    v_mov_b32 v208, v200
    v_mfma_f32_16x16x32_bf16 v[84:87], v[156:159], v[164:167], v[84:87]
    ds_read_b128 v[120:123], v10 offset:16384
    v_mov_b32 v209, v201
    v_mfma_f32_16x16x32_bf16 v[16:19], v[128:131], a[4:7], v[16:19]
    ds_read_b128 v[124:127], v11 offset:16384
    v_mov_b32 v210, v202
    v_mfma_f32_16x16x32_bf16 v[48:51], v[128:131], a[76:79], v[48:51]
    ds_read_b128 v[88:91], v9 offset:16384
    v_mov_b32 v211, v203
    v_mfma_f32_16x16x32_bf16 v[20:23], v[132:135], a[4:7], v[20:23]
    ds_read_b128 v[92:95], v9 offset:17408
    v_mov_b32 v212, v204
    v_mfma_f32_16x16x32_bf16 v[52:55], v[132:135], a[76:79], v[52:55]
    ds_read_b128 v[96:99], v9 offset:18432
    v_mov_b32 v213, v205
    v_mfma_f32_16x16x32_bf16 v[24:27], v[136:139], a[4:7], v[24:27]
    ds_read_b128 v[100:103], v9 offset:19456
    v_mov_b32 v214, v206
    v_mfma_f32_16x16x32_bf16 v[56:59], v[136:139], a[76:79], v[56:59]
    ds_read_b128 v[112:115], v9 offset:22528
    v_mov_b32 v215, v207
    v_mfma_f32_16x16x32_bf16 v[28:31], v[140:143], a[4:7], v[28:31]
    ds_read_b128 v[104:107], v9 offset:20480
    v_permlane16_swap_b32 v200, v208
    v_mfma_f32_16x16x32_bf16 v[60:63], v[140:143], a[76:79], v[60:63]
    ds_read_b128 v[108:111], v9 offset:21504
    v_permlane16_swap_b32 v201, v209
    v_mfma_f32_16x16x32_bf16 v[32:35], v[152:155], a[4:7], v[32:35]
    v_permlane16_swap_b32 v202, v210
    buffer_load_dwordx4 a[28:31], v3, s[4:7], s18 offen offset:3072 sc1
    v_mfma_f32_16x16x32_bf16 v[64:67], v[152:155], a[76:79], v[64:67]
    v_permlane16_swap_b32 v203, v211
    v_mfma_f32_16x16x32_bf16 v[36:39], a[4:7], v[144:147], v[36:39]
    v_permlane16_swap_b32 v204, v212
    buffer_load_dwordx4 a[100:103], v15, s[4:7], s18 offen offset:3072 sc1
    s_add_u32 s18, s18, 4096
    v_mfma_f32_16x16x32_bf16 v[68:71], a[76:79], v[144:147], v[68:71]
    v_permlane16_swap_b32 v205, v213
    v_mfma_f32_16x16x32_bf16 v[40:43], a[4:7], v[148:151], v[40:43]
    v_permlane16_swap_b32 v206, v214
    v_mfma_f32_16x16x32_bf16 v[72:75], a[76:79], v[148:151], v[72:75]
    v_permlane16_swap_b32 v207, v215
    v_mfma_f32_16x16x32_bf16 v[44:47], a[4:7], v[152:155], v[44:47]
    v_mfma_f32_16x16x32_bf16 v[76:79], a[76:79], v[152:155], v[76:79]
    s_waitcnt lgkmcnt(0)
    s_waitcnt vmcnt(10)
    v_mfma_f32_16x16x32_bf16 v[80:83], v[120:123], v[116:119], v[80:83]
    ds_read_b128 v[156:159], v9 offset:31744
    v_add_f32 v200, v200, v208
    v_mfma_f32_16x16x32_bf16 v[84:87], v[116:119], v[124:127], v[84:87]
    ds_read_b128 v[160:163], v10 offset:24576
    v_add_f32 v201, v201, v209
    v_mfma_f32_16x16x32_bf16 v[16:19], v[88:91], a[8:11], v[16:19]
    ds_read_b128 v[164:167], v11 offset:24576
    v_add_f32 v202, v202, v210
    v_mfma_f32_16x16x32_bf16 v[48:51], v[88:91], a[80:83], v[48:51]
    ds_read_b128 v[128:131], v9 offset:24576
    v_add_f32 v203, v203, v211
    v_mfma_f32_16x16x32_bf16 v[20:23], v[92:95], a[8:11], v[20:23]
    ds_read_b128 v[132:135], v9 offset:25600
    v_add_f32 v204, v204, v212
    v_mfma_f32_16x16x32_bf16 v[52:55], v[92:95], a[80:83], v[52:55]
    ds_read_b128 v[136:139], v9 offset:26624
    v_add_f32 v205, v205, v213
    v_mfma_f32_16x16x32_bf16 v[24:27], v[96:99], a[8:11], v[24:27]
    ds_read_b128 v[140:143], v9 offset:27648
    v_add_f32 v206, v206, v214
    v_mfma_f32_16x16x32_bf16 v[56:59], v[96:99], a[80:83], v[56:59]
    ds_read_b128 v[152:155], v9 offset:30720
    v_add_f32 v207, v207, v215
    v_mfma_f32_16x16x32_bf16 v[28:31], v[100:103], a[8:11], v[28:31]
    ds_read_b128 v[144:147], v9 offset:28672
    v_mov_b32 v208, v200
    v_mfma_f32_16x16x32_bf16 v[60:63], v[100:103], a[80:83], v[60:63]
    ds_read_b128 v[148:151], v9 offset:29696
    v_mov_b32 v209, v201
    v_mfma_f32_16x16x32_bf16 v[32:35], v[112:115], a[8:11], v[32:35]
    v_mov_b32 v210, v202
    buffer_load_dwordx4 a[32:35], v3, s[4:7], s18 offen offset:0 sc1
    v_mfma_f32_16x16x32_bf16 v[64:67], v[112:115], a[80:83], v[64:67]
    v_mov_b32 v211, v203
    v_mfma_f32_16x16x32_bf16 v[36:39], a[8:11], v[104:107], v[36:39]
    v_mov_b32 v212, v204
    buffer_load_dwordx4 a[104:107], v15, s[4:7], s18 offen offset:0 sc1
    v_mfma_f32_16x16x32_bf16 v[68:71], a[80:83], v[104:107], v[68:71]
    v_mov_b32 v213, v205
    v_mfma_f32_16x16x32_bf16 v[40:43], a[8:11], v[108:111], v[40:43]
    v_mov_b32 v214, v206
    v_mfma_f32_16x16x32_bf16 v[72:75], a[80:83], v[108:111], v[72:75]
    v_mov_b32 v215, v207
    v_mfma_f32_16x16x32_bf16 v[44:47], a[8:11], v[112:115], v[44:47]
    v_mfma_f32_16x16x32_bf16 v[76:79], a[80:83], v[112:115], v[76:79]
    s_waitcnt lgkmcnt(0)
    s_waitcnt vmcnt(10)
    v_mfma_f32_16x16x32_bf16 v[80:83], v[160:163], v[156:159], v[80:83]
    ds_read_b128 v[116:119], v9 offset:39936
    v_permlane32_swap_b32 v200, v208
    v_mfma_f32_16x16x32_bf16 v[84:87], v[156:159], v[164:167], v[84:87]
    ds_read_b128 v[120:123], v10 offset:32768
    v_permlane32_swap_b32 v201, v209
    v_mfma_f32_16x16x32_bf16 v[16:19], v[128:131], a[12:15], v[16:19]
    ds_read_b128 v[124:127], v11 offset:32768
    v_permlane32_swap_b32 v202, v210
    v_mfma_f32_16x16x32_bf16 v[48:51], v[128:131], a[84:87], v[48:51]
    ds_read_b128 v[88:91], v9 offset:32768
    v_permlane32_swap_b32 v203, v211
    v_mfma_f32_16x16x32_bf16 v[20:23], v[132:135], a[12:15], v[20:23]
    ds_read_b128 v[92:95], v9 offset:33792
    v_permlane32_swap_b32 v204, v212
    v_mfma_f32_16x16x32_bf16 v[52:55], v[132:135], a[84:87], v[52:55]
    ds_read_b128 v[96:99], v9 offset:34816
    v_permlane32_swap_b32 v205, v213
    v_mfma_f32_16x16x32_bf16 v[24:27], v[136:139], a[12:15], v[24:27]
    ds_read_b128 v[100:103], v9 offset:35840
    v_permlane32_swap_b32 v206, v214
    v_mfma_f32_16x16x32_bf16 v[56:59], v[136:139], a[84:87], v[56:59]
    ds_read_b128 v[112:115], v9 offset:38912
    v_permlane32_swap_b32 v207, v215
    v_mfma_f32_16x16x32_bf16 v[28:31], v[140:143], a[12:15], v[28:31]
    ds_read_b128 v[104:107], v9 offset:36864
    v_add_f32 v200, v200, v208
    v_mfma_f32_16x16x32_bf16 v[60:63], v[140:143], a[84:87], v[60:63]
    ds_read_b128 v[108:111], v9 offset:37888
    v_add_f32 v201, v201, v209
    v_mfma_f32_16x16x32_bf16 v[32:35], v[152:155], a[12:15], v[32:35]
    v_add_f32 v202, v202, v210
    buffer_load_dwordx4 a[36:39], v3, s[4:7], s18 offen offset:1024 sc1
    v_mfma_f32_16x16x32_bf16 v[64:67], v[152:155], a[84:87], v[64:67]
    v_add_f32 v203, v203, v211
    v_mfma_f32_16x16x32_bf16 v[36:39], a[12:15], v[144:147], v[36:39]
    v_add_f32 v204, v204, v212
    buffer_load_dwordx4 a[108:111], v15, s[4:7], s18 offen offset:1024 sc1
    v_mfma_f32_16x16x32_bf16 v[68:71], a[84:87], v[144:147], v[68:71]
    v_add_f32 v205, v205, v213
    v_mfma_f32_16x16x32_bf16 v[40:43], a[12:15], v[148:151], v[40:43]
    v_add_f32 v206, v206, v214
    v_mfma_f32_16x16x32_bf16 v[72:75], a[84:87], v[148:151], v[72:75]
    v_add_f32 v207, v207, v215
    v_mfma_f32_16x16x32_bf16 v[44:47], a[12:15], v[152:155], v[44:47]
    v_mfma_f32_16x16x32_bf16 v[76:79], a[84:87], v[152:155], v[76:79]
    s_waitcnt lgkmcnt(0)
    s_waitcnt vmcnt(10)
    v_mfma_f32_16x16x32_bf16 v[80:83], v[120:123], v[116:119], v[80:83]
    ds_read_b128 v[156:159], v9 offset:48128
    v_mul_f32 v200, 0x3ae38e39, v200
    v_mfma_f32_16x16x32_bf16 v[84:87], v[116:119], v[124:127], v[84:87]
    ds_read_b128 v[160:163], v10 offset:40960
    v_mul_f32 v201, 0x3ae38e39, v201
    v_mfma_f32_16x16x32_bf16 v[16:19], v[88:91], a[16:19], v[16:19]
    ds_read_b128 v[164:167], v11 offset:40960
    v_fma_f32 v201, -v200, v200, v201
    v_mfma_f32_16x16x32_bf16 v[48:51], v[88:91], a[88:91], v[48:51]
    ds_read_b128 v[128:131], v9 offset:40960
    v_max_f32 v201, 0, v201
    v_mfma_f32_16x16x32_bf16 v[20:23], v[92:95], a[16:19], v[20:23]
    ds_read_b128 v[132:135], v9 offset:41984
    v_add_f32 v208, 0x3727c5ac, v201
    v_mfma_f32_16x16x32_bf16 v[52:55], v[92:95], a[88:91], v[52:55]
    ds_read_b128 v[136:139], v9 offset:43008
    v_rsq_f32 v168, v208
    v_mfma_f32_16x16x32_bf16 v[24:27], v[96:99], a[16:19], v[24:27]
    ds_read_b128 v[140:143], v9 offset:44032
    v_mul_f32 v212, v200, v168
    v_mfma_f32_16x16x32_bf16 v[56:59], v[96:99], a[88:91], v[56:59]
    ds_read_b128 v[152:155], v9 offset:47104
    v_mov_b32 v169, v200
    v_mfma_f32_16x16x32_bf16 v[28:31], v[100:103], a[16:19], v[28:31]
    ds_read_b128 v[144:147], v9 offset:45056
    ds_write_b32 v12, v168 offset:0
    v_mfma_f32_16x16x32_bf16 v[60:63], v[100:103], a[88:91], v[60:63]
    ds_read_b128 v[148:151], v9 offset:46080
    ds_write_b32 v12, v212 offset:64
    v_mfma_f32_16x16x32_bf16 v[32:35], v[112:115], a[16:19], v[32:35]
    v_mul_f32 v202, 0x3ae38e39, v202
    buffer_load_dwordx4 a[40:43], v3, s[4:7], s18 offen offset:2048 sc1
    v_mfma_f32_16x16x32_bf16 v[64:67], v[112:115], a[88:91], v[64:67]
    v_mul_f32 v203, 0x3ae38e39, v203
    v_mfma_f32_16x16x32_bf16 v[36:39], a[16:19], v[104:107], v[36:39]
    v_fma_f32 v203, -v202, v202, v203
    buffer_load_dwordx4 a[112:115], v15, s[4:7], s18 offen offset:2048 sc1
    v_mfma_f32_16x16x32_bf16 v[68:71], a[88:91], v[104:107], v[68:71]
    v_max_f32 v203, 0, v203
    v_mfma_f32_16x16x32_bf16 v[40:43], a[16:19], v[108:111], v[40:43]
    v_add_f32 v209, 0x3727c5ac, v203
    v_mfma_f32_16x16x32_bf16 v[72:75], a[88:91], v[108:111], v[72:75]
    v_rsq_f32 v170, v209
    v_mfma_f32_16x16x32_bf16 v[44:47], a[16:19], v[112:115], v[44:47]
    v_mfma_f32_16x16x32_bf16 v[76:79], a[88:91], v[112:115], v[76:79]
    s_waitcnt lgkmcnt(0)
    s_waitcnt vmcnt(10)
    v_mfma_f32_16x16x32_bf16 v[80:83], v[160:163], v[156:159], v[80:83]
    ds_read_b128 v[116:119], v9 offset:56320
    v_mul_f32 v213, v202, v170
    v_mfma_f32_16x16x32_bf16 v[84:87], v[156:159], v[164:167], v[84:87]
    ds_read_b128 v[120:123], v10 offset:49152
    v_mov_b32 v171, v202
    v_mfma_f32_16x16x32_bf16 v[16:19], v[128:131], a[20:23], v[16:19]
    ds_read_b128 v[124:127], v11 offset:49152
    ds_write_b32 v12, v170 offset:128
    v_mfma_f32_16x16x32_bf16 v[48:51], v[128:131], a[92:95], v[48:51]
    ds_read_b128 v[88:91], v9 offset:49152
    ds_write_b32 v12, v213 offset:192
    v_mfma_f32_16x16x32_bf16 v[20:23], v[132:135], a[20:23], v[20:23]
    ds_read_b128 v[92:95], v9 offset:50176
    v_mul_f32 v204, 0x3ae38e39, v204
    v_mfma_f32_16x16x32_bf16 v[52:55], v[132:135], a[92:95], v[52:55]
    ds_read_b128 v[96:99], v9 offset:51200
    v_mul_f32 v205, 0x3ae38e39, v205
    v_mfma_f32_16x16x32_bf16 v[24:27], v[136:139], a[20:23], v[24:27]
    ds_read_b128 v[100:103], v9 offset:52224
    v_fma_f32 v205, -v204, v204, v205
    v_mfma_f32_16x16x32_bf16 v[56:59], v[136:139], a[92:95], v[56:59]
    ds_read_b128 v[112:115], v9 offset:55296
    v_max_f32 v205, 0, v205
    v_mfma_f32_16x16x32_bf16 v[28:31], v[140:143], a[20:23], v[28:31]
    ds_read_b128 v[104:107], v9 offset:53248
    v_add_f32 v210, 0x3727c5ac, v205
    v_mfma_f32_16x16x32_bf16 v[60:63], v[140:143], a[92:95], v[60:63]
    ds_read_b128 v[108:111], v9 offset:54272
    v_rsq_f32 v172, v210
    v_mfma_f32_16x16x32_bf16 v[32:35], v[152:155], a[20:23], v[32:35]
    v_mul_f32 v214, v204, v172
    buffer_load_dwordx4 a[44:47], v3, s[4:7], s18 offen offset:3072 sc1
    v_mfma_f32_16x16x32_bf16 v[64:67], v[152:155], a[92:95], v[64:67]
    v_mov_b32 v173, v204
    v_mfma_f32_16x16x32_bf16 v[36:39], a[20:23], v[144:147], v[36:39]
    ds_write_b32 v12, v172 offset:256
    buffer_load_dwordx4 a[116:119], v15, s[4:7], s18 offen offset:3072 sc1
    s_add_u32 s18, s18, 4096
    v_mfma_f32_16x16x32_bf16 v[68:71], a[92:95], v[144:147], v[68:71]
    ds_write_b32 v12, v214 offset:320
    v_mfma_f32_16x16x32_bf16 v[40:43], a[20:23], v[148:151], v[40:43]
    v_mul_f32 v206, 0x3ae38e39, v206
    v_mfma_f32_16x16x32_bf16 v[72:75], a[92:95], v[148:151], v[72:75]
    v_mul_f32 v207, 0x3ae38e39, v207
    v_mfma_f32_16x16x32_bf16 v[44:47], a[20:23], v[152:155], v[44:47]
    v_mfma_f32_16x16x32_bf16 v[76:79], a[92:95], v[152:155], v[76:79]
    s_waitcnt lgkmcnt(0)
    s_waitcnt vmcnt(10)
    v_mfma_f32_16x16x32_bf16 v[80:83], v[120:123], v[116:119], v[80:83]
    ds_read_b128 v[156:159], v9 offset:64512
    v_fma_f32 v207, -v206, v206, v207
    v_mfma_f32_16x16x32_bf16 v[84:87], v[116:119], v[124:127], v[84:87]
    ds_read_b128 v[160:163], v10 offset:57344
    v_max_f32 v207, 0, v207
    v_mfma_f32_16x16x32_bf16 v[16:19], v[88:91], a[24:27], v[16:19]
    ds_read_b128 v[164:167], v11 offset:57344
    v_add_f32 v211, 0x3727c5ac, v207
    v_mfma_f32_16x16x32_bf16 v[48:51], v[88:91], a[96:99], v[48:51]
    ds_read_b128 v[128:131], v9 offset:57344
    v_rsq_f32 v174, v211
    v_mfma_f32_16x16x32_bf16 v[20:23], v[92:95], a[24:27], v[20:23]
    ds_read_b128 v[132:135], v9 offset:58368
    v_mul_f32 v215, v206, v174
    v_mfma_f32_16x16x32_bf16 v[52:55], v[92:95], a[96:99], v[52:55]
    ds_read_b128 v[136:139], v9 offset:59392
    v_mov_b32 v175, v206
    v_mfma_f32_16x16x32_bf16 v[24:27], v[96:99], a[24:27], v[24:27]
    ds_read_b128 v[140:143], v9 offset:60416
    ds_write_b32 v12, v174 offset:384
    v_mfma_f32_16x16x32_bf16 v[56:59], v[96:99], a[96:99], v[56:59]
    ds_read_b128 v[152:155], v9 offset:63488
    ds_read_b128 v[176:179], v13 offset:0
    v_mfma_f32_16x16x32_bf16 v[28:31], v[100:103], a[24:27], v[28:31]
    ds_read_b128 v[144:147], v9 offset:61440
    ds_read_b128 v[180:183], v13 offset:64
    v_mfma_f32_16x16x32_bf16 v[60:63], v[100:103], a[96:99], v[60:63]
    ds_read_b128 v[148:151], v9 offset:62464
    ds_read_b128 v[184:187], v13 offset:128
    v_mfma_f32_16x16x32_bf16 v[32:35], v[112:115], a[24:27], v[32:35]
    ds_read_b128 v[188:191], v13 offset:192
    buffer_load_dwordx4 a[48:51], v3, s[4:7], s18 offen offset:0 sc1
    v_mfma_f32_16x16x32_bf16 v[64:67], v[112:115], a[96:99], v[64:67]
    ds_read_b128 v[192:195], v13 offset:256
    v_mfma_f32_16x16x32_bf16 v[36:39], a[24:27], v[104:107], v[36:39]
    ds_read_b128 v[196:199], v13 offset:320
    buffer_load_dwordx4 a[120:123], v15, s[4:7], s18 offen offset:0 sc1
    v_mfma_f32_16x16x32_bf16 v[68:71], a[96:99], v[104:107], v[68:71]
    ds_read_b128 v[216:219], v13 offset:384
    v_mfma_f32_16x16x32_bf16 v[40:43], a[24:27], v[108:111], v[40:43]
    v_mfma_f32_16x16x32_bf16 v[72:75], a[96:99], v[108:111], v[72:75]
    v_mfma_f32_16x16x32_bf16 v[44:47], a[24:27], v[112:115], v[44:47]
    v_mfma_f32_16x16x32_bf16 v[76:79], a[96:99], v[112:115], v[76:79]
    s_waitcnt lgkmcnt(0)
    s_waitcnt vmcnt(10)
    v_add_u32 v9, 0x10000, v9
    v_add_u32 v10, 0x10000, v10
    v_add_u32 v11, 0x10000, v11
    v_mfma_f32_16x16x32_bf16 v[80:83], v[160:163], v[156:159], v[80:83]
    ds_read_b128 v[116:119], v9 offset:7168
    v_mfma_f32_16x16x32_bf16 v[84:87], v[156:159], v[164:167], v[84:87]
    ds_read_b128 v[120:123], v10 offset:0
    v_mfma_f32_16x16x32_bf16 v[16:19], v[128:131], a[28:31], v[16:19]
    ds_read_b128 v[124:127], v11 offset:0
    v_mfma_f32_16x16x32_bf16 v[48:51], v[128:131], a[100:103], v[48:51]
    ds_read_b128 v[88:91], v9 offset:0
    v_mfma_f32_16x16x32_bf16 v[20:23], v[132:135], a[28:31], v[20:23]
    ds_read_b128 v[92:95], v9 offset:1024
    v_mfma_f32_16x16x32_bf16 v[52:55], v[132:135], a[100:103], v[52:55]
    ds_read_b128 v[96:99], v9 offset:2048
    v_mfma_f32_16x16x32_bf16 v[24:27], v[136:139], a[28:31], v[24:27]
    ds_read_b128 v[100:103], v9 offset:3072
    v_mfma_f32_16x16x32_bf16 v[56:59], v[136:139], a[100:103], v[56:59]
    ds_read_b128 v[112:115], v9 offset:6144
    v_mfma_f32_16x16x32_bf16 v[28:31], v[140:143], a[28:31], v[28:31]
    ds_read_b128 v[104:107], v9 offset:4096
    v_mfma_f32_16x16x32_bf16 v[60:63], v[140:143], a[100:103], v[60:63]
    ds_read_b128 v[108:111], v9 offset:5120
    v_mfma_f32_16x16x32_bf16 v[32:35], v[152:155], a[28:31], v[32:35]
    buffer_load_dwordx4 a[52:55], v3, s[4:7], s18 offen offset:1024 sc1
    v_mfma_f32_16x16x32_bf16 v[64:67], v[152:155], a[100:103], v[64:67]
    v_mfma_f32_16x16x32_bf16 v[36:39], a[28:31], v[144:147], v[36:39]
    buffer_load_dwordx4 a[124:127], v15, s[4:7], s18 offen offset:1024 sc1
    v_mfma_f32_16x16x32_bf16 v[68:71], a[100:103], v[144:147], v[68:71]
    v_mfma_f32_16x16x32_bf16 v[40:43], a[28:31], v[148:151], v[40:43]
    v_mfma_f32_16x16x32_bf16 v[72:75], a[100:103], v[148:151], v[72:75]
    v_mfma_f32_16x16x32_bf16 v[44:47], a[28:31], v[152:155], v[44:47]
    v_mfma_f32_16x16x32_bf16 v[76:79], a[100:103], v[152:155], v[76:79]
    s_waitcnt lgkmcnt(0)
    s_waitcnt vmcnt(10)
    v_mfma_f32_16x16x32_bf16 v[80:83], v[120:123], v[116:119], v[80:83]
    ds_read_b128 v[156:159], v9 offset:15360
    v_mfma_f32_16x16x32_bf16 v[84:87], v[116:119], v[124:127], v[84:87]
    ds_read_b128 v[160:163], v10 offset:8192
    v_mfma_f32_16x16x32_bf16 v[16:19], v[88:91], a[32:35], v[16:19]
    ds_read_b128 v[164:167], v11 offset:8192
    v_mfma_f32_16x16x32_bf16 v[48:51], v[88:91], a[104:107], v[48:51]
    ds_read_b128 v[128:131], v9 offset:8192
    v_mfma_f32_16x16x32_bf16 v[20:23], v[92:95], a[32:35], v[20:23]
    ds_read_b128 v[132:135], v9 offset:9216
    v_mfma_f32_16x16x32_bf16 v[52:55], v[92:95], a[104:107], v[52:55]
    ds_read_b128 v[136:139], v9 offset:10240
    v_mfma_f32_16x16x32_bf16 v[24:27], v[96:99], a[32:35], v[24:27]
    ds_read_b128 v[140:143], v9 offset:11264
    v_mfma_f32_16x16x32_bf16 v[56:59], v[96:99], a[104:107], v[56:59]
    ds_read_b128 v[152:155], v9 offset:14336
    v_mfma_f32_16x16x32_bf16 v[28:31], v[100:103], a[32:35], v[28:31]
    ds_read_b128 v[144:147], v9 offset:12288
    v_mfma_f32_16x16x32_bf16 v[60:63], v[100:103], a[104:107], v[60:63]
    ds_read_b128 v[148:151], v9 offset:13312
    v_mfma_f32_16x16x32_bf16 v[32:35], v[112:115], a[32:35], v[32:35]
    buffer_load_dwordx4 a[56:59], v3, s[4:7], s18 offen offset:2048 sc1
    v_mfma_f32_16x16x32_bf16 v[64:67], v[112:115], a[104:107], v[64:67]
    v_mfma_f32_16x16x32_bf16 v[36:39], a[32:35], v[104:107], v[36:39]
    buffer_load_dwordx4 a[128:131], v15, s[4:7], s18 offen offset:2048 sc1
    v_mfma_f32_16x16x32_bf16 v[68:71], a[104:107], v[104:107], v[68:71]
    v_mfma_f32_16x16x32_bf16 v[40:43], a[32:35], v[108:111], v[40:43]
    v_mfma_f32_16x16x32_bf16 v[72:75], a[104:107], v[108:111], v[72:75]
    v_mfma_f32_16x16x32_bf16 v[44:47], a[32:35], v[112:115], v[44:47]
    v_mfma_f32_16x16x32_bf16 v[76:79], a[104:107], v[112:115], v[76:79]
    s_waitcnt lgkmcnt(0)
    s_waitcnt vmcnt(10)
    v_mfma_f32_16x16x32_bf16 v[80:83], v[160:163], v[156:159], v[80:83]
    ds_read_b128 v[116:119], v9 offset:23552
    v_mfma_f32_16x16x32_bf16 v[84:87], v[156:159], v[164:167], v[84:87]
    ds_read_b128 v[120:123], v10 offset:16384
    v_mfma_f32_16x16x32_bf16 v[16:19], v[128:131], a[36:39], v[16:19]
    ds_read_b128 v[124:127], v11 offset:16384
    v_mfma_f32_16x16x32_bf16 v[48:51], v[128:131], a[108:111], v[48:51]
    ds_read_b128 v[88:91], v9 offset:16384
    v_mfma_f32_16x16x32_bf16 v[20:23], v[132:135], a[36:39], v[20:23]
    ds_read_b128 v[92:95], v9 offset:17408
    v_mfma_f32_16x16x32_bf16 v[52:55], v[132:135], a[108:111], v[52:55]
    ds_read_b128 v[96:99], v9 offset:18432
    v_mfma_f32_16x16x32_bf16 v[24:27], v[136:139], a[36:39], v[24:27]
    ds_read_b128 v[100:103], v9 offset:19456
    v_mfma_f32_16x16x32_bf16 v[56:59], v[136:139], a[108:111], v[56:59]
    ds_read_b128 v[112:115], v9 offset:22528
    v_mfma_f32_16x16x32_bf16 v[28:31], v[140:143], a[36:39], v[28:31]
    ds_read_b128 v[104:107], v9 offset:20480
    v_mfma_f32_16x16x32_bf16 v[60:63], v[140:143], a[108:111], v[60:63]
    ds_read_b128 v[108:111], v9 offset:21504
    v_mfma_f32_16x16x32_bf16 v[32:35], v[152:155], a[36:39], v[32:35]
    buffer_load_dwordx4 a[60:63], v3, s[4:7], s18 offen offset:3072 sc1
    v_mfma_f32_16x16x32_bf16 v[64:67], v[152:155], a[108:111], v[64:67]
    v_mfma_f32_16x16x32_bf16 v[36:39], a[36:39], v[144:147], v[36:39]
    buffer_load_dwordx4 a[132:135], v15, s[4:7], s18 offen offset:3072 sc1
    s_add_u32 s18, s18, 4096
    v_mfma_f32_16x16x32_bf16 v[68:71], a[108:111], v[144:147], v[68:71]
    v_mfma_f32_16x16x32_bf16 v[40:43], a[36:39], v[148:151], v[40:43]
    v_mfma_f32_16x16x32_bf16 v[72:75], a[108:111], v[148:151], v[72:75]
    v_mfma_f32_16x16x32_bf16 v[44:47], a[36:39], v[152:155], v[44:47]
    v_mfma_f32_16x16x32_bf16 v[76:79], a[108:111], v[152:155], v[76:79]
    s_waitcnt lgkmcnt(0)
    s_waitcnt vmcnt(10)
    v_mfma_f32_16x16x32_bf16 v[80:83], v[120:123], v[116:119], v[80:83]
    ds_read_b128 v[156:159], v9 offset:31744
    v_mfma_f32_16x16x32_bf16 v[84:87], v[116:119], v[124:127], v[84:87]
    ds_read_b128 v[160:163], v10 offset:24576
    v_mfma_f32_16x16x32_bf16 v[16:19], v[88:91], a[40:43], v[16:19]
    ds_read_b128 v[164:167], v11 offset:24576
    v_mfma_f32_16x16x32_bf16 v[48:51], v[88:91], a[112:115], v[48:51]
    ds_read_b128 v[128:131], v9 offset:24576
    v_mfma_f32_16x16x32_bf16 v[20:23], v[92:95], a[40:43], v[20:23]
    ds_read_b128 v[132:135], v9 offset:25600
    v_mfma_f32_16x16x32_bf16 v[52:55], v[92:95], a[112:115], v[52:55]
    ds_read_b128 v[136:139], v9 offset:26624
    v_mfma_f32_16x16x32_bf16 v[24:27], v[96:99], a[40:43], v[24:27]
    ds_read_b128 v[140:143], v9 offset:27648
    v_mfma_f32_16x16x32_bf16 v[56:59], v[96:99], a[112:115], v[56:59]
    ds_read_b128 v[152:155], v9 offset:30720
    v_mfma_f32_16x16x32_bf16 v[28:31], v[100:103], a[40:43], v[28:31]
    ds_read_b128 v[144:147], v9 offset:28672
    v_mfma_f32_16x16x32_bf16 v[60:63], v[100:103], a[112:115], v[60:63]
    ds_read_b128 v[148:151], v9 offset:29696
    v_mfma_f32_16x16x32_bf16 v[32:35], v[112:115], a[40:43], v[32:35]
    buffer_load_dwordx4 a[64:67], v3, s[4:7], s18 offen offset:0 sc1
    v_mfma_f32_16x16x32_bf16 v[64:67], v[112:115], a[112:115], v[64:67]
    v_mfma_f32_16x16x32_bf16 v[36:39], a[40:43], v[104:107], v[36:39]
    buffer_load_dwordx4 a[136:139], v15, s[4:7], s18 offen offset:0 sc1
    v_mfma_f32_16x16x32_bf16 v[68:71], a[112:115], v[104:107], v[68:71]
    v_mfma_f32_16x16x32_bf16 v[40:43], a[40:43], v[108:111], v[40:43]
    v_mfma_f32_16x16x32_bf16 v[72:75], a[112:115], v[108:111], v[72:75]
    v_mfma_f32_16x16x32_bf16 v[44:47], a[40:43], v[112:115], v[44:47]
    v_mfma_f32_16x16x32_bf16 v[76:79], a[112:115], v[112:115], v[76:79]
    s_waitcnt lgkmcnt(0)
    s_waitcnt vmcnt(10)
    v_mfma_f32_16x16x32_bf16 v[80:83], v[160:163], v[156:159], v[80:83]
    ds_read_b128 v[116:119], v9 offset:39936
    v_mfma_f32_16x16x32_bf16 v[84:87], v[156:159], v[164:167], v[84:87]
    ds_read_b128 v[120:123], v10 offset:32768
    v_mfma_f32_16x16x32_bf16 v[16:19], v[128:131], a[44:47], v[16:19]
    ds_read_b128 v[124:127], v11 offset:32768
    v_mfma_f32_16x16x32_bf16 v[48:51], v[128:131], a[116:119], v[48:51]
    ds_read_b128 v[88:91], v9 offset:32768
    v_mfma_f32_16x16x32_bf16 v[20:23], v[132:135], a[44:47], v[20:23]
    ds_read_b128 v[92:95], v9 offset:33792
    v_mfma_f32_16x16x32_bf16 v[52:55], v[132:135], a[116:119], v[52:55]
    ds_read_b128 v[96:99], v9 offset:34816
    v_mfma_f32_16x16x32_bf16 v[24:27], v[136:139], a[44:47], v[24:27]
    ds_read_b128 v[100:103], v9 offset:35840
    v_mfma_f32_16x16x32_bf16 v[56:59], v[136:139], a[116:119], v[56:59]
    ds_read_b128 v[112:115], v9 offset:38912
    v_mfma_f32_16x16x32_bf16 v[28:31], v[140:143], a[44:47], v[28:31]
    ds_read_b128 v[104:107], v9 offset:36864
    v_mfma_f32_16x16x32_bf16 v[60:63], v[140:143], a[116:119], v[60:63]
    ds_read_b128 v[108:111], v9 offset:37888
    v_mfma_f32_16x16x32_bf16 v[32:35], v[152:155], a[44:47], v[32:35]
    buffer_load_dwordx4 a[68:71], v3, s[4:7], s18 offen offset:1024 sc1
    v_mfma_f32_16x16x32_bf16 v[64:67], v[152:155], a[116:119], v[64:67]
    v_mfma_f32_16x16x32_bf16 v[36:39], a[44:47], v[144:147], v[36:39]
    buffer_load_dwordx4 a[140:143], v15, s[4:7], s18 offen offset:1024 sc1
    v_mfma_f32_16x16x32_bf16 v[68:71], a[116:119], v[144:147], v[68:71]
    v_mfma_f32_16x16x32_bf16 v[40:43], a[44:47], v[148:151], v[40:43]
    v_mfma_f32_16x16x32_bf16 v[72:75], a[116:119], v[148:151], v[72:75]
    v_mfma_f32_16x16x32_bf16 v[44:47], a[44:47], v[152:155], v[44:47]
    v_mfma_f32_16x16x32_bf16 v[76:79], a[116:119], v[152:155], v[76:79]
    s_waitcnt lgkmcnt(0)
    s_waitcnt vmcnt(10)
    v_mfma_f32_16x16x32_bf16 v[80:83], v[120:123], v[116:119], v[80:83]
    ds_read_b128 v[156:159], v9 offset:48128
    v_mfma_f32_16x16x32_bf16 v[84:87], v[116:119], v[124:127], v[84:87]
    ds_read_b128 v[160:163], v10 offset:40960
    v_mfma_f32_16x16x32_bf16 v[16:19], v[88:91], a[48:51], v[16:19]
    ds_read_b128 v[164:167], v11 offset:40960
    v_mfma_f32_16x16x32_bf16 v[48:51], v[88:91], a[120:123], v[48:51]
    ds_read_b128 v[128:131], v9 offset:40960
    v_mfma_f32_16x16x32_bf16 v[20:23], v[92:95], a[48:51], v[20:23]
    ds_read_b128 v[132:135], v9 offset:41984
    v_mfma_f32_16x16x32_bf16 v[52:55], v[92:95], a[120:123], v[52:55]
    ds_read_b128 v[136:139], v9 offset:43008
    v_mfma_f32_16x16x32_bf16 v[24:27], v[96:99], a[48:51], v[24:27]
    ds_read_b128 v[140:143], v9 offset:44032
    v_mfma_f32_16x16x32_bf16 v[56:59], v[96:99], a[120:123], v[56:59]
    ds_read_b128 v[152:155], v9 offset:47104
    v_mfma_f32_16x16x32_bf16 v[28:31], v[100:103], a[48:51], v[28:31]
    ds_read_b128 v[144:147], v9 offset:45056
    v_mfma_f32_16x16x32_bf16 v[60:63], v[100:103], a[120:123], v[60:63]
    ds_read_b128 v[148:151], v9 offset:46080
    v_mfma_f32_16x16x32_bf16 v[32:35], v[112:115], a[48:51], v[32:35]
    buffer_load_dwordx4 a[144:147], v3, s[4:7], s49 offen offset:0
    v_mfma_f32_16x16x32_bf16 v[64:67], v[112:115], a[120:123], v[64:67]
    v_mfma_f32_16x16x32_bf16 v[36:39], a[48:51], v[104:107], v[36:39]
    buffer_load_dwordx4 a[148:151], v3, s[4:7], s49 offen offset:1024
    v_mfma_f32_16x16x32_bf16 v[68:71], a[120:123], v[104:107], v[68:71]
    v_mfma_f32_16x16x32_bf16 v[40:43], a[48:51], v[108:111], v[40:43]
    buffer_load_dwordx4 a[152:155], v3, s[4:7], s49 offen offset:2048
    v_mfma_f32_16x16x32_bf16 v[72:75], a[120:123], v[108:111], v[72:75]
    v_mfma_f32_16x16x32_bf16 v[44:47], a[48:51], v[112:115], v[44:47]
    buffer_load_dwordx4 a[156:159], v3, s[4:7], s49 offen offset:3072
    v_mfma_f32_16x16x32_bf16 v[76:79], a[120:123], v[112:115], v[76:79]
    s_waitcnt lgkmcnt(0)
    s_waitcnt vmcnt(12)
    v_mfma_f32_16x16x32_bf16 v[80:83], v[160:163], v[156:159], v[80:83]
    ds_read_b128 v[116:119], v9 offset:56320
    v_mfma_f32_16x16x32_bf16 v[84:87], v[156:159], v[164:167], v[84:87]
    ds_read_b128 v[120:123], v10 offset:49152
    v_mfma_f32_16x16x32_bf16 v[16:19], v[128:131], a[52:55], v[16:19]
    ds_read_b128 v[124:127], v11 offset:49152
    v_mfma_f32_16x16x32_bf16 v[48:51], v[128:131], a[124:127], v[48:51]
    ds_read_b128 v[88:91], v9 offset:49152
    v_mfma_f32_16x16x32_bf16 v[20:23], v[132:135], a[52:55], v[20:23]
    ds_read_b128 v[92:95], v9 offset:50176
    v_mfma_f32_16x16x32_bf16 v[52:55], v[132:135], a[124:127], v[52:55]
    ds_read_b128 v[96:99], v9 offset:51200
    v_mfma_f32_16x16x32_bf16 v[24:27], v[136:139], a[52:55], v[24:27]
    ds_read_b128 v[100:103], v9 offset:52224
    v_mfma_f32_16x16x32_bf16 v[56:59], v[136:139], a[124:127], v[56:59]
    ds_read_b128 v[112:115], v9 offset:55296
    v_mfma_f32_16x16x32_bf16 v[28:31], v[140:143], a[52:55], v[28:31]
    ds_read_b128 v[104:107], v9 offset:53248
    v_mfma_f32_16x16x32_bf16 v[60:63], v[140:143], a[124:127], v[60:63]
    ds_read_b128 v[108:111], v9 offset:54272
    v_mfma_f32_16x16x32_bf16 v[32:35], v[152:155], a[52:55], v[32:35]
    buffer_load_dwordx4 a[160:163], v240, s[4:7], s49 offen offset:0
    v_mfma_f32_16x16x32_bf16 v[64:67], v[152:155], a[124:127], v[64:67]
    v_mfma_f32_16x16x32_bf16 v[36:39], a[52:55], v[144:147], v[36:39]
    buffer_load_dwordx4 a[164:167], v240, s[4:7], s49 offen offset:1024
    v_mfma_f32_16x16x32_bf16 v[68:71], a[124:127], v[144:147], v[68:71]
    v_mfma_f32_16x16x32_bf16 v[40:43], a[52:55], v[148:151], v[40:43]
    buffer_load_dwordx4 a[168:171], v240, s[4:7], s49 offen offset:2048
    v_mfma_f32_16x16x32_bf16 v[72:75], a[124:127], v[148:151], v[72:75]
    v_mfma_f32_16x16x32_bf16 v[44:47], a[52:55], v[152:155], v[44:47]
    buffer_load_dwordx4 a[172:175], v240, s[4:7], s49 offen offset:3072
    v_mfma_f32_16x16x32_bf16 v[76:79], a[124:127], v[152:155], v[76:79]
    s_waitcnt lgkmcnt(0)
    s_waitcnt vmcnt(14)
    v_mfma_f32_16x16x32_bf16 v[80:83], v[120:123], v[116:119], v[80:83]
    ds_read_b128 v[156:159], v9 offset:64512
    v_mfma_f32_16x16x32_bf16 v[84:87], v[116:119], v[124:127], v[84:87]
    ds_read_b128 v[160:163], v10 offset:57344
    v_mfma_f32_16x16x32_bf16 v[16:19], v[88:91], a[56:59], v[16:19]
    ds_read_b128 v[164:167], v11 offset:57344
    v_mfma_f32_16x16x32_bf16 v[48:51], v[88:91], a[128:131], v[48:51]
    ds_read_b128 v[128:131], v9 offset:57344
    v_mfma_f32_16x16x32_bf16 v[20:23], v[92:95], a[56:59], v[20:23]
    ds_read_b128 v[132:135], v9 offset:58368
    v_mfma_f32_16x16x32_bf16 v[52:55], v[92:95], a[128:131], v[52:55]
    ds_read_b128 v[136:139], v9 offset:59392
    v_mfma_f32_16x16x32_bf16 v[24:27], v[96:99], a[56:59], v[24:27]
    ds_read_b128 v[140:143], v9 offset:60416
    v_mfma_f32_16x16x32_bf16 v[56:59], v[96:99], a[128:131], v[56:59]
    ds_read_b128 v[152:155], v9 offset:63488
    v_mfma_f32_16x16x32_bf16 v[28:31], v[100:103], a[56:59], v[28:31]
    ds_read_b128 v[144:147], v9 offset:61440
    v_mfma_f32_16x16x32_bf16 v[60:63], v[100:103], a[128:131], v[60:63]
    ds_read_b128 v[148:151], v9 offset:62464
    v_mfma_f32_16x16x32_bf16 v[32:35], v[112:115], a[56:59], v[32:35]
    buffer_load_dwordx4 a[176:179], v241, s[4:7], s49 offen offset:0
    v_mfma_f32_16x16x32_bf16 v[64:67], v[112:115], a[128:131], v[64:67]
    v_mfma_f32_16x16x32_bf16 v[36:39], a[56:59], v[104:107], v[36:39]
    buffer_load_dwordx4 a[180:183], v241, s[4:7], s49 offen offset:1024
    v_mfma_f32_16x16x32_bf16 v[68:71], a[128:131], v[104:107], v[68:71]
    v_mfma_f32_16x16x32_bf16 v[40:43], a[56:59], v[108:111], v[40:43]
    buffer_load_dwordx4 a[184:187], v241, s[4:7], s49 offen offset:2048
    v_mfma_f32_16x16x32_bf16 v[72:75], a[128:131], v[108:111], v[72:75]
    v_mfma_f32_16x16x32_bf16 v[44:47], a[56:59], v[112:115], v[44:47]
    buffer_load_dwordx4 a[188:191], v241, s[4:7], s49 offen offset:3072
    v_mfma_f32_16x16x32_bf16 v[76:79], a[128:131], v[112:115], v[76:79]
    s_waitcnt lgkmcnt(0)
    s_waitcnt vmcnt(16)
    v_add_u32 v9, 0x10000, v9
    v_add_u32 v10, 0x10000, v10
    v_add_u32 v11, 0x10000, v11
    v_mfma_f32_16x16x32_bf16 v[80:83], v[160:163], v[156:159], v[80:83]
    ds_read_b128 v[116:119], v9 offset:7168
    v_mfma_f32_16x16x32_bf16 v[84:87], v[156:159], v[164:167], v[84:87]
    ds_read_b128 v[120:123], v10 offset:0
    v_mfma_f32_16x16x32_bf16 v[16:19], v[128:131], a[60:63], v[16:19]
    ds_read_b128 v[124:127], v11 offset:0
    v_mfma_f32_16x16x32_bf16 v[48:51], v[128:131], a[132:135], v[48:51]
    ds_read_b128 v[88:91], v9 offset:0
    v_mfma_f32_16x16x32_bf16 v[20:23], v[132:135], a[60:63], v[20:23]
    ds_read_b128 v[92:95], v9 offset:1024
    v_mfma_f32_16x16x32_bf16 v[52:55], v[132:135], a[132:135], v[52:55]
    ds_read_b128 v[96:99], v9 offset:2048
    v_mfma_f32_16x16x32_bf16 v[24:27], v[136:139], a[60:63], v[24:27]
    ds_read_b128 v[100:103], v9 offset:3072
    v_mfma_f32_16x16x32_bf16 v[56:59], v[136:139], a[132:135], v[56:59]
    ds_read_b128 v[112:115], v9 offset:6144
    v_mfma_f32_16x16x32_bf16 v[28:31], v[140:143], a[60:63], v[28:31]
    ds_read_b128 v[104:107], v9 offset:4096
    v_mfma_f32_16x16x32_bf16 v[60:63], v[140:143], a[132:135], v[60:63]
    ds_read_b128 v[108:111], v9 offset:5120
    v_mfma_f32_16x16x32_bf16 v[32:35], v[152:155], a[60:63], v[32:35]
    buffer_load_dwordx4 a[192:195], v242, s[4:7], s49 offen offset:0
    v_mfma_f32_16x16x32_bf16 v[64:67], v[152:155], a[132:135], v[64:67]
    v_mfma_f32_16x16x32_bf16 v[36:39], a[60:63], v[144:147], v[36:39]
    buffer_load_dwordx4 a[196:199], v242, s[4:7], s49 offen offset:1024
    v_mfma_f32_16x16x32_bf16 v[68:71], a[132:135], v[144:147], v[68:71]
    v_mfma_f32_16x16x32_bf16 v[40:43], a[60:63], v[148:151], v[40:43]
    buffer_load_dwordx4 a[200:203], v242, s[4:7], s49 offen offset:2048
    v_mfma_f32_16x16x32_bf16 v[72:75], a[132:135], v[148:151], v[72:75]
    v_mfma_f32_16x16x32_bf16 v[44:47], a[60:63], v[152:155], v[44:47]
    buffer_load_dwordx4 a[204:207], v242, s[4:7], s49 offen offset:3072
    v_mfma_f32_16x16x32_bf16 v[76:79], a[132:135], v[152:155], v[76:79]
    s_waitcnt lgkmcnt(0)
    s_waitcnt vmcnt(18)
    v_mfma_f32_16x16x32_bf16 v[80:83], v[120:123], v[116:119], v[80:83]
    ds_read_b128 v[156:159], v9 offset:15360
    v_cndmask_b32 v200, v216, v217, s[30:31]
    v_mfma_f32_16x16x32_bf16 v[84:87], v[116:119], v[124:127], v[84:87]
    ds_read_b128 v[160:163], v10 offset:8192
    v_cndmask_b32 v201, v218, v219, s[30:31]
    v_mfma_f32_16x16x32_bf16 v[16:19], v[88:91], a[64:67], v[16:19]
    ds_read_b128 v[164:167], v11 offset:8192
    v_cndmask_b32 v202, v176, v177, s[30:31]
    v_mfma_f32_16x16x32_bf16 v[48:51], v[88:91], a[136:139], v[48:51]
    ds_read_b128 v[128:131], v9 offset:8192
    v_cndmask_b32 v203, v178, v179, s[30:31]
    v_mfma_f32_16x16x32_bf16 v[20:23], v[92:95], a[64:67], v[20:23]
    ds_read_b128 v[132:135], v9 offset:9216
    v_cndmask_b32 v204, v184, v185, s[30:31]
    v_mfma_f32_16x16x32_bf16 v[52:55], v[92:95], a[136:139], v[52:55]
    ds_read_b128 v[136:139], v9 offset:10240
    v_cndmask_b32 v205, v186, v187, s[30:31]
    v_mfma_f32_16x16x32_bf16 v[24:27], v[96:99], a[64:67], v[24:27]
    ds_read_b128 v[140:143], v9 offset:11264
    v_cmp_ne_u32 vcc, 0, v248
    v_mfma_f32_16x16x32_bf16 v[56:59], v[96:99], a[136:139], v[56:59]
    ds_read_b128 v[152:155], v9 offset:14336
    v_cndmask_b32 v244, v200, v202, vcc
    v_mfma_f32_16x16x32_bf16 v[28:31], v[100:103], a[64:67], v[28:31]
    ds_read_b128 v[144:147], v9 offset:12288
    v_cndmask_b32 v246, v202, v204, vcc
    v_mfma_f32_16x16x32_bf16 v[60:63], v[100:103], a[136:139], v[60:63]
    ds_read_b128 v[148:151], v9 offset:13312
    v_cmp_ne_u32 vcc, 0, v249
    v_mfma_f32_16x16x32_bf16 v[32:35], v[112:115], a[64:67], v[32:35]
    s_nop 0
    v_cndmask_b32 v245, v201, v203, vcc
    buffer_load_dwordx4 a[208:211], v243, s[4:7], s49 offen offset:0
    v_mfma_f32_16x16x32_bf16 v[64:67], v[112:115], a[136:139], v[64:67]
    v_cndmask_b32 v247, v203, v205, vcc
    v_mfma_f32_16x16x32_bf16 v[36:39], a[64:67], v[104:107], v[36:39]
    v_mul_f32 v206, 0x3eae1a93, v168
    buffer_load_dwordx4 a[212:215], v243, s[4:7], s49 offen offset:1024
    v_mfma_f32_16x16x32_bf16 v[68:71], a[136:139], v[104:107], v[68:71]
    v_mul_f32 v244, v244, v206
    v_mfma_f32_16x16x32_bf16 v[40:43], a[64:67], v[108:111], v[40:43]
    v_mul_f32 v245, v245, v206
    v_mfma_f32_16x16x32_bf16 v[72:75], a[136:139], v[108:111], v[72:75]
    v_mul_f32 v207, 0x3eae1a93, v170
    v_mfma_f32_16x16x32_bf16 v[44:47], a[64:67], v[112:115], v[44:47]
    v_mul_f32 v246, v246, v207
    v_mfma_f32_16x16x32_bf16 v[76:79], a[136:139], v[112:115], v[76:79]
    v_mul_f32 v247, v247, v207
    s_waitcnt lgkmcnt(0)
    s_waitcnt vmcnt(18)
    s_lshl_b32 s32, s27, 6
    s_add_u32 s32, s32, 162816
    v_add_u32 v12, s32, v7
    s_lshl_b32 s33, s28, 6
    s_add_u32 s33, s33, 162816
    v_add_u32 v13, s33, v8
    s_mov_b32 s34, 0x00010001
    s_mov_b32 s35, 0x00010001
    v_mfma_f32_16x16x32_bf16 v[80:83], v[160:163], v[156:159], v[80:83]
    v_mov_b32 v91, 0
    v_mfma_f32_16x16x32_bf16 v[84:87], v[156:159], v[164:167], v[84:87]
    v_mov_b32 v95, 0
    v_mfma_f32_16x16x32_bf16 v[16:19], v[128:131], a[68:71], v[16:19]
    v_mov_b32 v99, 0
    v_mfma_f32_16x16x32_bf16 v[48:51], v[128:131], a[140:143], v[48:51]
    v_mov_b32 v103, 0
    v_mfma_f32_16x16x32_bf16 v[20:23], v[132:135], a[68:71], v[20:23]
    v_mov_b32 v107, 0
    v_mfma_f32_16x16x32_bf16 v[52:55], v[132:135], a[140:143], v[52:55]
    v_mov_b32 v111, 0
    v_mfma_f32_16x16x32_bf16 v[24:27], v[136:139], a[68:71], v[24:27]
    v_mov_b32 v115, 0
    v_mfma_f32_16x16x32_bf16 v[56:59], v[136:139], a[140:143], v[56:59]
    v_mov_b32 v119, 0
    v_mfma_f32_16x16x32_bf16 v[28:31], v[140:143], a[68:71], v[28:31]
    v_mov_b32 v123, 0
    v_mfma_f32_16x16x32_bf16 v[60:63], v[140:143], a[140:143], v[60:63]
    v_mov_b32 v127, 0
    v_mfma_f32_16x16x32_bf16 v[32:35], v[152:155], a[68:71], v[32:35]
    s_mov_b64 exec, s[34:35]
    ds_write_b128 v12, v[80:83]
    s_mov_b64 exec, 0xffff
    ds_write_b32 v13, v84
    s_mov_b64 exec, -1
    v_mfma_f32_16x16x32_bf16 v[64:67], v[152:155], a[140:143], v[64:67]
    v_mfma_f32_16x16x32_bf16 v[36:39], a[68:71], v[144:147], v[36:39]
    v_mfma_f32_16x16x32_bf16 v[68:71], a[140:143], v[144:147], v[68:71]
    v_mfma_f32_16x16x32_bf16 v[40:43], a[68:71], v[148:151], v[40:43]
    v_mfma_f32_16x16x32_bf16 v[72:75], a[140:143], v[148:151], v[72:75]
    v_mfma_f32_16x16x32_bf16 v[44:47], a[68:71], v[152:155], v[44:47]
    v_mfma_f32_16x16x32_bf16 v[76:79], a[140:143], v[152:155], v[76:79]
    s_waitcnt lgkmcnt(0)
    s_nop 6
    s_branch main_kernel_epi
main_kernel_fin:
    s_mov_b32 s40, s38
    s_and_b32 s41, s39, 0xffff
    s_mov_b32 s42, 2359296
    s_mov_b32 s43, 0x00020000
    s_lshl_b32 s20, s8, 3
    s_lshr_b32 s21, s9, 1
    s_add_u32 s20, s20, s21
    s_mul_i32 s20, s20, 18432
    v_mul_u32_u24 v6, 592, v4
    v_lshl_add_u32 v6, v5, 3, v6
    s_lshl_b32 s21, s3, 6
    v_add_u32 v6, s21, v6
    s_mov_b32 s21, 16384
    s_cmp_eq_u32 s3, 0
    s_cselect_b32 s21, 512, s21
    v_add_u32 v7, s21, v6
    ds_write_b64 v6, v[40:41] offset:0
    ds_write_b64 v6, v[42:43] offset:32
    ds_write_b64 v6, v[44:45] offset:256
    ds_write_b64 v6, v[46:47] offset:288
    ds_write_b64 v7, v[48:49] offset:0
    ds_write_b64 v7, v[50:51] offset:32
    v_add_u32 v60, 0, v0
    v_mul_u32_u24 v64, 1821, v60
    v_lshrrev_b32 v64, 16, v64
    v_mul_u32_u24 v68, 36, v64
    v_sub_u32 v68, v60, v68
    v_lshlrev_b32 v68, 4, v68
    v_mul_u32_u24 v72, 592, v64
    v_add_u32 v72, v72, v68
    v_mul_u32_u24 v76, 1152, v64
    v_add_u32 v76, v76, v68
    v_add_u32 v61, 256, v0
    v_mul_u32_u24 v65, 1821, v61
    v_lshrrev_b32 v65, 16, v65
    v_mul_u32_u24 v69, 36, v65
    v_sub_u32 v69, v61, v69
    v_lshlrev_b32 v69, 4, v69
    v_mul_u32_u24 v73, 592, v65
    v_add_u32 v73, v73, v69
    v_mul_u32_u24 v77, 1152, v65
    v_add_u32 v77, v77, v69
    v_add_u32 v62, 512, v0
    v_mul_u32_u24 v66, 1821, v62
    v_lshrrev_b32 v66, 16, v66
    v_mul_u32_u24 v70, 36, v66
    v_sub_u32 v70, v62, v70
    v_lshlrev_b32 v70, 4, v70
    v_mul_u32_u24 v74, 592, v66
    v_add_u32 v74, v74, v70
    v_mul_u32_u24 v78, 1152, v66
    v_add_u32 v78, v78, v70
    s_mul_i32 s21, s15, 576
    s_add_u32 s20, s20, s21
    s_cmp_eq_u32 s3, 0
    s_cselect_b32 s21, s20, 268435456
    s_waitcnt lgkmcnt(0)
    s_barrier
    ds_read_b128 v[80:83], v72
    ds_read_b128 v[84:87], v73
    ds_read_b128 v[88:91], v74
    s_waitcnt lgkmcnt(2)
    buffer_store_dwordx4 v[80:83], v76, s[40:43], s20 offen sc1
    s_waitcnt lgkmcnt(1)
    buffer_store_dwordx4 v[84:87], v77, s[40:43], s20 offen sc1
    s_waitcnt lgkmcnt(0)
    buffer_store_dwordx4 v[88:91], v78, s[40:43], s21 offen sc1
    s_endpgm
    s_nop 0
main_kernel_w0:
    s_add_u32 s57, s57, 1
    s_cmp_gt_u32 s57, 0x40000
    s_cbranch_scc1 main_kernel_r0
    s_sleep 2
    s_mov_b64 exec, 15
    buffer_load_dword v2, v15, s[4:7], s27 offen sc1
    s_mov_b64 exec, -1
    s_waitcnt vmcnt(0)
    v_cmp_ge_u32 vcc, 0, v2
    s_nop 0
    s_and_b32 s30, vcc_lo, 15
    s_nop 2
    s_cbranch_scc1 main_kernel_w0
    s_branch main_kernel_r0
main_kernel_w1:
    s_add_u32 s57, s57, 1
    s_cmp_gt_u32 s57, 0x40000
    s_cbranch_scc1 main_kernel_r1
    s_sleep 2
    s_mov_b64 exec, 15
    buffer_load_dword v243, v15, s[4:7], s27 offen sc1
    s_mov_b64 exec, -1
    s_waitcnt vmcnt(0)
    v_cmp_ge_u32 vcc, 1, v243
    s_nop 0
    s_and_b32 s30, vcc_lo, 15
    s_nop 2
    s_cbranch_scc1 main_kernel_w1
    s_branch main_kernel_r1
main_kernel_w2:
    s_add_u32 s57, s57, 1
    s_cmp_gt_u32 s57, 0x40000
    s_cbranch_scc1 main_kernel_r2
    s_sleep 2
    s_mov_b64 exec, 15
    buffer_load_dword v2, v15, s[4:7], s27 offen sc1
    s_mov_b64 exec, -1
    s_waitcnt vmcnt(0)
    v_cmp_ge_u32 vcc, 2, v2
    s_nop 0
    s_and_b32 s30, vcc_lo, 15
    s_nop 2
    s_cbranch_scc1 main_kernel_w2
    s_branch main_kernel_r2
main_kernel_end:
    s_endpgm

code_end:
    s_endpgm
.section .rodata,"a"
.p2align 6
.amdhsa_kernel p0_kernel
  .amdhsa_next_free_vgpr 96
  .amdhsa_next_free_sgpr 102
  .amdhsa_accum_offset 96
  .amdhsa_group_segment_fixed_size 0
  .amdhsa_kernarg_size 88
  .amdhsa_user_sgpr_count 2
  .amdhsa_user_sgpr_kernarg_segment_ptr 1
  .amdhsa_system_sgpr_workgroup_id_x 1
.end_amdhsa_kernel

.p2align 6
.amdhsa_kernel main_kernel
  .amdhsa_next_free_vgpr 512
  .amdhsa_next_free_sgpr 102
  .amdhsa_accum_offset 256
  .amdhsa_group_segment_fixed_size 0
  .amdhsa_kernarg_size 88
  .amdhsa_user_sgpr_count 2
  .amdhsa_user_sgpr_kernarg_segment_ptr 1
  .amdhsa_system_sgpr_workgroup_id_x 1
.end_amdhsa_kernel
```
